```python
import torch

def _softmax(x, axis=-1):
    return torch.softmax(x, dim=axis)
def _gelu(x):
    return torch.nn.functional.gelu(x, approximate="tanh")
def _silu(x):
    return torch.nn.functional.silu(x)
def _sigmoid(x):
    return torch.sigmoid(x)
def _layernorm(x, axis=-1, eps=1e-5):
    m = x.mean(dim=axis, keepdim=True)
    v = x.var(dim=axis, keepdim=True, unbiased=False)
    return (x - m) / torch.sqrt(v + eps)
def _scatter_add(tgt, idx, src, axis=0):
    return tgt.clone().index_add_(axis, idx, src)
def _segment_sum(src, seg, n):
    out = torch.zeros((n,) + src.shape[1:], dtype=src.dtype)
    return out.index_add_(0, seg, src)
def _pad(x, pw):
    flat = tuple(v for pair in reversed(pw) for v in pair)
    return torch.nn.functional.pad(x, flat)

kernel_name = 'parallel_sum__softmax_full_mha__dense_activation_squared_relu__prompt'

def setup_inputs():

    _w = (lambda a: (lambda t: t.to(torch.bfloat16) if t.is_floating_point() else t)(torch.as_tensor(a)))
    def _A_setup():
        B, S, D = 1, 2048, 448
        return {
            "x": _w((lambda *s: torch.randn(*s, dtype=torch.bfloat16) * 0.05)(B, S, D)),
            "wqkv": _w((lambda *s: torch.randn(*s, dtype=torch.bfloat16) * 0.2)(D, 3 * D)),
            "wo": _w((lambda *s: torch.randn(*s, dtype=torch.bfloat16) * 0.1)(D, D)),
        }
    _A_in = _A_setup()

    def _B_setup():
        B, S, D, F = 1, 2048, 448, 1792
        return {
            "x": _w((lambda *s: torch.randn(*s, dtype=torch.bfloat16) * 0.05)(B, S, D)),
            "w1": _w((lambda *s: torch.randn(*s, dtype=torch.bfloat16) * 0.1)(D, F)),
            "b1": _w((lambda *s: torch.randn(*s, dtype=torch.bfloat16) * 0.8)(F)),
            "w2": _w((lambda *s: torch.randn(*s, dtype=torch.bfloat16) * 0.1)(F, D)),
            "b2": _w((lambda *s: torch.randn(*s, dtype=torch.bfloat16) * 12.8)(D)),
        }
    _B_in = _B_setup()

    return {
        "A_x": _A_in["x"],
        "A_wqkv": _A_in["wqkv"],
        "A_wo": _A_in["wo"],
        "B_x": _B_in["x"],
        "B_w1": _B_in["w1"],
        "B_b1": _B_in["b1"],
        "B_w2": _B_in["w2"],
        "B_b2": _B_in["b2"],
    }

def reference(A_x, A_wqkv, A_wo, B_x, B_w1, B_b1, B_w2, B_b2):
    def _A_ref(x, wqkv, wo):
        B, S, D = x.shape
        H = 16; Dh = D // H
        qkv = (lambda x, *d: x.permute(*d))((x @ wqkv).reshape(B, S, 3, H, Dh), 2, 0, 3, 1, 4)
        q, k, v = qkv[0], qkv[1], qkv[2]
        scale = Dh ** -0.5
        scores = torch.einsum("bhqd,bhkd->bhqk", q, k) * scale
        p = _softmax(scores, axis=-1)
        o = torch.einsum("bhqk,bhkd->bhqd", p, v)
        return (lambda x, *d: x.permute(*d))(o, 0, 2, 1, 3).reshape(B, S, D) @ wo

    def _B_ref(x, w1, b1, w2, b2):
        h = torch.einsum("bsd,df->bsf", x, w1) + b1
        zero = torch.zeros_like(h)
        r = torch.where(h > zero, h, zero)
        h = r * r
        out = torch.einsum("bsf,fd->bsd", h, w2) + b2
        return out

    x = A_x
    xn = _layernorm(x, axis=-1)
    return x + _A_ref(xn, A_wqkv, A_wo) + _B_ref(xn, B_w1, B_b1, B_w2, B_b2)
```

```asm
; @launch grid=(256,1,1) block=(256,1,1) lds=163840
.amdgcn_target "amdgcn-amd-amdhsa--gfx950"
.text
.globl parallel_sum__softmax_full_mha__dense_activation_squared_relu__prompt_kernel
.p2align 12
.fill 320, 4, 0xbf800000
.p2align 8
.type parallel_sum__softmax_full_mha__dense_activation_squared_relu__prompt_kernel,@function
parallel_sum__softmax_full_mha__dense_activation_squared_relu__prompt_kernel:
    s_cmp_ge_u32 s2, 256
    s_cbranch_scc1 L_done
    s_nop 0
    s_load_dwordx16 s[64:79], s[0:1], 0
    s_load_dwordx4 s[88:91], s[0:1], 64
    s_load_dwordx2 s[92:93], s[0:1], 80
    v_lshrrev_b32 v1, 6, v0
    s_getpc_b64 s[86:87]
L_pc:
    v_readfirstlane_b32 s44, v1
    v_and_b32 v1, 63, v0
    s_lshr_b32 s49, s2, 3
    s_lshl_b32 s49, s49, 11
    s_lshl_b32 s50, s44, 9
    s_add_u32 s49, s49, s50
    s_min_u32 s49, s49, L_code_end-L_pc-512
    v_lshlrev_b32 v12, 3, v1
    v_add_u32 v12, s49, v12
    global_load_dwordx2 a[250:251], v12, s[86:87]
    s_and_b32 s49, s2, 3
    s_lshl_b32 s49, s49, 2
    s_lshr_b32 s50, s2, 6
    s_add_u32 s45, s49, s50
    v_lshlrev_b32 v2, 4, v1
    v_lshrrev_b32 v3, 3, v1
    v_mul_u32_u24 v3, 896, v3
    v_and_b32 v4, 7, v1
    v_lshrrev_b32 v5, 4, v1
    v_xor_b32_e64 v4, v4, v5
    v_lshl_add_u32 v10, v4, 4, v3
    v_xor_b32_e64 v11, 64, v10
    s_lshl_b32 s49, s45, 2
    s_add_u32 s49, s49, s44
    s_mul_i32 s50, s44, 28672
    s_mov_b32 m0, s50
    s_nop 0
    s_mul_i32 s96, s49, 28672
    s_mov_b32 s10, 1835008
    s_mov_b32 s11, 0x00020000
    s_mov_b32 s6, 268435456
    s_mov_b32 s7, 0x00020000
    s_lshr_b32 s49, s2, 3
    s_and_b32 s49, s49, 7
    s_lshl_b32 s51, s45, 1
    s_add_u32 s49, s49, s51
    s_mul_i32 s51, s49, 37
    s_lshr_b32 s51, s51, 8
    s_mul_i32 s51, s51, 7
    s_sub_u32 s80, s49, s51
    s_waitcnt lgkmcnt(0)
    s_mov_b32 s8, s64
    s_mov_b32 s9, s65
    s_mov_b32 s4, s92
    s_mov_b32 s5, s93
    s_mov_b32 s36, s88
    s_mov_b32 s37, s89
    s_mov_b32 s40, s90
    s_mov_b32 s41, s91
    s_or_b32 s51, s2, s44
    s_cmp_lg_u32 s51, 0
    s_cbranch_scc1 L_noclear
    v_lshlrev_b32 v12, 7, v1
    v_mov_b32 v13, 0
    s_mov_b32 s51, 16777216
    s_mov_b32 exec_hi, 0xffff
    buffer_store_dword v13, v12, s[4:7], s51 offen sc1
    s_mov_b32 exec_hi, -1
L_noclear:
    s_lshl_b32 s87, s80, 7
    s_add_u32 s87, s87, s96
    s_nop 0
    buffer_load_dwordx4 v10, s[8:11], s87 offen lds
    s_addk_i32 m0, 1024
    s_addk_i32 s87, 7168
    s_add_u32 s53, s80, 1
    s_cmp_eq_u32 s53, 7
    s_cselect_b32 s81, 0, s53
    s_mov_b32 s12, s66
    s_mov_b32 s13, s67
    s_mov_b32 s28, s68
    s_mov_b32 s29, s69
    s_mov_b32 s16, s72
    s_mov_b32 s17, s73
    s_mov_b32 s20, s74
    s_mov_b32 s21, s75
    s_mov_b32 s24, s76
    buffer_load_dwordx4 v11, s[8:11], s87 offen lds
    s_addk_i32 m0, 1024
    s_addk_i32 s87, 7168
    s_mov_b32 s25, s77
    s_mov_b32 s32, s78
    s_mov_b32 s33, s79
    s_nop 0
    s_mov_b32 s14, 1204224
    s_mov_b32 s15, 0x00020000
    s_mov_b32 s18, 1605632
    s_mov_b32 s19, 0x00020000
    s_mov_b32 s42, 256
    s_mov_b32 s43, 0x00020000
    buffer_load_dwordx4 v10, s[8:11], s87 offen lds
    s_addk_i32 m0, 1024
    s_addk_i32 s87, 7168
    s_mov_b32 s22, 3584
    s_mov_b32 s23, 0x00020000
    s_mov_b32 s26, 1605632
    s_mov_b32 s27, 0x00020000
    s_mov_b32 s30, 401408
    s_mov_b32 s31, 0x00020000
    s_mov_b32 s34, 896
    s_mov_b32 s35, 0x00020000
    s_mov_b32 s38, 1835008
    buffer_load_dwordx4 v11, s[8:11], s87 offen lds
    s_addk_i32 m0, 1024
    s_nop 0
    s_mov_b32 s39, 0x00020000
    s_lshr_b32 s49, s2, 2
    s_and_b32 s49, s49, 1
    s_lshl_b32 s49, s49, 3
    s_lshr_b32 s50, s2, 3
    s_and_b32 s50, s50, 7
    s_add_u32 s46, s49, s50
    v_lshrrev_b32 v3, 2, v1
    s_lshl_b32 s49, s44, 4
    s_lshl_b32 s87, s81, 7
    s_add_u32 s87, s87, s96
    buffer_load_dwordx4 v10, s[8:11], s87 offen lds
    s_addk_i32 m0, 1024
    s_addk_i32 s87, 7168
    s_add_u32 s53, s81, 1
    s_cmp_eq_u32 s53, 7
    s_cselect_b32 s82, 0, s53
    v_add_u32 v3, s49, v3
    v_mul_u32_u24 v3, 2688, v3
    v_and_b32 v4, 3, v1
    v_lshlrev_b32 v4, 4, v4
    s_mul_i32 s50, s46, 168
    v_add3_u32 v7, v3, v4, s50
    s_lshr_b32 s49, s46, 2
    s_mul_i32 s49, s49, 7
    s_and_b32 s50, s46, 3
    s_nop 0
    buffer_load_dwordx4 v11, s[8:11], s87 offen lds
    s_addk_i32 m0, 1024
    s_addk_i32 s87, 7168
    s_lshl_b32 s51, s50, 1
    s_add_u32 s47, s49, s51
    s_lshl_b32 s97, s47, 7
    s_add_u32 s50, s50, 1
    s_lshr_b32 s50, s50, 2
    s_sub_u32 s48, 2, s50
    v_lshrrev_b32_e64 v3, 2, v1
    v_and_b32 v3, 7, v3
    s_lshl_b32 s49, s44, 3
    buffer_load_dwordx4 v10, s[8:11], s87 offen lds
    s_addk_i32 m0, 1024
    s_addk_i32 s87, 7168
    v_add_u32_e64 v3, s49, v3
    v_mul_u32_u24 v3, 3584, v3
    v_lshrrev_b32 v6, 5, v1
    v_lshlrev_b32 v5, 6, v6
    v_add3_u32 v8, v3, v4, v5
    v_and_b32 v3, 31, v1
    v_lshrrev_b32 v4, 3, v3
    v_lshlrev_b32 v4, 10, v4
    v_and_b32 v5, 7, v3
    buffer_load_dwordx4 v11, s[8:11], s87 offen lds
    s_addk_i32 m0, 1024
    v_lshlrev_b32 v5, 7, v5
    s_mul_i32 s49, s44, 28672
    v_add3_u32 v4, v4, v5, s49
    v_lshrrev_b32 v3, 1, v3
    v_and_b32 v3, 7, v3
    v_xor_b32 v3, v3, v6
    v_xor_b32 v5, 0, v3
    v_lshl_add_u32 v12, v5, 4, v4
    v_xor_b32_e64 v5, 2, v3
    s_lshl_b32 s87, s82, 7
    s_add_u32 s87, s87, s96
    buffer_load_dwordx4 v10, s[8:11], s87 offen lds
    s_addk_i32 m0, 1024
    s_addk_i32 s87, 7168
    s_add_u32 s53, s82, 1
    s_cmp_eq_u32 s53, 7
    s_cselect_b32 s83, 0, s53
    s_nop 0
    v_lshl_add_u32 v13, v5, 4, v4
    v_xor_b32_e64 v5, 4, v3
    v_lshl_add_u32 v14, v5, 4, v4
    v_xor_b32_e64 v5, 6, v3
    v_lshl_add_u32 v15, v5, 4, v4
    v_lshrrev_b32 v3, 2, v1
    v_and_b32 v3, 3, v3
    v_lshlrev_b32 v3, 6, v3
    v_lshrrev_b32 v4, 4, v1
    buffer_load_dwordx4 v11, s[8:11], s87 offen lds
    s_addk_i32 m0, 1024
    s_addk_i32 s87, 7168
    v_and_b32 v4, 1, v4
    v_lshlrev_b32 v4, 5, v4
    v_and_b32 v5, 3, v1
    v_lshlrev_b32 v5, 3, v5
    v_add3_u32 v16, v3, v4, v5
    v_lshlrev_b32 v4, 9, v6
    v_add_u32 v4, v16, v4
    v_add_u32 v3, 114688, v4
    v_add_u32 v4, 67584, v4
    buffer_load_dwordx4 v10, s[8:11], s87 offen lds
    s_addk_i32 m0, 1024
    s_addk_i32 s87, 7168
    v_lshlrev_b32 v17, 10, v6
    v_add_u32 v5, v16, v17
    v_add_u32 v9, 67584, v5
    s_mov_b32 s54, 0x3f803f80
    s_mov_b32 s55, 0xffff0000
    s_mov_b32 s56, 0x3e8b97f6
    s_mul_i32 s49, s46, 3
    s_add_u32 s49, s49, 0
    s_lshr_b32 s77, s49, 4
    s_nop 0
    buffer_load_dwordx4 v11, s[8:11], s87 offen lds
    s_addk_i32 m0, 1024
    s_and_b32 s49, s49, 15
    s_lshl_b32 s49, s49, 6
    s_lshl_b32 s51, s45, 2
    s_add_u32 s49, s49, s51
    s_add_u32 s49, s49, s44
    s_min_u32 s51, s77, 1
    s_add_u32 s51, s51, 11
    s_lshl_b32 s49, s49, s51
    s_min_u32 s51, s77, 1
    s_lshl_b32 s87, s83, 7
    s_add_u32 s87, s87, s96
    buffer_load_dwordx4 v10, s[8:11], s87 offen lds
    s_addk_i32 m0, 1024
    s_addk_i32 s87, 7168
    s_add_u32 s53, s83, 1
    s_cmp_eq_u32 s53, 7
    s_cselect_b32 s84, 0, s53
    s_nop 0
    s_mul_i32 s51, s51, 2097152
    s_add_u32 s49, s49, s51
    s_lshr_b32 s51, s77, 1
    s_lshl_b32 s51, s51, 11
    s_add_u32 s74, s49, s51
    s_mul_i32 s49, s46, 3
    s_add_u32 s49, s49, 1
    s_lshr_b32 s78, s49, 4
    s_and_b32 s49, s49, 15
    buffer_load_dwordx4 v11, s[8:11], s87 offen lds
    s_addk_i32 m0, 1024
    s_addk_i32 s87, 7168
    s_lshl_b32 s49, s49, 6
    s_lshl_b32 s51, s45, 2
    s_add_u32 s49, s49, s51
    s_add_u32 s49, s49, s44
    s_min_u32 s51, s78, 1
    s_add_u32 s51, s51, 11
    s_lshl_b32 s49, s49, s51
    s_min_u32 s51, s78, 1
    s_mul_i32 s51, s51, 2097152
    buffer_load_dwordx4 v10, s[8:11], s87 offen lds
    s_addk_i32 m0, 1024
    s_addk_i32 s87, 7168
    s_add_u32 s49, s49, s51
    s_lshr_b32 s51, s78, 1
    s_lshl_b32 s51, s51, 11
    s_add_u32 s75, s49, s51
    s_mul_i32 s49, s46, 3
    s_add_u32 s49, s49, 2
    s_lshr_b32 s79, s49, 4
    s_and_b32 s49, s49, 15
    s_lshl_b32 s49, s49, 6
    s_nop 0
    buffer_load_dwordx4 v11, s[8:11], s87 offen lds
    s_addk_i32 m0, 1024
    s_lshl_b32 s51, s45, 2
    s_add_u32 s49, s49, s51
    s_add_u32 s49, s49, s44
    s_min_u32 s51, s79, 1
    s_add_u32 s51, s51, 11
    s_lshl_b32 s49, s49, s51
    s_min_u32 s51, s79, 1
    s_mul_i32 s51, s51, 2097152
    s_add_u32 s49, s49, s51
    s_lshl_b32 s87, s84, 7
    s_add_u32 s87, s87, s96
    s_nop 0
    buffer_load_dwordx4 v10, s[8:11], s87 offen lds
    s_addk_i32 m0, 1024
    s_addk_i32 s87, 7168
    s_add_u32 s53, s84, 1
    s_cmp_eq_u32 s53, 7
    s_cselect_b32 s85, 0, s53
    s_lshr_b32 s51, s79, 1
    s_lshl_b32 s51, s51, 11
    s_add_u32 s76, s49, s51
    s_and_b32 s49, s2, 7
    s_lshl_b32 s49, s49, 1
    s_lshr_b32 s50, s2, 3
    s_and_b32 s57, s50, 1
    s_add_u32 s57, s57, s49
    s_lshr_b32 s58, s2, 4
    buffer_load_dwordx4 v11, s[8:11], s87 offen lds
    s_addk_i32 m0, 1024
    s_addk_i32 s87, 7168
    s_min_u32 s50, s50, 27
    s_mul_i32 s51, s50, 37
    s_lshr_b32 s51, s51, 8
    s_mul_i32 s52, s51, 7
    s_sub_u32 s60, s50, s52
    s_and_b32 s49, s2, 7
    s_lshl_b32 s49, s49, 2
    s_add_u32 s59, s49, s51
    v_lshrrev_b32_e64 v18, 2, v1
    buffer_load_dwordx4 v10, s[8:11], s87 offen lds
    s_addk_i32 m0, 1024
    s_addk_i32 s87, 7168
    v_and_b32 v19, 3, v18
    v_lshlrev_b32 v19, 6, v19
    v_lshrrev_b32 v20, 4, v1
    v_and_b32 v20, 1, v20
    v_lshlrev_b32 v20, 5, v20
    v_and_b32 v21, 3, v1
    v_lshlrev_b32_e64 v22, 3, v21
    v_add3_u32 v19, v19, v20, v22
    v_lshrrev_b32_e64 v20, 5, v1
    buffer_load_dwordx4 v11, s[8:11], s87 offen lds
    s_addk_i32 m0, 1024
    v_lshlrev_b32 v22, 8, v20
    s_mul_i32 s67, s44, 28672
    s_lshr_b32 s49, s44, 1
    s_lshl_b32 s49, s49, 9
    s_add_u32 s49, s49, s67
    s_nop 0
    v_add3_u32 v248, v19, v22, s49
    v_xor_b32 v253, 512, v248
    v_and_b32_e64 v18, 7, v18
    v_mul_u32_u24 v18, 896, v18
    s_lshl_b32 s87, s85, 7
    s_add_u32 s87, s87, s96
    buffer_load_dwordx4 v10, s[8:11], s87 offen lds
    s_addk_i32 m0, 1024
    s_addk_i32 s87, 7168
    s_add_u32 s53, s85, 1
    s_cmp_eq_u32 s53, 7
    s_cselect_b32 s86, 0, s53
    v_lshlrev_b32 v20, 6, v20
    v_lshlrev_b32_e64 v21, 4, v21
    v_add3_u32 v18, v18, v20, v21
    s_lshl_b32 s49, s60, 7
    v_add_u32 v249, s49, v18
    s_and_b32 s51, s44, 1
    s_nop 0
    s_mul_i32 s49, s59, 112
    s_mul_i32 s50, s44, 14
    s_add_u32 s49, s49, s50
    buffer_load_dwordx4 v11, s[8:11], s87 offen lds
    s_addk_i32 m0, 1024
    s_addk_i32 s87, 7168
    s_lshl_b32 s49, s49, 11
    s_nop 0
    s_add_u32 s49, s49, 8388608
    s_mul_i32 s50, s51, 114688
    s_add_u32 s64, s49, s50
    s_sub_u32 s98, s49, s50
    s_add_u32 s98, s98, 114688
    s_lshl_b32 s49, s59, 5
    s_lshl_b32 s50, s44, 2
    s_add_u32 s49, s49, s50
    s_nop 0
    buffer_load_dwordx4 v10, s[8:11], s87 offen lds
    s_addk_i32 m0, 1024
    s_addk_i32 s87, 7168
    s_lshl_b32 s49, s49, 11
    s_nop 0
    s_add_u32 s49, s49, 6291456
    s_lshl_b32 s50, s51, 15
    s_add_u32 s65, s49, s50
    s_sub_u32 s99, s49, s50
    s_nop 0
    s_add_u32 s99, s99, 32768
    s_mul_i32 s66, s44, 401408
    s_mul_i32 s68, s44, 100352
    v_and_b32_e64 v18, 31, v1
    buffer_load_dwordx4 v11, s[8:11], s87 offen lds
    s_addk_i32 m0, 1024
    s_lshl_b32 s49, s59, 6
    s_lshl_b32 s50, s51, 5
    s_add_u32 s49, s49, s50
    v_add_u32_e64 v18, s49, v18
    v_mul_u32_u24 v18, 896, v18
    v_lshrrev_b32 v20, 5, v1
    v_lshlrev_b32 v20, 4, v20
    s_lshl_b32 s49, s60, 7
    s_lshr_b32 s50, s44, 1
    s_lshl_b32 s87, s86, 7
    s_add_u32 s87, s87, s96
    buffer_load_dwordx4 v10, s[8:11], s87 offen lds
    s_addk_i32 m0, 1024
    s_addk_i32 s87, 7168
    s_lshl_b32 s50, s50, 6
    s_add_u32 s49, s49, s50
    v_add3_u32 v250, v18, v20, s49
    v_min_u32 v18, 2, v1
    v_lshlrev_b32 v18, 4, v18
    v_add_u32 v18, s57, v18
    v_mul_u32_u24 v18, 43, v18
    v_lshrrev_b32 v18, 7, v18
    v_lshlrev_b32 v251, 7, v18
    buffer_load_dwordx4 v11, s[8:11], s87 offen lds
    s_addk_i32 m0, 1024
    s_addk_i32 s87, 7168
    v_mov_b32_e64 v252, 0
    buffer_load_dwordx4 v10, s[8:11], s87 offen lds
    s_addk_i32 m0, 1024
    s_addk_i32 s87, 7168
    buffer_load_dwordx4 v11, s[8:11], s87 offen lds
    v_mov_b32 v212, 0
    v_mov_b32 v213, 0
    v_mov_b32 v214, 0
    v_mov_b32 v215, 0
    v_mov_b32 v216, 0
    v_mov_b32 v217, 0
    v_mov_b32 v218, 0
    v_mov_b32 v219, 0
    s_waitcnt vmcnt(24)
    s_or_b32 s51, s2, s44
    s_cmp_lg_u32 s51, 0
    s_cbranch_scc1 L_noflag
    v_mov_b32_e64 v10, 0
    v_mov_b32 v11, 1
    s_mov_b64 exec, 1
    buffer_store_dword v11, v10, s[40:43], 0 offen sc1
    s_mov_b64 exec, -1
L_noflag:
    s_nop 0
    ds_read_b128 v[16:19], v12 offset:0
    ds_read_b128 v[20:23], v13 offset:0
    ds_read_b128 v[24:27], v14 offset:0
    ds_read_b128 v[28:31], v15 offset:0
    s_waitcnt vmcnt(20)
    s_nop 0
    ds_read_b128 v[32:35], v12 offset:4096
    ds_read_b128 v[36:39], v13 offset:4096
    ds_read_b128 v[40:43], v14 offset:4096
    ds_read_b128 v[44:47], v15 offset:4096
    s_waitcnt lgkmcnt(4)
    v_dot2c_f32_bf16 v212, s54, v16
    v_dot2c_f32_bf16 v216, v16, v16
    v_dot2c_f32_bf16 v213, s54, v17
    v_dot2c_f32_bf16 v217, v17, v17
    v_dot2c_f32_bf16 v214, s54, v18
    v_dot2c_f32_bf16 v218, v18, v18
    v_dot2c_f32_bf16 v215, s54, v19
    v_dot2c_f32_bf16 v219, v19, v19
    v_dot2c_f32_bf16 v212, s54, v20
    v_dot2c_f32_bf16 v216, v20, v20
    v_dot2c_f32_bf16 v213, s54, v21
    v_dot2c_f32_bf16 v217, v21, v21
    v_dot2c_f32_bf16 v214, s54, v22
    v_dot2c_f32_bf16 v218, v22, v22
    v_dot2c_f32_bf16 v215, s54, v23
    v_dot2c_f32_bf16 v219, v23, v23
    v_dot2c_f32_bf16 v212, s54, v24
    v_dot2c_f32_bf16 v216, v24, v24
    v_dot2c_f32_bf16 v213, s54, v25
    v_dot2c_f32_bf16 v217, v25, v25
    v_dot2c_f32_bf16 v214, s54, v26
    v_dot2c_f32_bf16 v218, v26, v26
    v_dot2c_f32_bf16 v215, s54, v27
    v_dot2c_f32_bf16 v219, v27, v27
    v_dot2c_f32_bf16 v212, s54, v28
    v_dot2c_f32_bf16 v216, v28, v28
    v_dot2c_f32_bf16 v213, s54, v29
    v_dot2c_f32_bf16 v217, v29, v29
    v_dot2c_f32_bf16 v214, s54, v30
    v_dot2c_f32_bf16 v218, v30, v30
    v_dot2c_f32_bf16 v215, s54, v31
    v_dot2c_f32_bf16 v219, v31, v31
    s_waitcnt vmcnt(16)
    ds_read_b128 v[48:51], v12 offset:8192
    ds_read_b128 v[52:55], v13 offset:8192
    ds_read_b128 v[56:59], v14 offset:8192
    ds_read_b128 v[60:63], v15 offset:8192
    s_waitcnt lgkmcnt(4)
    v_dot2c_f32_bf16 v212, s54, v32
    v_dot2c_f32_bf16 v216, v32, v32
    v_dot2c_f32_bf16 v213, s54, v33
    v_dot2c_f32_bf16 v217, v33, v33
    v_dot2c_f32_bf16 v214, s54, v34
    v_dot2c_f32_bf16 v218, v34, v34
    v_dot2c_f32_bf16 v215, s54, v35
    v_dot2c_f32_bf16 v219, v35, v35
    v_dot2c_f32_bf16 v212, s54, v36
    v_dot2c_f32_bf16 v216, v36, v36
    v_dot2c_f32_bf16 v213, s54, v37
    v_dot2c_f32_bf16 v217, v37, v37
    v_dot2c_f32_bf16 v214, s54, v38
    v_dot2c_f32_bf16 v218, v38, v38
    v_dot2c_f32_bf16 v215, s54, v39
    v_dot2c_f32_bf16 v219, v39, v39
    v_dot2c_f32_bf16 v212, s54, v40
    v_dot2c_f32_bf16 v216, v40, v40
    v_dot2c_f32_bf16 v213, s54, v41
    v_dot2c_f32_bf16 v217, v41, v41
    v_dot2c_f32_bf16 v214, s54, v42
    v_dot2c_f32_bf16 v218, v42, v42
    v_dot2c_f32_bf16 v215, s54, v43
    v_dot2c_f32_bf16 v219, v43, v43
    v_dot2c_f32_bf16 v212, s54, v44
    v_dot2c_f32_bf16 v216, v44, v44
    v_dot2c_f32_bf16 v213, s54, v45
    v_dot2c_f32_bf16 v217, v45, v45
    v_dot2c_f32_bf16 v214, s54, v46
    v_dot2c_f32_bf16 v218, v46, v46
    v_dot2c_f32_bf16 v215, s54, v47
    v_dot2c_f32_bf16 v219, v47, v47
    s_waitcnt vmcnt(12)
    ds_read_b128 v[64:67], v12 offset:12288
    ds_read_b128 v[68:71], v13 offset:12288
    ds_read_b128 v[72:75], v14 offset:12288
    ds_read_b128 v[76:79], v15 offset:12288
    s_waitcnt lgkmcnt(4)
    v_dot2c_f32_bf16 v212, s54, v48
    v_dot2c_f32_bf16 v216, v48, v48
    v_dot2c_f32_bf16 v213, s54, v49
    v_dot2c_f32_bf16 v217, v49, v49
    v_dot2c_f32_bf16 v214, s54, v50
    v_dot2c_f32_bf16 v218, v50, v50
    v_dot2c_f32_bf16 v215, s54, v51
    v_dot2c_f32_bf16 v219, v51, v51
    v_dot2c_f32_bf16 v212, s54, v52
    v_dot2c_f32_bf16 v216, v52, v52
    v_dot2c_f32_bf16 v213, s54, v53
    v_dot2c_f32_bf16 v217, v53, v53
    v_dot2c_f32_bf16 v214, s54, v54
    v_dot2c_f32_bf16 v218, v54, v54
    v_dot2c_f32_bf16 v215, s54, v55
    v_dot2c_f32_bf16 v219, v55, v55
    v_dot2c_f32_bf16 v212, s54, v56
    v_dot2c_f32_bf16 v216, v56, v56
    v_dot2c_f32_bf16 v213, s54, v57
    v_dot2c_f32_bf16 v217, v57, v57
    v_dot2c_f32_bf16 v214, s54, v58
    v_dot2c_f32_bf16 v218, v58, v58
    v_dot2c_f32_bf16 v215, s54, v59
    v_dot2c_f32_bf16 v219, v59, v59
    v_dot2c_f32_bf16 v212, s54, v60
    v_dot2c_f32_bf16 v216, v60, v60
    v_dot2c_f32_bf16 v213, s54, v61
    v_dot2c_f32_bf16 v217, v61, v61
    v_dot2c_f32_bf16 v214, s54, v62
    v_dot2c_f32_bf16 v218, v62, v62
    v_dot2c_f32_bf16 v215, s54, v63
    v_dot2c_f32_bf16 v219, v63, v63
    s_waitcnt vmcnt(8)
    ds_read_b128 v[80:83], v12 offset:16384
    ds_read_b128 v[84:87], v13 offset:16384
    ds_read_b128 v[88:91], v14 offset:16384
    ds_read_b128 v[92:95], v15 offset:16384
    s_waitcnt lgkmcnt(4)
    v_dot2c_f32_bf16 v212, s54, v64
    v_dot2c_f32_bf16 v216, v64, v64
    v_dot2c_f32_bf16 v213, s54, v65
    v_dot2c_f32_bf16 v217, v65, v65
    v_dot2c_f32_bf16 v214, s54, v66
    v_dot2c_f32_bf16 v218, v66, v66
    v_dot2c_f32_bf16 v215, s54, v67
    v_dot2c_f32_bf16 v219, v67, v67
    s_lshl_b32 s51, s44, 10
    s_add_u32 m0, s51, 114688
    s_mul_i32 s49, s80, 172032
    buffer_load_dwordx4 v7, s[12:15], s49 offen lds
    v_dot2c_f32_bf16 v212, s54, v68
    v_dot2c_f32_bf16 v216, v68, v68
    v_dot2c_f32_bf16 v213, s54, v69
    v_dot2c_f32_bf16 v217, v69, v69
    v_dot2c_f32_bf16 v214, s54, v70
    v_dot2c_f32_bf16 v218, v70, v70
    v_dot2c_f32_bf16 v215, s54, v71
    v_dot2c_f32_bf16 v219, v71, v71
    s_lshl_b32 s51, s44, 10
    s_nop 0
    s_add_u32 m0, s51, 118784
    s_mul_i32 s49, s80, 172032
    s_add_u32 s49, s49, 56
    s_nop 0
    buffer_load_dwordx4 v7, s[12:15], s49 offen lds
    v_dot2c_f32_bf16 v212, s54, v72
    v_dot2c_f32_bf16 v216, v72, v72
    v_dot2c_f32_bf16 v213, s54, v73
    v_dot2c_f32_bf16 v217, v73, v73
    v_dot2c_f32_bf16 v214, s54, v74
    v_dot2c_f32_bf16 v218, v74, v74
    v_dot2c_f32_bf16 v215, s54, v75
    v_dot2c_f32_bf16 v219, v75, v75
    s_lshl_b32 s51, s44, 10
    s_nop 0
    s_add_u32 m0, s51, 122880
    s_mul_i32 s49, s80, 172032
    s_add_u32 s49, s49, 112
    buffer_load_dwordx4 v7, s[12:15], s49 offen lds
    v_dot2c_f32_bf16 v212, s54, v76
    v_dot2c_f32_bf16 v216, v76, v76
    v_dot2c_f32_bf16 v213, s54, v77
    v_dot2c_f32_bf16 v217, v77, v77
    v_dot2c_f32_bf16 v214, s54, v78
    v_dot2c_f32_bf16 v218, v78, v78
    v_dot2c_f32_bf16 v215, s54, v79
    v_dot2c_f32_bf16 v219, v79, v79
    s_lshl_b32 s51, s44, 10
    s_nop 0
    s_add_u32 m0, s51, 126976
    s_mul_i32 s49, s81, 172032
    buffer_load_dwordx4 v7, s[12:15], s49 offen lds
    s_waitcnt vmcnt(8)
    s_nop 0
    ds_read_b128 v[96:99], v12 offset:20480
    ds_read_b128 v[100:103], v13 offset:20480
    ds_read_b128 v[104:107], v14 offset:20480
    ds_read_b128 v[108:111], v15 offset:20480
    s_waitcnt lgkmcnt(4)
    v_dot2c_f32_bf16 v212, s54, v80
    v_dot2c_f32_bf16 v216, v80, v80
    v_dot2c_f32_bf16 v213, s54, v81
    v_dot2c_f32_bf16 v217, v81, v81
    v_dot2c_f32_bf16 v214, s54, v82
    v_dot2c_f32_bf16 v218, v82, v82
    v_dot2c_f32_bf16 v215, s54, v83
    v_dot2c_f32_bf16 v219, v83, v83
    s_lshl_b32 s51, s44, 10
    s_add_u32 m0, s51, 131072
    s_mul_i32 s49, s81, 172032
    s_add_u32 s49, s49, 56
    s_nop 0
    buffer_load_dwordx4 v7, s[12:15], s49 offen lds
    v_dot2c_f32_bf16 v212, s54, v84
    v_dot2c_f32_bf16 v216, v84, v84
    v_dot2c_f32_bf16 v213, s54, v85
    v_dot2c_f32_bf16 v217, v85, v85
    v_dot2c_f32_bf16 v214, s54, v86
    v_dot2c_f32_bf16 v218, v86, v86
    v_dot2c_f32_bf16 v215, s54, v87
    v_dot2c_f32_bf16 v219, v87, v87
    s_lshl_b32 s51, s44, 10
    s_nop 0
    s_add_u32 m0, s51, 135168
    s_mul_i32 s49, s81, 172032
    s_add_u32 s49, s49, 112
    buffer_load_dwordx4 v7, s[12:15], s49 offen lds
    v_dot2c_f32_bf16 v212, s54, v88
    v_dot2c_f32_bf16 v216, v88, v88
    v_dot2c_f32_bf16 v213, s54, v89
    v_dot2c_f32_bf16 v217, v89, v89
    v_dot2c_f32_bf16 v214, s54, v90
    v_dot2c_f32_bf16 v218, v90, v90
    v_dot2c_f32_bf16 v215, s54, v91
    v_dot2c_f32_bf16 v219, v91, v91
    s_lshl_b32 s51, s44, 10
    s_nop 0
    s_add_u32 m0, s51, 139264
    s_mul_i32 s49, s82, 172032
    buffer_load_dwordx4 v7, s[12:15], s49 offen lds
    v_dot2c_f32_bf16 v212, s54, v92
    v_dot2c_f32_bf16 v216, v92, v92
    v_dot2c_f32_bf16 v213, s54, v93
    v_dot2c_f32_bf16 v217, v93, v93
    v_dot2c_f32_bf16 v214, s54, v94
    v_dot2c_f32_bf16 v218, v94, v94
    v_dot2c_f32_bf16 v215, s54, v95
    v_dot2c_f32_bf16 v219, v95, v95
    s_lshl_b32 s51, s44, 10
    s_nop 0
    s_add_u32 m0, s51, 143360
    s_mul_i32 s49, s82, 172032
    s_add_u32 s49, s49, 56
    s_nop 0
    buffer_load_dwordx4 v7, s[12:15], s49 offen lds
    s_waitcnt vmcnt(8)
    s_nop 0
    ds_read_b128 v[112:115], v12 offset:24576
    ds_read_b128 v[116:119], v13 offset:24576
    ds_read_b128 v[120:123], v14 offset:24576
    ds_read_b128 v[124:127], v15 offset:24576
    s_waitcnt lgkmcnt(4)
    v_dot2c_f32_bf16 v212, s54, v96
    v_dot2c_f32_bf16 v216, v96, v96
    v_dot2c_f32_bf16 v213, s54, v97
    v_dot2c_f32_bf16 v217, v97, v97
    v_dot2c_f32_bf16 v214, s54, v98
    v_dot2c_f32_bf16 v218, v98, v98
    v_dot2c_f32_bf16 v215, s54, v99
    v_dot2c_f32_bf16 v219, v99, v99
    s_lshl_b32 s51, s44, 10
    s_add_u32 m0, s51, 147456
    s_mul_i32 s49, s82, 172032
    s_add_u32 s49, s49, 112
    buffer_load_dwordx4 v7, s[12:15], s49 offen lds
    v_dot2c_f32_bf16 v212, s54, v100
    v_dot2c_f32_bf16 v216, v100, v100
    v_dot2c_f32_bf16 v213, s54, v101
    v_dot2c_f32_bf16 v217, v101, v101
    v_dot2c_f32_bf16 v214, s54, v102
    v_dot2c_f32_bf16 v218, v102, v102
    v_dot2c_f32_bf16 v215, s54, v103
    v_dot2c_f32_bf16 v219, v103, v103
    s_lshl_b32 s51, s44, 10
    s_nop 0
    s_add_u32 m0, s51, 151552
    s_mul_i32 s49, s83, 172032
    buffer_load_dwordx4 v7, s[12:15], s49 offen lds
    v_dot2c_f32_bf16 v212, s54, v104
    v_dot2c_f32_bf16 v216, v104, v104
    v_dot2c_f32_bf16 v213, s54, v105
    v_dot2c_f32_bf16 v217, v105, v105
    v_dot2c_f32_bf16 v214, s54, v106
    v_dot2c_f32_bf16 v218, v106, v106
    v_dot2c_f32_bf16 v215, s54, v107
    v_dot2c_f32_bf16 v219, v107, v107
    s_lshl_b32 s51, s44, 10
    s_nop 0
    s_add_u32 m0, s51, 155648
    s_mul_i32 s49, s83, 172032
    s_add_u32 s49, s49, 56
    s_nop 0
    buffer_load_dwordx4 v7, s[12:15], s49 offen lds
    v_dot2c_f32_bf16 v212, s54, v108
    v_dot2c_f32_bf16 v216, v108, v108
    v_dot2c_f32_bf16 v213, s54, v109
    v_dot2c_f32_bf16 v217, v109, v109
    v_dot2c_f32_bf16 v214, s54, v110
    v_dot2c_f32_bf16 v218, v110, v110
    v_dot2c_f32_bf16 v215, s54, v111
    v_dot2c_f32_bf16 v219, v111, v111
    s_lshl_b32 s51, s44, 10
    s_nop 0
    s_add_u32 m0, s51, 159744
    s_mul_i32 s49, s83, 172032
    s_add_u32 s49, s49, 112
    buffer_load_dwordx4 v7, s[12:15], s49 offen lds
    s_waitcnt lgkmcnt(0)
    v_dot2c_f32_bf16 v212, s54, v112
    v_dot2c_f32_bf16 v216, v112, v112
    v_dot2c_f32_bf16 v213, s54, v113
    v_dot2c_f32_bf16 v217, v113, v113
    v_dot2c_f32_bf16 v214, s54, v114
    v_dot2c_f32_bf16 v218, v114, v114
    v_dot2c_f32_bf16 v215, s54, v115
    v_dot2c_f32_bf16 v219, v115, v115
    v_dot2c_f32_bf16 v212, s54, v116
    v_dot2c_f32_bf16 v216, v116, v116
    v_dot2c_f32_bf16 v213, s54, v117
    v_dot2c_f32_bf16 v217, v117, v117
    v_dot2c_f32_bf16 v214, s54, v118
    v_dot2c_f32_bf16 v218, v118, v118
    v_dot2c_f32_bf16 v215, s54, v119
    v_dot2c_f32_bf16 v219, v119, v119
    v_dot2c_f32_bf16 v212, s54, v120
    v_dot2c_f32_bf16 v216, v120, v120
    v_dot2c_f32_bf16 v213, s54, v121
    v_dot2c_f32_bf16 v217, v121, v121
    v_dot2c_f32_bf16 v214, s54, v122
    v_dot2c_f32_bf16 v218, v122, v122
    v_dot2c_f32_bf16 v215, s54, v123
    v_dot2c_f32_bf16 v219, v123, v123
    v_dot2c_f32_bf16 v212, s54, v124
    v_dot2c_f32_bf16 v216, v124, v124
    v_dot2c_f32_bf16 v213, s54, v125
    v_dot2c_f32_bf16 v217, v125, v125
    v_dot2c_f32_bf16 v214, s54, v126
    v_dot2c_f32_bf16 v218, v126, v126
    v_dot2c_f32_bf16 v215, s54, v127
    v_dot2c_f32_bf16 v219, v127, v127
    s_barrier
    s_nop 2
    v_add_f32 v212, v212, v213
    v_add_f32 v214, v214, v215
    v_add_f32 v216, v216, v217
    v_add_f32 v218, v218, v219
    v_add_f32 v212, v212, v214
    v_add_f32 v216, v216, v218
    v_mov_b32 v213, v212
    v_mov_b32 v217, v216
    s_lshl_b32 s51, s44, 10
    s_add_u32 m0, s51, 67584
    s_mul_i32 s49, s84, 172032
    buffer_load_dwordx4 v7, s[12:15], s49 offen lds
    v_permlane32_swap_b32 v212, v213
    v_permlane32_swap_b32 v216, v217
    v_add_f32 v212, v212, v213
    v_add_f32 v216, v216, v217
    v_mul_f32 v212, 0x3b124925, v212
    v_mul_f32 v216, 0x3b124925, v216
    v_fma_f32 v216, -v212, v212, v216
    v_max_f32_e64 v216, 0, v216
    v_add_f32 v216, 0x3727c5ac, v216
    v_rsq_f32 v228, v216
    s_lshl_b32 s51, s44, 10
    s_add_u32 m0, s51, 71680
    s_mul_i32 s49, s84, 172032
    s_add_u32 s49, s49, 56
    s_nop 0
    buffer_load_dwordx4 v7, s[12:15], s49 offen lds
    v_mov_b32_e64 v232, v228
    v_cvt_pk_bf16_f32 v228, v228, 0
    v_lshlrev_b32 v229, 16, v228
    v_rcp_f32 v233, v229
    v_mul_f32 v230, v212, v229
    v_mul_f32 v232, v232, v233
    v_mul_f32_e64 v234, s56, v232
    v_sub_f32 v230, 0, v230
    s_lshl_b32 s51, s44, 10
    s_add_u32 m0, s51, 75776
    s_mul_i32 s49, s84, 172032
    s_add_u32 s49, s49, 112
    buffer_load_dwordx4 v7, s[12:15], s49 offen lds
    v_dot2_f32_bf16 v212, v16, v228, v230
    v_dot2_f32_bf16 v213, v16, v229, v230
    v_dot2_f32_bf16 v214, v17, v228, v230
    v_dot2_f32_bf16 v215, v17, v229, v230
    v_dot2_f32_bf16 v216, v18, v228, v230
    v_dot2_f32_bf16 v217, v18, v229, v230
    v_dot2_f32_bf16 v218, v19, v228, v230
    v_dot2_f32_bf16 v219, v19, v229, v230
    v_cvt_pk_bf16_f32 v16, v212, v213
    v_cvt_pk_bf16_f32 v17, v214, v215
    v_cvt_pk_bf16_f32 v18, v216, v217
    v_cvt_pk_bf16_f32 v19, v218, v219
    v_dot2_f32_bf16 v220, v20, v228, v230
    v_dot2_f32_bf16 v221, v20, v229, v230
    v_dot2_f32_bf16 v222, v21, v228, v230
    v_dot2_f32_bf16 v223, v21, v229, v230
    v_dot2_f32_bf16 v224, v22, v228, v230
    v_dot2_f32_bf16 v225, v22, v229, v230
    v_dot2_f32_bf16 v226, v23, v228, v230
    v_dot2_f32_bf16 v227, v23, v229, v230
    v_cvt_pk_bf16_f32 v20, v220, v221
    v_cvt_pk_bf16_f32 v21, v222, v223
    v_cvt_pk_bf16_f32 v22, v224, v225
    v_cvt_pk_bf16_f32 v23, v226, v227
    s_lshl_b32 s51, s44, 10
    s_nop 0
    s_add_u32 m0, s51, 79872
    s_mul_i32 s49, s85, 172032
    buffer_load_dwordx4 v7, s[12:15], s49 offen lds
    v_dot2_f32_bf16 v212, v24, v228, v230
    v_dot2_f32_bf16 v213, v24, v229, v230
    v_dot2_f32_bf16 v214, v25, v228, v230
    v_dot2_f32_bf16 v215, v25, v229, v230
    v_dot2_f32_bf16 v216, v26, v228, v230
    v_dot2_f32_bf16 v217, v26, v229, v230
    v_dot2_f32_bf16 v218, v27, v228, v230
    v_dot2_f32_bf16 v219, v27, v229, v230
    v_cvt_pk_bf16_f32 v24, v212, v213
    v_cvt_pk_bf16_f32 v25, v214, v215
    v_cvt_pk_bf16_f32 v26, v216, v217
    v_cvt_pk_bf16_f32 v27, v218, v219
    v_dot2_f32_bf16 v220, v28, v228, v230
    v_dot2_f32_bf16 v221, v28, v229, v230
    v_dot2_f32_bf16 v222, v29, v228, v230
    v_dot2_f32_bf16 v223, v29, v229, v230
    v_dot2_f32_bf16 v224, v30, v228, v230
    v_dot2_f32_bf16 v225, v30, v229, v230
    v_dot2_f32_bf16 v226, v31, v228, v230
    v_dot2_f32_bf16 v227, v31, v229, v230
    v_cvt_pk_bf16_f32 v28, v220, v221
    v_cvt_pk_bf16_f32 v29, v222, v223
    v_cvt_pk_bf16_f32 v30, v224, v225
    v_cvt_pk_bf16_f32 v31, v226, v227
    s_lshl_b32 s51, s44, 10
    s_nop 0
    s_add_u32 m0, s51, 83968
    s_mul_i32 s49, s85, 172032
    s_add_u32 s49, s49, 56
    s_nop 0
    buffer_load_dwordx4 v7, s[12:15], s49 offen lds
    v_dot2_f32_bf16 v212, v32, v228, v230
    v_dot2_f32_bf16 v213, v32, v229, v230
    v_dot2_f32_bf16 v214, v33, v228, v230
    v_dot2_f32_bf16 v215, v33, v229, v230
    v_dot2_f32_bf16 v216, v34, v228, v230
    v_dot2_f32_bf16 v217, v34, v229, v230
    v_dot2_f32_bf16 v218, v35, v228, v230
    v_dot2_f32_bf16 v219, v35, v229, v230
    v_cvt_pk_bf16_f32 v32, v212, v213
    v_cvt_pk_bf16_f32 v33, v214, v215
    v_cvt_pk_bf16_f32 v34, v216, v217
    v_cvt_pk_bf16_f32 v35, v218, v219
    v_dot2_f32_bf16 v220, v36, v228, v230
    v_dot2_f32_bf16 v221, v36, v229, v230
    v_dot2_f32_bf16 v222, v37, v228, v230
    v_dot2_f32_bf16 v223, v37, v229, v230
    v_dot2_f32_bf16 v224, v38, v228, v230
    v_dot2_f32_bf16 v225, v38, v229, v230
    v_dot2_f32_bf16 v226, v39, v228, v230
    v_dot2_f32_bf16 v227, v39, v229, v230
    v_cvt_pk_bf16_f32 v36, v220, v221
    v_cvt_pk_bf16_f32 v37, v222, v223
    v_cvt_pk_bf16_f32 v38, v224, v225
    v_cvt_pk_bf16_f32 v39, v226, v227
    s_lshl_b32 s51, s44, 10
    s_nop 0
    s_add_u32 m0, s51, 88064
    s_mul_i32 s49, s85, 172032
    s_add_u32 s49, s49, 112
    buffer_load_dwordx4 v7, s[12:15], s49 offen lds
    v_dot2_f32_bf16 v212, v40, v228, v230
    v_dot2_f32_bf16 v213, v40, v229, v230
    v_dot2_f32_bf16 v214, v41, v228, v230
    v_dot2_f32_bf16 v215, v41, v229, v230
    v_dot2_f32_bf16 v216, v42, v228, v230
    v_dot2_f32_bf16 v217, v42, v229, v230
    v_dot2_f32_bf16 v218, v43, v228, v230
    v_dot2_f32_bf16 v219, v43, v229, v230
    v_cvt_pk_bf16_f32 v40, v212, v213
    v_cvt_pk_bf16_f32 v41, v214, v215
    v_cvt_pk_bf16_f32 v42, v216, v217
    v_cvt_pk_bf16_f32 v43, v218, v219
    v_dot2_f32_bf16 v220, v44, v228, v230
    v_dot2_f32_bf16 v221, v44, v229, v230
    v_dot2_f32_bf16 v222, v45, v228, v230
    v_dot2_f32_bf16 v223, v45, v229, v230
    v_dot2_f32_bf16 v224, v46, v228, v230
    v_dot2_f32_bf16 v225, v46, v229, v230
    v_dot2_f32_bf16 v226, v47, v228, v230
    v_dot2_f32_bf16 v227, v47, v229, v230
    v_cvt_pk_bf16_f32 v44, v220, v221
    v_cvt_pk_bf16_f32 v45, v222, v223
    v_cvt_pk_bf16_f32 v46, v224, v225
    v_cvt_pk_bf16_f32 v47, v226, v227
    s_lshl_b32 s51, s44, 10
    s_nop 0
    s_add_u32 m0, s51, 92160
    s_mul_i32 s49, s86, 172032
    buffer_load_dwordx4 v7, s[12:15], s49 offen lds
    v_dot2_f32_bf16 v212, v48, v228, v230
    v_dot2_f32_bf16 v213, v48, v229, v230
    v_dot2_f32_bf16 v214, v49, v228, v230
    v_dot2_f32_bf16 v215, v49, v229, v230
    v_dot2_f32_bf16 v216, v50, v228, v230
    v_dot2_f32_bf16 v217, v50, v229, v230
    v_dot2_f32_bf16 v218, v51, v228, v230
    v_dot2_f32_bf16 v219, v51, v229, v230
    v_cvt_pk_bf16_f32 v48, v212, v213
    v_cvt_pk_bf16_f32 v49, v214, v215
    v_cvt_pk_bf16_f32 v50, v216, v217
    v_cvt_pk_bf16_f32 v51, v218, v219
    v_dot2_f32_bf16 v220, v52, v228, v230
    v_dot2_f32_bf16 v221, v52, v229, v230
    v_dot2_f32_bf16 v222, v53, v228, v230
    v_dot2_f32_bf16 v223, v53, v229, v230
    v_dot2_f32_bf16 v224, v54, v228, v230
    v_dot2_f32_bf16 v225, v54, v229, v230
    v_dot2_f32_bf16 v226, v55, v228, v230
    v_dot2_f32_bf16 v227, v55, v229, v230
    v_cvt_pk_bf16_f32 v52, v220, v221
    v_cvt_pk_bf16_f32 v53, v222, v223
    v_cvt_pk_bf16_f32 v54, v224, v225
    v_cvt_pk_bf16_f32 v55, v226, v227
    s_lshl_b32 s51, s44, 10
    s_nop 0
    s_add_u32 m0, s51, 96256
    s_mul_i32 s49, s86, 172032
    s_add_u32 s49, s49, 56
    s_nop 0
    buffer_load_dwordx4 v7, s[12:15], s49 offen lds
    v_dot2_f32_bf16 v212, v56, v228, v230
    v_dot2_f32_bf16 v213, v56, v229, v230
    v_dot2_f32_bf16 v214, v57, v228, v230
    v_dot2_f32_bf16 v215, v57, v229, v230
    v_dot2_f32_bf16 v216, v58, v228, v230
    v_dot2_f32_bf16 v217, v58, v229, v230
    v_dot2_f32_bf16 v218, v59, v228, v230
    v_dot2_f32_bf16 v219, v59, v229, v230
    v_cvt_pk_bf16_f32 v56, v212, v213
    v_cvt_pk_bf16_f32 v57, v214, v215
    v_cvt_pk_bf16_f32 v58, v216, v217
    v_cvt_pk_bf16_f32 v59, v218, v219
    v_dot2_f32_bf16 v220, v60, v228, v230
    v_dot2_f32_bf16 v221, v60, v229, v230
    v_dot2_f32_bf16 v222, v61, v228, v230
    v_dot2_f32_bf16 v223, v61, v229, v230
    v_dot2_f32_bf16 v224, v62, v228, v230
    v_dot2_f32_bf16 v225, v62, v229, v230
    v_dot2_f32_bf16 v226, v63, v228, v230
    v_dot2_f32_bf16 v227, v63, v229, v230
    v_cvt_pk_bf16_f32 v60, v220, v221
    v_cvt_pk_bf16_f32 v61, v222, v223
    v_cvt_pk_bf16_f32 v62, v224, v225
    v_cvt_pk_bf16_f32 v63, v226, v227
    s_lshl_b32 s51, s44, 10
    s_nop 0
    s_add_u32 m0, s51, 100352
    s_mul_i32 s49, s86, 172032
    s_add_u32 s49, s49, 112
    buffer_load_dwordx4 v7, s[12:15], s49 offen lds
    v_dot2_f32_bf16 v212, v64, v228, v230
    v_dot2_f32_bf16 v213, v64, v229, v230
    v_dot2_f32_bf16 v214, v65, v228, v230
    v_dot2_f32_bf16 v215, v65, v229, v230
    v_dot2_f32_bf16 v216, v66, v228, v230
    v_dot2_f32_bf16 v217, v66, v229, v230
    v_dot2_f32_bf16 v218, v67, v228, v230
    v_dot2_f32_bf16 v219, v67, v229, v230
    v_cvt_pk_bf16_f32 v64, v212, v213
    v_cvt_pk_bf16_f32 v65, v214, v215
    v_cvt_pk_bf16_f32 v66, v216, v217
    v_cvt_pk_bf16_f32 v67, v218, v219
    v_dot2_f32_bf16 v220, v68, v228, v230
    v_dot2_f32_bf16 v221, v68, v229, v230
    v_dot2_f32_bf16 v222, v69, v228, v230
    v_dot2_f32_bf16 v223, v69, v229, v230
    v_dot2_f32_bf16 v224, v70, v228, v230
    v_dot2_f32_bf16 v225, v70, v229, v230
    v_dot2_f32_bf16 v226, v71, v228, v230
    v_dot2_f32_bf16 v227, v71, v229, v230
    v_cvt_pk_bf16_f32 v68, v220, v221
    v_cvt_pk_bf16_f32 v69, v222, v223
    v_cvt_pk_bf16_f32 v70, v224, v225
    v_cvt_pk_bf16_f32 v71, v226, v227
    s_lshl_b32 s51, s44, 10
    s_add_u32 m0, s51, 0
    s_mul_i32 s49, s80, 229376
    s_add_u32 s49, s49, s97
    s_nop 0
    buffer_load_dwordx4 v8, s[16:19], s49 offen lds
    v_dot2_f32_bf16 v212, v72, v228, v230
    v_dot2_f32_bf16 v213, v72, v229, v230
    v_dot2_f32_bf16 v214, v73, v228, v230
    v_dot2_f32_bf16 v215, v73, v229, v230
    v_dot2_f32_bf16 v216, v74, v228, v230
    v_dot2_f32_bf16 v217, v74, v229, v230
    v_dot2_f32_bf16 v218, v75, v228, v230
    v_dot2_f32_bf16 v219, v75, v229, v230
    v_cvt_pk_bf16_f32 v72, v212, v213
    v_cvt_pk_bf16_f32 v73, v214, v215
    v_cvt_pk_bf16_f32 v74, v216, v217
    v_cvt_pk_bf16_f32 v75, v218, v219
    v_dot2_f32_bf16 v220, v76, v228, v230
    v_dot2_f32_bf16 v221, v76, v229, v230
    v_dot2_f32_bf16 v222, v77, v228, v230
    v_dot2_f32_bf16 v223, v77, v229, v230
    v_dot2_f32_bf16 v224, v78, v228, v230
    v_dot2_f32_bf16 v225, v78, v229, v230
    v_dot2_f32_bf16 v226, v79, v228, v230
    v_dot2_f32_bf16 v227, v79, v229, v230
    v_cvt_pk_bf16_f32 v76, v220, v221
    v_cvt_pk_bf16_f32 v77, v222, v223
    v_cvt_pk_bf16_f32 v78, v224, v225
    v_cvt_pk_bf16_f32 v79, v226, v227
    s_lshl_b32 s51, s44, 10
    s_nop 0
    s_add_u32 m0, s51, 4096
    s_mul_i32 s49, s80, 229376
    s_add_u32 s49, s49, s97
    s_nop 0
    s_add_u32 s49, s49, 114688
    buffer_load_dwordx4 v8, s[16:19], s49 offen lds
    v_dot2_f32_bf16 v212, v80, v228, v230
    v_dot2_f32_bf16 v213, v80, v229, v230
    v_dot2_f32_bf16 v214, v81, v228, v230
    v_dot2_f32_bf16 v215, v81, v229, v230
    v_dot2_f32_bf16 v216, v82, v228, v230
    v_dot2_f32_bf16 v217, v82, v229, v230
    v_dot2_f32_bf16 v218, v83, v228, v230
    v_dot2_f32_bf16 v219, v83, v229, v230
    v_cvt_pk_bf16_f32 v80, v212, v213
    v_cvt_pk_bf16_f32 v81, v214, v215
    v_cvt_pk_bf16_f32 v82, v216, v217
    v_cvt_pk_bf16_f32 v83, v218, v219
    v_dot2_f32_bf16 v220, v84, v228, v230
    v_dot2_f32_bf16 v221, v84, v229, v230
    v_dot2_f32_bf16 v222, v85, v228, v230
    v_dot2_f32_bf16 v223, v85, v229, v230
    v_dot2_f32_bf16 v224, v86, v228, v230
    v_dot2_f32_bf16 v225, v86, v229, v230
    v_dot2_f32_bf16 v226, v87, v228, v230
    v_dot2_f32_bf16 v227, v87, v229, v230
    v_cvt_pk_bf16_f32 v84, v220, v221
    v_cvt_pk_bf16_f32 v85, v222, v223
    v_cvt_pk_bf16_f32 v86, v224, v225
    v_cvt_pk_bf16_f32 v87, v226, v227
    s_lshl_b32 s51, s44, 10
    s_nop 0
    s_add_u32 m0, s51, 8192
    s_mul_i32 s49, s81, 229376
    s_add_u32 s49, s49, s97
    s_nop 0
    buffer_load_dwordx4 v8, s[16:19], s49 offen lds
    v_dot2_f32_bf16 v212, v88, v228, v230
    v_dot2_f32_bf16 v213, v88, v229, v230
    v_dot2_f32_bf16 v214, v89, v228, v230
    v_dot2_f32_bf16 v215, v89, v229, v230
    v_dot2_f32_bf16 v216, v90, v228, v230
    v_dot2_f32_bf16 v217, v90, v229, v230
    v_dot2_f32_bf16 v218, v91, v228, v230
    v_dot2_f32_bf16 v219, v91, v229, v230
    v_cvt_pk_bf16_f32 v88, v212, v213
    v_cvt_pk_bf16_f32 v89, v214, v215
    v_cvt_pk_bf16_f32 v90, v216, v217
    v_cvt_pk_bf16_f32 v91, v218, v219
    v_dot2_f32_bf16 v220, v92, v228, v230
    v_dot2_f32_bf16 v221, v92, v229, v230
    v_dot2_f32_bf16 v222, v93, v228, v230
    v_dot2_f32_bf16 v223, v93, v229, v230
    v_dot2_f32_bf16 v224, v94, v228, v230
    v_dot2_f32_bf16 v225, v94, v229, v230
    v_dot2_f32_bf16 v226, v95, v228, v230
    v_dot2_f32_bf16 v227, v95, v229, v230
    v_cvt_pk_bf16_f32 v92, v220, v221
    v_cvt_pk_bf16_f32 v93, v222, v223
    v_cvt_pk_bf16_f32 v94, v224, v225
    v_cvt_pk_bf16_f32 v95, v226, v227
    s_lshl_b32 s51, s44, 10
    s_nop 0
    s_add_u32 m0, s51, 12288
    s_mul_i32 s49, s81, 229376
    s_add_u32 s49, s49, s97
    s_nop 0
    s_add_u32 s49, s49, 114688
    buffer_load_dwordx4 v8, s[16:19], s49 offen lds
    v_dot2_f32_bf16 v212, v96, v228, v230
    v_dot2_f32_bf16 v213, v96, v229, v230
    v_dot2_f32_bf16 v214, v97, v228, v230
    v_dot2_f32_bf16 v215, v97, v229, v230
    v_dot2_f32_bf16 v216, v98, v228, v230
    v_dot2_f32_bf16 v217, v98, v229, v230
    v_dot2_f32_bf16 v218, v99, v228, v230
    v_dot2_f32_bf16 v219, v99, v229, v230
    v_cvt_pk_bf16_f32 v96, v212, v213
    v_cvt_pk_bf16_f32 v97, v214, v215
    v_cvt_pk_bf16_f32 v98, v216, v217
    v_cvt_pk_bf16_f32 v99, v218, v219
    v_dot2_f32_bf16 v220, v100, v228, v230
    v_dot2_f32_bf16 v221, v100, v229, v230
    v_dot2_f32_bf16 v222, v101, v228, v230
    v_dot2_f32_bf16 v223, v101, v229, v230
    v_dot2_f32_bf16 v224, v102, v228, v230
    v_dot2_f32_bf16 v225, v102, v229, v230
    v_dot2_f32_bf16 v226, v103, v228, v230
    v_dot2_f32_bf16 v227, v103, v229, v230
    v_cvt_pk_bf16_f32 v100, v220, v221
    v_cvt_pk_bf16_f32 v101, v222, v223
    v_cvt_pk_bf16_f32 v102, v224, v225
    v_cvt_pk_bf16_f32 v103, v226, v227
    s_lshl_b32 s51, s44, 10
    s_nop 0
    s_add_u32 m0, s51, 16384
    s_mul_i32 s49, s82, 229376
    s_add_u32 s49, s49, s97
    s_nop 0
    buffer_load_dwordx4 v8, s[16:19], s49 offen lds
    v_dot2_f32_bf16 v212, v104, v228, v230
    v_dot2_f32_bf16 v213, v104, v229, v230
    v_dot2_f32_bf16 v214, v105, v228, v230
    v_dot2_f32_bf16 v215, v105, v229, v230
    v_dot2_f32_bf16 v216, v106, v228, v230
    v_dot2_f32_bf16 v217, v106, v229, v230
    v_dot2_f32_bf16 v218, v107, v228, v230
    v_dot2_f32_bf16 v219, v107, v229, v230
    v_cvt_pk_bf16_f32 v104, v212, v213
    v_cvt_pk_bf16_f32 v105, v214, v215
    v_cvt_pk_bf16_f32 v106, v216, v217
    v_cvt_pk_bf16_f32 v107, v218, v219
    v_dot2_f32_bf16 v220, v108, v228, v230
    v_dot2_f32_bf16 v221, v108, v229, v230
    v_dot2_f32_bf16 v222, v109, v228, v230
    v_dot2_f32_bf16 v223, v109, v229, v230
    v_dot2_f32_bf16 v224, v110, v228, v230
    v_dot2_f32_bf16 v225, v110, v229, v230
    v_dot2_f32_bf16 v226, v111, v228, v230
    v_dot2_f32_bf16 v227, v111, v229, v230
    v_cvt_pk_bf16_f32 v108, v220, v221
    v_cvt_pk_bf16_f32 v109, v222, v223
    v_cvt_pk_bf16_f32 v110, v224, v225
    v_cvt_pk_bf16_f32 v111, v226, v227
    s_lshl_b32 s51, s44, 10
    s_nop 0
    s_add_u32 m0, s51, 20480
    s_mul_i32 s49, s82, 229376
    s_add_u32 s49, s49, s97
    s_nop 0
    s_add_u32 s49, s49, 114688
    buffer_load_dwordx4 v8, s[16:19], s49 offen lds
    v_dot2_f32_bf16 v212, v112, v228, v230
    v_dot2_f32_bf16 v213, v112, v229, v230
    v_dot2_f32_bf16 v214, v113, v228, v230
    v_dot2_f32_bf16 v215, v113, v229, v230
    v_dot2_f32_bf16 v216, v114, v228, v230
    v_dot2_f32_bf16 v217, v114, v229, v230
    v_dot2_f32_bf16 v218, v115, v228, v230
    v_dot2_f32_bf16 v219, v115, v229, v230
    v_cvt_pk_bf16_f32 v112, v212, v213
    v_cvt_pk_bf16_f32 v113, v214, v215
    v_cvt_pk_bf16_f32 v114, v216, v217
    v_cvt_pk_bf16_f32 v115, v218, v219
    v_dot2_f32_bf16 v220, v116, v228, v230
    v_dot2_f32_bf16 v221, v116, v229, v230
    v_dot2_f32_bf16 v222, v117, v228, v230
    v_dot2_f32_bf16 v223, v117, v229, v230
    v_dot2_f32_bf16 v224, v118, v228, v230
    v_dot2_f32_bf16 v225, v118, v229, v230
    v_dot2_f32_bf16 v226, v119, v228, v230
    v_dot2_f32_bf16 v227, v119, v229, v230
    v_cvt_pk_bf16_f32 v116, v220, v221
    v_cvt_pk_bf16_f32 v117, v222, v223
    v_cvt_pk_bf16_f32 v118, v224, v225
    v_cvt_pk_bf16_f32 v119, v226, v227
    v_dot2_f32_bf16 v212, v120, v228, v230
    v_dot2_f32_bf16 v213, v120, v229, v230
    v_dot2_f32_bf16 v214, v121, v228, v230
    v_dot2_f32_bf16 v215, v121, v229, v230
    v_dot2_f32_bf16 v216, v122, v228, v230
    v_dot2_f32_bf16 v217, v122, v229, v230
    v_dot2_f32_bf16 v218, v123, v228, v230
    v_dot2_f32_bf16 v219, v123, v229, v230
    v_cvt_pk_bf16_f32 v120, v212, v213
    v_cvt_pk_bf16_f32 v121, v214, v215
    v_cvt_pk_bf16_f32 v122, v216, v217
    v_cvt_pk_bf16_f32 v123, v218, v219
    v_dot2_f32_bf16 v220, v124, v228, v230
    v_dot2_f32_bf16 v221, v124, v229, v230
    v_dot2_f32_bf16 v222, v125, v228, v230
    v_dot2_f32_bf16 v223, v125, v229, v230
    v_dot2_f32_bf16 v224, v126, v228, v230
    v_dot2_f32_bf16 v225, v126, v229, v230
    v_dot2_f32_bf16 v226, v127, v228, v230
    v_dot2_f32_bf16 v227, v127, v229, v230
    v_cvt_pk_bf16_f32 v124, v220, v221
    v_cvt_pk_bf16_f32 v125, v222, v223
    v_cvt_pk_bf16_f32 v126, v224, v225
    v_cvt_pk_bf16_f32 v127, v226, v227
    s_cmp_ge_u32 s46, 11
    s_cbranch_scc1 L_gemm_vvv
    s_cmp_eq_u32 s46, 10
    s_cbranch_scc1 L_gemm_kkv
    s_waitcnt vmcnt(15)
    s_barrier
    ds_read_b64_tr_b16 v[176:177], v3 offset:0
    ds_read_b64_tr_b16 v[178:179], v3 offset:256
    ds_read_b64_tr_b16 v[180:181], v3 offset:4096
    ds_read_b64_tr_b16 v[182:183], v3 offset:4352
    ds_read_b64_tr_b16 v[184:185], v3 offset:8192
    ds_read_b64_tr_b16 v[186:187], v3 offset:8448
    ds_read_b64_tr_b16 v[188:189], v3 offset:1024
    ds_read_b64_tr_b16 v[190:191], v3 offset:1280
    ds_read_b64_tr_b16 v[192:193], v3 offset:5120
    ds_read_b64_tr_b16 v[194:195], v3 offset:5376
    ds_read_b64_tr_b16 v[196:197], v3 offset:9216
    ds_read_b64_tr_b16 v[198:199], v3 offset:9472
    s_waitcnt lgkmcnt(6)
    s_nop 0
    v_mfma_f32_32x32x16_bf16 v[128:143], v[176:179], v[16:19], 0
    ds_read_b64_tr_b16 v[200:201], v3 offset:2048
    ds_read_b64_tr_b16 v[202:203], v3 offset:2304
    v_mfma_f32_32x32x16_bf16 v[144:159], v[180:183], v[16:19], 0
    ds_read_b64_tr_b16 v[204:205], v3 offset:6144
    ds_read_b64_tr_b16 v[206:207], v3 offset:6400
    v_mfma_f32_32x32x16_bf16 v[160:175], v[184:187], v[16:19], 0
    ds_read_b64_tr_b16 v[208:209], v3 offset:10240
    ds_read_b64_tr_b16 v[210:211], v3 offset:10496
    s_lshl_b32 s51, s44, 10
    s_nop 0
    s_add_u32 m0, s51, 24576
    s_mul_i32 s49, s83, 229376
    s_add_u32 s49, s49, s97
    s_nop 0
    buffer_load_dwordx4 v8, s[16:19], s49 offen lds
    s_waitcnt lgkmcnt(6)
    s_nop 0
    v_mfma_f32_32x32x16_bf16 v[128:143], v[188:191], v[20:23], v[128:143]
    ds_read_b64_tr_b16 v[176:177], v3 offset:3072
    ds_read_b64_tr_b16 v[178:179], v3 offset:3328
    v_mfma_f32_32x32x16_bf16 v[144:159], v[192:195], v[20:23], v[144:159]
    ds_read_b64_tr_b16 v[180:181], v3 offset:7168
    ds_read_b64_tr_b16 v[182:183], v3 offset:7424
    v_mfma_f32_32x32x16_bf16 v[160:175], v[196:199], v[20:23], v[160:175]
    ds_read_b64_tr_b16 v[184:185], v3 offset:11264
    ds_read_b64_tr_b16 v[186:187], v3 offset:11520
    s_lshl_b32 s51, s44, 10
    s_nop 0
    s_add_u32 m0, s51, 28672
    s_mul_i32 s49, s83, 229376
    s_add_u32 s49, s49, s97
    s_nop 0
    s_add_u32 s49, s49, 114688
    buffer_load_dwordx4 v8, s[16:19], s49 offen lds
    s_waitcnt lgkmcnt(6)
    s_nop 0
    v_mfma_f32_32x32x16_bf16 v[128:143], v[200:203], v[24:27], v[128:143]
    ds_read_b64_tr_b16 v[188:189], v3 offset:12288
    ds_read_b64_tr_b16 v[190:191], v3 offset:12544
    v_mfma_f32_32x32x16_bf16 v[144:159], v[204:207], v[24:27], v[144:159]
    ds_read_b64_tr_b16 v[192:193], v3 offset:16384
    ds_read_b64_tr_b16 v[194:195], v3 offset:16640
    v_mfma_f32_32x32x16_bf16 v[160:175], v[208:211], v[24:27], v[160:175]
    ds_read_b64_tr_b16 v[196:197], v3 offset:20480
    ds_read_b64_tr_b16 v[198:199], v3 offset:20736
    s_lshl_b32 s51, s44, 10
    s_nop 0
    s_add_u32 m0, s51, 32768
    s_mul_i32 s49, s84, 229376
    s_add_u32 s49, s49, s97
    s_nop 0
    buffer_load_dwordx4 v8, s[16:19], s49 offen lds
    s_waitcnt lgkmcnt(6)
    s_nop 0
    v_mfma_f32_32x32x16_bf16 v[128:143], v[176:179], v[28:31], v[128:143]
    ds_read_b64_tr_b16 v[200:201], v3 offset:13312
    ds_read_b64_tr_b16 v[202:203], v3 offset:13568
    v_mfma_f32_32x32x16_bf16 v[144:159], v[180:183], v[28:31], v[144:159]
    ds_read_b64_tr_b16 v[204:205], v3 offset:17408
    ds_read_b64_tr_b16 v[206:207], v3 offset:17664
    v_mfma_f32_32x32x16_bf16 v[160:175], v[184:187], v[28:31], v[160:175]
    ds_read_b64_tr_b16 v[208:209], v3 offset:21504
    ds_read_b64_tr_b16 v[210:211], v3 offset:21760
    s_lshl_b32 s51, s44, 10
    s_nop 0
    s_add_u32 m0, s51, 36864
    s_mul_i32 s49, s84, 229376
    s_add_u32 s49, s49, s97
    s_nop 0
    s_add_u32 s49, s49, 114688
    buffer_load_dwordx4 v8, s[16:19], s49 offen lds
    s_waitcnt lgkmcnt(6)
    s_nop 0
    v_mfma_f32_32x32x16_bf16 v[128:143], v[188:191], v[32:35], v[128:143]
    ds_read_b64_tr_b16 v[176:177], v3 offset:14336
    ds_read_b64_tr_b16 v[178:179], v3 offset:14592
    v_mfma_f32_32x32x16_bf16 v[144:159], v[192:195], v[32:35], v[144:159]
    ds_read_b64_tr_b16 v[180:181], v3 offset:18432
    ds_read_b64_tr_b16 v[182:183], v3 offset:18688
    v_mfma_f32_32x32x16_bf16 v[160:175], v[196:199], v[32:35], v[160:175]
    ds_read_b64_tr_b16 v[184:185], v3 offset:22528
    ds_read_b64_tr_b16 v[186:187], v3 offset:22784
    s_lshl_b32 s51, s44, 10
    s_nop 0
    s_add_u32 m0, s51, 40960
    s_mul_i32 s49, s85, 229376
    s_add_u32 s49, s49, s97
    s_nop 0
    buffer_load_dwordx4 v8, s[16:19], s49 offen lds
    s_waitcnt lgkmcnt(6)
    s_nop 0
    v_mfma_f32_32x32x16_bf16 v[128:143], v[200:203], v[36:39], v[128:143]
    ds_read_b64_tr_b16 v[188:189], v3 offset:15360
    ds_read_b64_tr_b16 v[190:191], v3 offset:15616
    v_mfma_f32_32x32x16_bf16 v[144:159], v[204:207], v[36:39], v[144:159]
    ds_read_b64_tr_b16 v[192:193], v3 offset:19456
    ds_read_b64_tr_b16 v[194:195], v3 offset:19712
    v_mfma_f32_32x32x16_bf16 v[160:175], v[208:211], v[36:39], v[160:175]
    ds_read_b64_tr_b16 v[196:197], v3 offset:23552
    ds_read_b64_tr_b16 v[198:199], v3 offset:23808
    s_lshl_b32 s51, s44, 10
    s_nop 0
    s_add_u32 m0, s51, 45056
    s_mul_i32 s49, s85, 229376
    s_add_u32 s49, s49, s97
    s_nop 0
    s_add_u32 s49, s49, 114688
    buffer_load_dwordx4 v8, s[16:19], s49 offen lds
    s_waitcnt lgkmcnt(6)
    s_nop 0
    v_mfma_f32_32x32x16_bf16 v[128:143], v[176:179], v[40:43], v[128:143]
    ds_read_b64_tr_b16 v[200:201], v3 offset:24576
    ds_read_b64_tr_b16 v[202:203], v3 offset:24832
    v_mfma_f32_32x32x16_bf16 v[144:159], v[180:183], v[40:43], v[144:159]
    ds_read_b64_tr_b16 v[204:205], v3 offset:28672
    ds_read_b64_tr_b16 v[206:207], v3 offset:28928
    v_mfma_f32_32x32x16_bf16 v[160:175], v[184:187], v[40:43], v[160:175]
    ds_read_b64_tr_b16 v[208:209], v3 offset:32768
    ds_read_b64_tr_b16 v[210:211], v3 offset:33024
    s_lshl_b32 s51, s44, 10
    s_nop 0
    s_add_u32 m0, s51, 49152
    s_mul_i32 s49, s86, 229376
    s_add_u32 s49, s49, s97
    s_nop 0
    buffer_load_dwordx4 v8, s[16:19], s49 offen lds
    s_waitcnt lgkmcnt(6)
    s_nop 0
    v_mfma_f32_32x32x16_bf16 v[128:143], v[188:191], v[44:47], v[128:143]
    ds_read_b64_tr_b16 v[176:177], v3 offset:25600
    ds_read_b64_tr_b16 v[178:179], v3 offset:25856
    v_mfma_f32_32x32x16_bf16 v[144:159], v[192:195], v[44:47], v[144:159]
    ds_read_b64_tr_b16 v[180:181], v3 offset:29696
    ds_read_b64_tr_b16 v[182:183], v3 offset:29952
    v_mfma_f32_32x32x16_bf16 v[160:175], v[196:199], v[44:47], v[160:175]
    ds_read_b64_tr_b16 v[184:185], v3 offset:33792
    ds_read_b64_tr_b16 v[186:187], v3 offset:34048
    s_lshl_b32 s51, s44, 10
    s_nop 0
    s_add_u32 m0, s51, 53248
    s_mul_i32 s49, s86, 229376
    s_add_u32 s49, s49, s97
    s_nop 0
    s_add_u32 s49, s49, 114688
    buffer_load_dwordx4 v8, s[16:19], s49 offen lds
    s_waitcnt lgkmcnt(6)
    s_nop 0
    v_mfma_f32_32x32x16_bf16 v[128:143], v[200:203], v[48:51], v[128:143]
    ds_read_b64_tr_b16 v[188:189], v3 offset:26624
    ds_read_b64_tr_b16 v[190:191], v3 offset:26880
    v_mfma_f32_32x32x16_bf16 v[144:159], v[204:207], v[48:51], v[144:159]
    ds_read_b64_tr_b16 v[192:193], v3 offset:30720
    ds_read_b64_tr_b16 v[194:195], v3 offset:30976
    v_mfma_f32_32x32x16_bf16 v[160:175], v[208:211], v[48:51], v[160:175]
    ds_read_b64_tr_b16 v[196:197], v3 offset:34816
    ds_read_b64_tr_b16 v[198:199], v3 offset:35072
    s_waitcnt lgkmcnt(6)
    s_nop 0
    v_mfma_f32_32x32x16_bf16 v[128:143], v[176:179], v[52:55], v[128:143]
    ds_read_b64_tr_b16 v[200:201], v3 offset:27648
    ds_read_b64_tr_b16 v[202:203], v3 offset:27904
    v_mfma_f32_32x32x16_bf16 v[144:159], v[180:183], v[52:55], v[144:159]
    ds_read_b64_tr_b16 v[204:205], v3 offset:31744
    ds_read_b64_tr_b16 v[206:207], v3 offset:32000
    v_mfma_f32_32x32x16_bf16 v[160:175], v[184:187], v[52:55], v[160:175]
    ds_read_b64_tr_b16 v[208:209], v3 offset:35840
    ds_read_b64_tr_b16 v[210:211], v3 offset:36096
    s_cmp_lg_u32 s44, 0
    s_cbranch_scc1 L_nowb_1
    v_lshlrev_b32_e64 v6, 7, v1
    buffer_load_dword a255, v6, s[32:35], 0 offen
L_nowb_1:
    s_waitcnt lgkmcnt(6)
    s_nop 0
    v_mfma_f32_32x32x16_bf16 v[128:143], v[188:191], v[56:59], v[128:143]
    ds_read_b64_tr_b16 v[176:177], v3 offset:36864
    ds_read_b64_tr_b16 v[178:179], v3 offset:37120
    v_mfma_f32_32x32x16_bf16 v[144:159], v[192:195], v[56:59], v[144:159]
    ds_read_b64_tr_b16 v[180:181], v3 offset:40960
    ds_read_b64_tr_b16 v[182:183], v3 offset:41216
    v_mfma_f32_32x32x16_bf16 v[160:175], v[196:199], v[56:59], v[160:175]
    ds_read_b64_tr_b16 v[184:185], v3 offset:45056
    ds_read_b64_tr_b16 v[186:187], v3 offset:45312
    v_and_b32 v11, 31, v0
    v_lshlrev_b32 v11, 1, v11
    v_mov_b32 v244, 0
    v_mov_b32 v245, 0
    v_mov_b32_e64 v246, 0
    v_mov_b32 v247, 0
    s_mov_b32 exec_hi, 0
    buffer_load_ushort v244, v11, s[20:23], s97 offen offset:0
    buffer_load_ushort v245, v11, s[20:23], s97 offen offset:64
    buffer_load_ushort v246, v11, s[20:23], s97 offen offset:128
    buffer_load_ushort v247, v11, s[20:23], s97 offen offset:192
    s_mov_b32 exec_hi, -1
    s_waitcnt lgkmcnt(6)
    v_mfma_f32_32x32x16_bf16 v[128:143], v[200:203], v[60:63], v[128:143]
    ds_read_b64_tr_b16 v[188:189], v3 offset:37888
    ds_read_b64_tr_b16 v[190:191], v3 offset:38144
    v_mfma_f32_32x32x16_bf16 v[144:159], v[204:207], v[60:63], v[144:159]
    ds_read_b64_tr_b16 v[192:193], v3 offset:41984
    ds_read_b64_tr_b16 v[194:195], v3 offset:42240
    v_mfma_f32_32x32x16_bf16 v[160:175], v[208:211], v[60:63], v[160:175]
    ds_read_b64_tr_b16 v[196:197], v3 offset:46080
    ds_read_b64_tr_b16 v[198:199], v3 offset:46336
    s_waitcnt lgkmcnt(6)
    s_nop 0
    v_mfma_f32_32x32x16_bf16 v[128:143], v[176:179], v[64:67], v[128:143]
    ds_read_b64_tr_b16 v[200:201], v3 offset:38912
    ds_read_b64_tr_b16 v[202:203], v3 offset:39168
    v_mfma_f32_32x32x16_bf16 v[144:159], v[180:183], v[64:67], v[144:159]
    ds_read_b64_tr_b16 v[204:205], v3 offset:43008
    ds_read_b64_tr_b16 v[206:207], v3 offset:43264
    v_mfma_f32_32x32x16_bf16 v[160:175], v[184:187], v[64:67], v[160:175]
    ds_read_b64_tr_b16 v[208:209], v3 offset:47104
    ds_read_b64_tr_b16 v[210:211], v3 offset:47360
    s_waitcnt lgkmcnt(6)
    s_nop 0
    v_mfma_f32_32x32x16_bf16 v[128:143], v[188:191], v[68:71], v[128:143]
    ds_read_b64_tr_b16 v[176:177], v3 offset:39936
    ds_read_b64_tr_b16 v[178:179], v3 offset:40192
    v_mfma_f32_32x32x16_bf16 v[144:159], v[192:195], v[68:71], v[144:159]
    ds_read_b64_tr_b16 v[180:181], v3 offset:44032
    ds_read_b64_tr_b16 v[182:183], v3 offset:44288
    v_mfma_f32_32x32x16_bf16 v[160:175], v[196:199], v[68:71], v[160:175]
    ds_read_b64_tr_b16 v[184:185], v3 offset:48128
    ds_read_b64_tr_b16 v[186:187], v3 offset:48384
    s_waitcnt vmcnt(18)
    s_barrier
    s_waitcnt lgkmcnt(6)
    s_nop 0
    v_mfma_f32_32x32x16_bf16 v[128:143], v[200:203], v[72:75], v[128:143]
    ds_read_b64_tr_b16 v[188:189], v4 offset:0
    ds_read_b64_tr_b16 v[190:191], v4 offset:256
    v_mfma_f32_32x32x16_bf16 v[144:159], v[204:207], v[72:75], v[144:159]
    ds_read_b64_tr_b16 v[192:193], v4 offset:4096
    ds_read_b64_tr_b16 v[194:195], v4 offset:4352
    v_mfma_f32_32x32x16_bf16 v[160:175], v[208:211], v[72:75], v[160:175]
    ds_read_b64_tr_b16 v[196:197], v4 offset:8192
    ds_read_b64_tr_b16 v[198:199], v4 offset:8448
    v_lshlrev_b32_e64 v6, 7, v1
    s_cmp_lg_u32 s44, 1
    s_cbranch_scc1 L_nowarm_2
    s_mul_i32 s49, s2, 6272
    s_mov_b32 exec_hi, 0x1ffff
    buffer_load_dword a254, v6, s[16:19], s49 offen
    s_mov_b64 exec, -1
L_nowarm_2:
    s_cmp_lg_u32 s44, 2
    s_cbranch_scc1 L_nowarm_3
    s_nop 0
    s_mul_i32 s49, s2, 6272
    s_mov_b32 exec_hi, 0x1ffff
    buffer_load_dword a252, v6, s[24:27], s49 offen
    s_mov_b64 exec, -1
L_nowarm_3:
    s_cmp_lg_u32 s44, 3
    s_cbranch_scc1 L_nowarm_4
    s_nop 0
    s_mul_i32 s49, s2, 1568
    s_mov_b32 exec_lo, 0x1fff
    s_mov_b32 exec_hi, 0
    s_nop 0
    buffer_load_dword a253, v6, s[28:31], s49 offen
    s_mov_b64 exec, -1
L_nowarm_4:
    s_cmp_lt_u32 s48, 2
    s_cbranch_scc1 L_nopb_5
    s_lshl_b32 s51, s44, 10
    s_add_u32 m0, s51, 114688
    s_mul_i32 s49, s80, 229376
    s_add_u32 s49, s49, s97
    s_nop 0
    s_add_u32 s49, s49, 128
    buffer_load_dwordx4 v8, s[16:19], s49 offen lds
L_nopb_5:
    s_waitcnt lgkmcnt(6)
    s_nop 0
    v_mfma_f32_32x32x16_bf16 v[128:143], v[176:179], v[76:79], v[128:143]
    ds_read_b64_tr_b16 v[200:201], v4 offset:1024
    ds_read_b64_tr_b16 v[202:203], v4 offset:1280
    v_mfma_f32_32x32x16_bf16 v[144:159], v[180:183], v[76:79], v[144:159]
    ds_read_b64_tr_b16 v[204:205], v4 offset:5120
    ds_read_b64_tr_b16 v[206:207], v4 offset:5376
    v_mfma_f32_32x32x16_bf16 v[160:175], v[184:187], v[76:79], v[160:175]
    ds_read_b64_tr_b16 v[208:209], v4 offset:9216
    ds_read_b64_tr_b16 v[210:211], v4 offset:9472
    s_cmp_lt_u32 s48, 2
    s_cbranch_scc1 L_nopb_6
    s_lshl_b32 s51, s44, 10
    s_nop 0
    s_add_u32 m0, s51, 118784
    s_mul_i32 s49, s80, 229376
    s_add_u32 s49, s49, s97
    s_nop 0
    s_add_u32 s49, s49, 114816
    buffer_load_dwordx4 v8, s[16:19], s49 offen lds
L_nopb_6:
    s_waitcnt lgkmcnt(6)
    s_nop 0
    v_mfma_f32_32x32x16_bf16 v[128:143], v[188:191], v[80:83], v[128:143]
    ds_read_b64_tr_b16 v[176:177], v4 offset:2048
    ds_read_b64_tr_b16 v[178:179], v4 offset:2304
    v_mfma_f32_32x32x16_bf16 v[144:159], v[192:195], v[80:83], v[144:159]
    ds_read_b64_tr_b16 v[180:181], v4 offset:6144
    ds_read_b64_tr_b16 v[182:183], v4 offset:6400
    v_mfma_f32_32x32x16_bf16 v[160:175], v[196:199], v[80:83], v[160:175]
    ds_read_b64_tr_b16 v[184:185], v4 offset:10240
    ds_read_b64_tr_b16 v[186:187], v4 offset:10496
    s_waitcnt lgkmcnt(6)
    s_nop 0
    v_mfma_f32_32x32x16_bf16 v[128:143], v[200:203], v[84:87], v[128:143]
    ds_read_b64_tr_b16 v[188:189], v4 offset:3072
    ds_read_b64_tr_b16 v[190:191], v4 offset:3328
    v_mfma_f32_32x32x16_bf16 v[144:159], v[204:207], v[84:87], v[144:159]
    ds_read_b64_tr_b16 v[192:193], v4 offset:7168
    ds_read_b64_tr_b16 v[194:195], v4 offset:7424
    v_mfma_f32_32x32x16_bf16 v[160:175], v[208:211], v[84:87], v[160:175]
    ds_read_b64_tr_b16 v[196:197], v4 offset:11264
    ds_read_b64_tr_b16 v[198:199], v4 offset:11520
    s_cmp_lt_u32 s48, 2
    s_cbranch_scc1 L_nopb_7
    s_lshl_b32 s51, s44, 10
    s_nop 0
    s_add_u32 m0, s51, 122880
    s_mul_i32 s49, s81, 229376
    s_add_u32 s49, s49, s97
    s_nop 0
    s_add_u32 s49, s49, 128
    buffer_load_dwordx4 v8, s[16:19], s49 offen lds
L_nopb_7:
    s_waitcnt lgkmcnt(6)
    s_nop 0
    v_mfma_f32_32x32x16_bf16 v[128:143], v[176:179], v[88:91], v[128:143]
    ds_read_b64_tr_b16 v[200:201], v4 offset:12288
    ds_read_b64_tr_b16 v[202:203], v4 offset:12544
    v_mfma_f32_32x32x16_bf16 v[144:159], v[180:183], v[88:91], v[144:159]
    ds_read_b64_tr_b16 v[204:205], v4 offset:16384
    ds_read_b64_tr_b16 v[206:207], v4 offset:16640
    v_mfma_f32_32x32x16_bf16 v[160:175], v[184:187], v[88:91], v[160:175]
    ds_read_b64_tr_b16 v[208:209], v4 offset:20480
    ds_read_b64_tr_b16 v[210:211], v4 offset:20736
    s_cmp_lt_u32 s48, 2
    s_cbranch_scc1 L_nopb_8
    s_lshl_b32 s51, s44, 10
    s_nop 0
    s_add_u32 m0, s51, 126976
    s_mul_i32 s49, s81, 229376
    s_add_u32 s49, s49, s97
    s_nop 0
    s_add_u32 s49, s49, 114816
    buffer_load_dwordx4 v8, s[16:19], s49 offen lds
L_nopb_8:
    s_waitcnt lgkmcnt(6)
    s_nop 0
    v_mfma_f32_32x32x16_bf16 v[128:143], v[188:191], v[92:95], v[128:143]
    ds_read_b64_tr_b16 v[176:177], v4 offset:13312
    ds_read_b64_tr_b16 v[178:179], v4 offset:13568
    v_mfma_f32_32x32x16_bf16 v[144:159], v[192:195], v[92:95], v[144:159]
    ds_read_b64_tr_b16 v[180:181], v4 offset:17408
    ds_read_b64_tr_b16 v[182:183], v4 offset:17664
    v_mfma_f32_32x32x16_bf16 v[160:175], v[196:199], v[92:95], v[160:175]
    ds_read_b64_tr_b16 v[184:185], v4 offset:21504
    ds_read_b64_tr_b16 v[186:187], v4 offset:21760
    s_waitcnt lgkmcnt(6)
    s_nop 0
    v_mfma_f32_32x32x16_bf16 v[128:143], v[200:203], v[96:99], v[128:143]
    ds_read_b64_tr_b16 v[188:189], v4 offset:14336
    ds_read_b64_tr_b16 v[190:191], v4 offset:14592
    v_mfma_f32_32x32x16_bf16 v[144:159], v[204:207], v[96:99], v[144:159]
    ds_read_b64_tr_b16 v[192:193], v4 offset:18432
    ds_read_b64_tr_b16 v[194:195], v4 offset:18688
    v_mfma_f32_32x32x16_bf16 v[160:175], v[208:211], v[96:99], v[160:175]
    ds_read_b64_tr_b16 v[196:197], v4 offset:22528
    ds_read_b64_tr_b16 v[198:199], v4 offset:22784
    s_cmp_lt_u32 s48, 2
    s_cbranch_scc1 L_nopb_9
    s_lshl_b32 s51, s44, 10
    s_nop 0
    s_add_u32 m0, s51, 131072
    s_mul_i32 s49, s82, 229376
    s_add_u32 s49, s49, s97
    s_nop 0
    s_add_u32 s49, s49, 128
    buffer_load_dwordx4 v8, s[16:19], s49 offen lds
L_nopb_9:
    s_waitcnt lgkmcnt(6)
    s_nop 0
    v_mfma_f32_32x32x16_bf16 v[128:143], v[176:179], v[100:103], v[128:143]
    ds_read_b64_tr_b16 v[200:201], v4 offset:15360
    ds_read_b64_tr_b16 v[202:203], v4 offset:15616
    v_mfma_f32_32x32x16_bf16 v[144:159], v[180:183], v[100:103], v[144:159]
    ds_read_b64_tr_b16 v[204:205], v4 offset:19456
    ds_read_b64_tr_b16 v[206:207], v4 offset:19712
    v_mfma_f32_32x32x16_bf16 v[160:175], v[184:187], v[100:103], v[160:175]
    ds_read_b64_tr_b16 v[208:209], v4 offset:23552
    ds_read_b64_tr_b16 v[210:211], v4 offset:23808
    s_cmp_lt_u32 s48, 2
    s_cbranch_scc1 L_nopb_10
    s_lshl_b32 s51, s44, 10
    s_nop 0
    s_add_u32 m0, s51, 135168
    s_mul_i32 s49, s82, 229376
    s_add_u32 s49, s49, s97
    s_nop 0
    s_add_u32 s49, s49, 114816
    buffer_load_dwordx4 v8, s[16:19], s49 offen lds
L_nopb_10:
    s_waitcnt lgkmcnt(6)
    s_nop 0
    v_mfma_f32_32x32x16_bf16 v[128:143], v[188:191], v[104:107], v[128:143]
    ds_read_b64_tr_b16 v[176:177], v4 offset:24576
    ds_read_b64_tr_b16 v[178:179], v4 offset:24832
    v_mfma_f32_32x32x16_bf16 v[144:159], v[192:195], v[104:107], v[144:159]
    ds_read_b64_tr_b16 v[180:181], v4 offset:28672
    ds_read_b64_tr_b16 v[182:183], v4 offset:28928
    v_mfma_f32_32x32x16_bf16 v[160:175], v[196:199], v[104:107], v[160:175]
    ds_read_b64_tr_b16 v[184:185], v4 offset:32768
    ds_read_b64_tr_b16 v[186:187], v4 offset:33024
    s_waitcnt lgkmcnt(6)
    s_nop 0
    v_mfma_f32_32x32x16_bf16 v[128:143], v[200:203], v[108:111], v[128:143]
    ds_read_b64_tr_b16 v[188:189], v4 offset:25600
    ds_read_b64_tr_b16 v[190:191], v4 offset:25856
    v_mfma_f32_32x32x16_bf16 v[144:159], v[204:207], v[108:111], v[144:159]
    ds_read_b64_tr_b16 v[192:193], v4 offset:29696
    ds_read_b64_tr_b16 v[194:195], v4 offset:29952
    v_mfma_f32_32x32x16_bf16 v[160:175], v[208:211], v[108:111], v[160:175]
    ds_read_b64_tr_b16 v[196:197], v4 offset:33792
    ds_read_b64_tr_b16 v[198:199], v4 offset:34048
    s_cmp_lt_u32 s48, 2
    s_cbranch_scc1 L_nopb_11
    s_lshl_b32 s51, s44, 10
    s_nop 0
    s_add_u32 m0, s51, 139264
    s_mul_i32 s49, s83, 229376
    s_add_u32 s49, s49, s97
    s_nop 0
    s_add_u32 s49, s49, 128
    buffer_load_dwordx4 v8, s[16:19], s49 offen lds
L_nopb_11:
    s_waitcnt lgkmcnt(6)
    s_nop 0
    v_mfma_f32_32x32x16_bf16 v[128:143], v[176:179], v[112:115], v[128:143]
    ds_read_b64_tr_b16 v[200:201], v4 offset:26624
    ds_read_b64_tr_b16 v[202:203], v4 offset:26880
    v_mfma_f32_32x32x16_bf16 v[144:159], v[180:183], v[112:115], v[144:159]
    ds_read_b64_tr_b16 v[204:205], v4 offset:30720
    ds_read_b64_tr_b16 v[206:207], v4 offset:30976
    v_mfma_f32_32x32x16_bf16 v[160:175], v[184:187], v[112:115], v[160:175]
    ds_read_b64_tr_b16 v[208:209], v4 offset:34816
    ds_read_b64_tr_b16 v[210:211], v4 offset:35072
    s_cmp_lt_u32 s48, 2
    s_cbranch_scc1 L_nopb_12
    s_lshl_b32 s51, s44, 10
    s_nop 0
    s_add_u32 m0, s51, 143360
    s_mul_i32 s49, s83, 229376
    s_add_u32 s49, s49, s97
    s_nop 0
    s_add_u32 s49, s49, 114816
    buffer_load_dwordx4 v8, s[16:19], s49 offen lds
L_nopb_12:
    s_waitcnt lgkmcnt(6)
    s_nop 0
    v_mfma_f32_32x32x16_bf16 v[128:143], v[188:191], v[116:119], v[128:143]
    ds_read_b64_tr_b16 v[176:177], v4 offset:27648
    ds_read_b64_tr_b16 v[178:179], v4 offset:27904
    v_mfma_f32_32x32x16_bf16 v[144:159], v[192:195], v[116:119], v[144:159]
    ds_read_b64_tr_b16 v[180:181], v4 offset:31744
    ds_read_b64_tr_b16 v[182:183], v4 offset:32000
    v_mfma_f32_32x32x16_bf16 v[160:175], v[196:199], v[116:119], v[160:175]
    ds_read_b64_tr_b16 v[184:185], v4 offset:35840
    ds_read_b64_tr_b16 v[186:187], v4 offset:36096
    s_waitcnt lgkmcnt(6)
    s_nop 0
    v_mfma_f32_32x32x16_bf16 v[128:143], v[200:203], v[120:123], v[128:143]
    v_mfma_f32_32x32x16_bf16 v[144:159], v[204:207], v[120:123], v[144:159]
    v_mfma_f32_32x32x16_bf16 v[160:175], v[208:211], v[120:123], v[160:175]
    s_cmp_lt_u32 s48, 2
    s_cbranch_scc1 L_nopb_13
    s_lshl_b32 s51, s44, 10
    s_nop 0
    s_add_u32 m0, s51, 147456
    s_mul_i32 s49, s84, 229376
    s_add_u32 s49, s49, s97
    s_nop 0
    s_add_u32 s49, s49, 128
    buffer_load_dwordx4 v8, s[16:19], s49 offen lds
L_nopb_13:
    s_waitcnt lgkmcnt(0)
    s_nop 0
    v_mfma_f32_32x32x16_bf16 v[128:143], v[176:179], v[124:127], v[128:143]
    v_mfma_f32_32x32x16_bf16 v[144:159], v[180:183], v[124:127], v[144:159]
    v_mfma_f32_32x32x16_bf16 v[160:175], v[184:187], v[124:127], v[160:175]
    s_branch L_gemm_done
L_gemm_kkv:
    s_waitcnt vmcnt(15)
    s_barrier
    s_nop 0
    ds_read_b64_tr_b16 v[176:177], v3 offset:0
    ds_read_b64_tr_b16 v[178:179], v3 offset:256
    ds_read_b64_tr_b16 v[180:181], v3 offset:4096
    ds_read_b64_tr_b16 v[182:183], v3 offset:4352
    ds_read_b64_tr_b16 v[184:185], v3 offset:8192
    ds_read_b64_tr_b16 v[186:187], v3 offset:8448
    ds_read_b64_tr_b16 v[188:189], v3 offset:1024
    ds_read_b64_tr_b16 v[190:191], v3 offset:1280
    ds_read_b64_tr_b16 v[192:193], v3 offset:5120
    ds_read_b64_tr_b16 v[194:195], v3 offset:5376
    ds_read_b64_tr_b16 v[196:197], v3 offset:9216
    ds_read_b64_tr_b16 v[198:199], v3 offset:9472
    s_waitcnt lgkmcnt(6)
    s_nop 0
    v_mfma_f32_32x32x16_bf16 v[128:143], v[176:179], v[16:19], 0
    ds_read_b64_tr_b16 v[200:201], v3 offset:2048
    ds_read_b64_tr_b16 v[202:203], v3 offset:2304
    v_mfma_f32_32x32x16_bf16 v[144:159], v[180:183], v[16:19], 0
    ds_read_b64_tr_b16 v[204:205], v3 offset:6144
    ds_read_b64_tr_b16 v[206:207], v3 offset:6400
    v_mfma_f32_32x32x16_bf16 v[160:175], v[16:19], v[184:187], 0
    ds_read_b64_tr_b16 v[208:209], v3 offset:10240
    ds_read_b64_tr_b16 v[210:211], v3 offset:10496
    s_lshl_b32 s51, s44, 10
    s_nop 0
    s_add_u32 m0, s51, 24576
    s_mul_i32 s49, s83, 229376
    s_add_u32 s49, s49, s97
    s_nop 0
    buffer_load_dwordx4 v8, s[16:19], s49 offen lds
    s_waitcnt lgkmcnt(6)
    s_nop 0
    v_mfma_f32_32x32x16_bf16 v[128:143], v[188:191], v[20:23], v[128:143]
    ds_read_b64_tr_b16 v[176:177], v3 offset:3072
    ds_read_b64_tr_b16 v[178:179], v3 offset:3328
    v_mfma_f32_32x32x16_bf16 v[144:159], v[192:195], v[20:23], v[144:159]
    ds_read_b64_tr_b16 v[180:181], v3 offset:7168
    ds_read_b64_tr_b16 v[182:183], v3 offset:7424
    v_mfma_f32_32x32x16_bf16 v[160:175], v[20:23], v[196:199], v[160:175]
    ds_read_b64_tr_b16 v[184:185], v3 offset:11264
    ds_read_b64_tr_b16 v[186:187], v3 offset:11520
    s_lshl_b32 s51, s44, 10
    s_nop 0
    s_add_u32 m0, s51, 28672
    s_mul_i32 s49, s83, 229376
    s_add_u32 s49, s49, s97
    s_nop 0
    s_add_u32 s49, s49, 114688
    buffer_load_dwordx4 v8, s[16:19], s49 offen lds
    s_waitcnt lgkmcnt(6)
    s_nop 0
    v_mfma_f32_32x32x16_bf16 v[128:143], v[200:203], v[24:27], v[128:143]
    ds_read_b64_tr_b16 v[188:189], v3 offset:12288
    ds_read_b64_tr_b16 v[190:191], v3 offset:12544
    v_mfma_f32_32x32x16_bf16 v[144:159], v[204:207], v[24:27], v[144:159]
    ds_read_b64_tr_b16 v[192:193], v3 offset:16384
    ds_read_b64_tr_b16 v[194:195], v3 offset:16640
    v_mfma_f32_32x32x16_bf16 v[160:175], v[24:27], v[208:211], v[160:175]
    ds_read_b64_tr_b16 v[196:197], v3 offset:20480
    ds_read_b64_tr_b16 v[198:199], v3 offset:20736
    s_lshl_b32 s51, s44, 10
    s_nop 0
    s_add_u32 m0, s51, 32768
    s_mul_i32 s49, s84, 229376
    s_add_u32 s49, s49, s97
    s_nop 0
    buffer_load_dwordx4 v8, s[16:19], s49 offen lds
    s_waitcnt lgkmcnt(6)
    s_nop 0
    v_mfma_f32_32x32x16_bf16 v[128:143], v[176:179], v[28:31], v[128:143]
    ds_read_b64_tr_b16 v[200:201], v3 offset:13312
    ds_read_b64_tr_b16 v[202:203], v3 offset:13568
    v_mfma_f32_32x32x16_bf16 v[144:159], v[180:183], v[28:31], v[144:159]
    ds_read_b64_tr_b16 v[204:205], v3 offset:17408
    ds_read_b64_tr_b16 v[206:207], v3 offset:17664
    v_mfma_f32_32x32x16_bf16 v[160:175], v[28:31], v[184:187], v[160:175]
    ds_read_b64_tr_b16 v[208:209], v3 offset:21504
    ds_read_b64_tr_b16 v[210:211], v3 offset:21760
    s_lshl_b32 s51, s44, 10
    s_nop 0
    s_add_u32 m0, s51, 36864
    s_mul_i32 s49, s84, 229376
    s_add_u32 s49, s49, s97
    s_nop 0
    s_add_u32 s49, s49, 114688
    buffer_load_dwordx4 v8, s[16:19], s49 offen lds
    s_waitcnt lgkmcnt(6)
    s_nop 0
    v_mfma_f32_32x32x16_bf16 v[128:143], v[188:191], v[32:35], v[128:143]
    ds_read_b64_tr_b16 v[176:177], v3 offset:14336
    ds_read_b64_tr_b16 v[178:179], v3 offset:14592
    v_mfma_f32_32x32x16_bf16 v[144:159], v[192:195], v[32:35], v[144:159]
    ds_read_b64_tr_b16 v[180:181], v3 offset:18432
    ds_read_b64_tr_b16 v[182:183], v3 offset:18688
    v_mfma_f32_32x32x16_bf16 v[160:175], v[32:35], v[196:199], v[160:175]
    ds_read_b64_tr_b16 v[184:185], v3 offset:22528
    ds_read_b64_tr_b16 v[186:187], v3 offset:22784
    s_lshl_b32 s51, s44, 10
    s_nop 0
    s_add_u32 m0, s51, 40960
    s_mul_i32 s49, s85, 229376
    s_add_u32 s49, s49, s97
    s_nop 0
    buffer_load_dwordx4 v8, s[16:19], s49 offen lds
    s_waitcnt lgkmcnt(6)
    s_nop 0
    v_mfma_f32_32x32x16_bf16 v[128:143], v[200:203], v[36:39], v[128:143]
    ds_read_b64_tr_b16 v[188:189], v3 offset:15360
    ds_read_b64_tr_b16 v[190:191], v3 offset:15616
    v_mfma_f32_32x32x16_bf16 v[144:159], v[204:207], v[36:39], v[144:159]
    ds_read_b64_tr_b16 v[192:193], v3 offset:19456
    ds_read_b64_tr_b16 v[194:195], v3 offset:19712
    v_mfma_f32_32x32x16_bf16 v[160:175], v[36:39], v[208:211], v[160:175]
    ds_read_b64_tr_b16 v[196:197], v3 offset:23552
    ds_read_b64_tr_b16 v[198:199], v3 offset:23808
    s_lshl_b32 s51, s44, 10
    s_nop 0
    s_add_u32 m0, s51, 45056
    s_mul_i32 s49, s85, 229376
    s_add_u32 s49, s49, s97
    s_nop 0
    s_add_u32 s49, s49, 114688
    buffer_load_dwordx4 v8, s[16:19], s49 offen lds
    s_waitcnt lgkmcnt(6)
    s_nop 0
    v_mfma_f32_32x32x16_bf16 v[128:143], v[176:179], v[40:43], v[128:143]
    ds_read_b64_tr_b16 v[200:201], v3 offset:24576
    ds_read_b64_tr_b16 v[202:203], v3 offset:24832
    v_mfma_f32_32x32x16_bf16 v[144:159], v[180:183], v[40:43], v[144:159]
    ds_read_b64_tr_b16 v[204:205], v3 offset:28672
    ds_read_b64_tr_b16 v[206:207], v3 offset:28928
    v_mfma_f32_32x32x16_bf16 v[160:175], v[40:43], v[184:187], v[160:175]
    ds_read_b64_tr_b16 v[208:209], v3 offset:32768
    ds_read_b64_tr_b16 v[210:211], v3 offset:33024
    s_lshl_b32 s51, s44, 10
    s_nop 0
    s_add_u32 m0, s51, 49152
    s_mul_i32 s49, s86, 229376
    s_add_u32 s49, s49, s97
    s_nop 0
    buffer_load_dwordx4 v8, s[16:19], s49 offen lds
    s_waitcnt lgkmcnt(6)
    s_nop 0
    v_mfma_f32_32x32x16_bf16 v[128:143], v[188:191], v[44:47], v[128:143]
    ds_read_b64_tr_b16 v[176:177], v3 offset:25600
    ds_read_b64_tr_b16 v[178:179], v3 offset:25856
    v_mfma_f32_32x32x16_bf16 v[144:159], v[192:195], v[44:47], v[144:159]
    ds_read_b64_tr_b16 v[180:181], v3 offset:29696
    ds_read_b64_tr_b16 v[182:183], v3 offset:29952
    v_mfma_f32_32x32x16_bf16 v[160:175], v[44:47], v[196:199], v[160:175]
    ds_read_b64_tr_b16 v[184:185], v3 offset:33792
    ds_read_b64_tr_b16 v[186:187], v3 offset:34048
    s_lshl_b32 s51, s44, 10
    s_nop 0
    s_add_u32 m0, s51, 53248
    s_mul_i32 s49, s86, 229376
    s_add_u32 s49, s49, s97
    s_nop 0
    s_add_u32 s49, s49, 114688
    buffer_load_dwordx4 v8, s[16:19], s49 offen lds
    s_waitcnt lgkmcnt(6)
    s_nop 0
    v_mfma_f32_32x32x16_bf16 v[128:143], v[200:203], v[48:51], v[128:143]
    ds_read_b64_tr_b16 v[188:189], v3 offset:26624
    ds_read_b64_tr_b16 v[190:191], v3 offset:26880
    v_mfma_f32_32x32x16_bf16 v[144:159], v[204:207], v[48:51], v[144:159]
    ds_read_b64_tr_b16 v[192:193], v3 offset:30720
    ds_read_b64_tr_b16 v[194:195], v3 offset:30976
    v_mfma_f32_32x32x16_bf16 v[160:175], v[48:51], v[208:211], v[160:175]
    ds_read_b64_tr_b16 v[196:197], v3 offset:34816
    ds_read_b64_tr_b16 v[198:199], v3 offset:35072
    s_waitcnt lgkmcnt(6)
    s_nop 0
    v_mfma_f32_32x32x16_bf16 v[128:143], v[176:179], v[52:55], v[128:143]
    ds_read_b64_tr_b16 v[200:201], v3 offset:27648
    ds_read_b64_tr_b16 v[202:203], v3 offset:27904
    v_mfma_f32_32x32x16_bf16 v[144:159], v[180:183], v[52:55], v[144:159]
    ds_read_b64_tr_b16 v[204:205], v3 offset:31744
    ds_read_b64_tr_b16 v[206:207], v3 offset:32000
    v_mfma_f32_32x32x16_bf16 v[160:175], v[52:55], v[184:187], v[160:175]
    ds_read_b64_tr_b16 v[208:209], v3 offset:35840
    ds_read_b64_tr_b16 v[210:211], v3 offset:36096
    s_cmp_lg_u32 s44, 0
    s_cbranch_scc1 L_nowb_14
    v_lshlrev_b32_e64 v6, 7, v1
    buffer_load_dword a255, v6, s[32:35], 0 offen
L_nowb_14:
    s_waitcnt lgkmcnt(6)
    s_nop 0
    v_mfma_f32_32x32x16_bf16 v[128:143], v[188:191], v[56:59], v[128:143]
    ds_read_b64_tr_b16 v[176:177], v3 offset:36864
    ds_read_b64_tr_b16 v[178:179], v3 offset:37120
    v_mfma_f32_32x32x16_bf16 v[144:159], v[192:195], v[56:59], v[144:159]
    ds_read_b64_tr_b16 v[180:181], v3 offset:40960
    ds_read_b64_tr_b16 v[182:183], v3 offset:41216
    v_mfma_f32_32x32x16_bf16 v[160:175], v[56:59], v[196:199], v[160:175]
    ds_read_b64_tr_b16 v[184:185], v3 offset:45056
    ds_read_b64_tr_b16 v[186:187], v3 offset:45312
    v_and_b32 v11, 31, v0
    v_lshlrev_b32 v11, 1, v11
    v_mov_b32 v244, 0
    v_mov_b32 v245, 0
    v_mov_b32_e64 v246, 0
    v_mov_b32 v247, 0
    s_mov_b32 exec_hi, 0
    buffer_load_ushort v244, v11, s[20:23], s97 offen offset:0
    buffer_load_ushort v245, v11, s[20:23], s97 offen offset:64
    buffer_load_ushort v246, v11, s[20:23], s97 offen offset:128
    buffer_load_ushort v247, v11, s[20:23], s97 offen offset:192
    s_mov_b32 exec_hi, -1
    s_waitcnt lgkmcnt(6)
    v_mfma_f32_32x32x16_bf16 v[128:143], v[200:203], v[60:63], v[128:143]
    ds_read_b64_tr_b16 v[188:189], v3 offset:37888
    ds_read_b64_tr_b16 v[190:191], v3 offset:38144
    v_mfma_f32_32x32x16_bf16 v[144:159], v[204:207], v[60:63], v[144:159]
    ds_read_b64_tr_b16 v[192:193], v3 offset:41984
    ds_read_b64_tr_b16 v[194:195], v3 offset:42240
    v_mfma_f32_32x32x16_bf16 v[160:175], v[60:63], v[208:211], v[160:175]
    ds_read_b64_tr_b16 v[196:197], v3 offset:46080
    ds_read_b64_tr_b16 v[198:199], v3 offset:46336
    s_waitcnt lgkmcnt(6)
    s_nop 0
    v_mfma_f32_32x32x16_bf16 v[128:143], v[176:179], v[64:67], v[128:143]
    ds_read_b64_tr_b16 v[200:201], v3 offset:38912
    ds_read_b64_tr_b16 v[202:203], v3 offset:39168
    v_mfma_f32_32x32x16_bf16 v[144:159], v[180:183], v[64:67], v[144:159]
    ds_read_b64_tr_b16 v[204:205], v3 offset:43008
    ds_read_b64_tr_b16 v[206:207], v3 offset:43264
    v_mfma_f32_32x32x16_bf16 v[160:175], v[64:67], v[184:187], v[160:175]
    ds_read_b64_tr_b16 v[208:209], v3 offset:47104
    ds_read_b64_tr_b16 v[210:211], v3 offset:47360
    s_waitcnt lgkmcnt(6)
    s_nop 0
    v_mfma_f32_32x32x16_bf16 v[128:143], v[188:191], v[68:71], v[128:143]
    ds_read_b64_tr_b16 v[176:177], v3 offset:39936
    ds_read_b64_tr_b16 v[178:179], v3 offset:40192
    v_mfma_f32_32x32x16_bf16 v[144:159], v[192:195], v[68:71], v[144:159]
    ds_read_b64_tr_b16 v[180:181], v3 offset:44032
    ds_read_b64_tr_b16 v[182:183], v3 offset:44288
    v_mfma_f32_32x32x16_bf16 v[160:175], v[68:71], v[196:199], v[160:175]
    ds_read_b64_tr_b16 v[184:185], v3 offset:48128
    ds_read_b64_tr_b16 v[186:187], v3 offset:48384
    s_waitcnt vmcnt(18)
    s_barrier
    s_waitcnt lgkmcnt(6)
    s_nop 0
    v_mfma_f32_32x32x16_bf16 v[128:143], v[200:203], v[72:75], v[128:143]
    ds_read_b64_tr_b16 v[188:189], v4 offset:0
    ds_read_b64_tr_b16 v[190:191], v4 offset:256
    v_mfma_f32_32x32x16_bf16 v[144:159], v[204:207], v[72:75], v[144:159]
    ds_read_b64_tr_b16 v[192:193], v4 offset:4096
    ds_read_b64_tr_b16 v[194:195], v4 offset:4352
    v_mfma_f32_32x32x16_bf16 v[160:175], v[72:75], v[208:211], v[160:175]
    ds_read_b64_tr_b16 v[196:197], v4 offset:8192
    ds_read_b64_tr_b16 v[198:199], v4 offset:8448
    v_lshlrev_b32_e64 v6, 7, v1
    s_cmp_lg_u32 s44, 1
    s_cbranch_scc1 L_nowarm_15
    s_mul_i32 s49, s2, 6272
    s_mov_b32 exec_hi, 0x1ffff
    buffer_load_dword a254, v6, s[16:19], s49 offen
    s_mov_b64 exec, -1
L_nowarm_15:
    s_cmp_lg_u32 s44, 2
    s_cbranch_scc1 L_nowarm_16
    s_nop 0
    s_mul_i32 s49, s2, 6272
    s_mov_b32 exec_hi, 0x1ffff
    buffer_load_dword a252, v6, s[24:27], s49 offen
    s_mov_b64 exec, -1
L_nowarm_16:
    s_cmp_lg_u32 s44, 3
    s_cbranch_scc1 L_nowarm_17
    s_nop 0
    s_mul_i32 s49, s2, 1568
    s_mov_b32 exec_lo, 0x1fff
    s_mov_b32 exec_hi, 0
    s_nop 0
    buffer_load_dword a253, v6, s[28:31], s49 offen
    s_mov_b64 exec, -1
L_nowarm_17:
    s_cmp_lt_u32 s48, 2
    s_cbranch_scc1 L_nopb_18
    s_lshl_b32 s51, s44, 10
    s_add_u32 m0, s51, 114688
    s_mul_i32 s49, s80, 229376
    s_add_u32 s49, s49, s97
    s_nop 0
    s_add_u32 s49, s49, 128
    buffer_load_dwordx4 v8, s[16:19], s49 offen lds
L_nopb_18:
    s_waitcnt lgkmcnt(6)
    s_nop 0
    v_mfma_f32_32x32x16_bf16 v[128:143], v[176:179], v[76:79], v[128:143]
    ds_read_b64_tr_b16 v[200:201], v4 offset:1024
    ds_read_b64_tr_b16 v[202:203], v4 offset:1280
    v_mfma_f32_32x32x16_bf16 v[144:159], v[180:183], v[76:79], v[144:159]
    ds_read_b64_tr_b16 v[204:205], v4 offset:5120
    ds_read_b64_tr_b16 v[206:207], v4 offset:5376
    v_mfma_f32_32x32x16_bf16 v[160:175], v[76:79], v[184:187], v[160:175]
    ds_read_b64_tr_b16 v[208:209], v4 offset:9216
    ds_read_b64_tr_b16 v[210:211], v4 offset:9472
    s_cmp_lt_u32 s48, 2
    s_cbranch_scc1 L_nopb_19
    s_lshl_b32 s51, s44, 10
    s_nop 0
    s_add_u32 m0, s51, 118784
    s_mul_i32 s49, s80, 229376
    s_add_u32 s49, s49, s97
    s_nop 0
    s_add_u32 s49, s49, 114816
    buffer_load_dwordx4 v8, s[16:19], s49 offen lds
L_nopb_19:
    s_waitcnt lgkmcnt(6)
    s_nop 0
    v_mfma_f32_32x32x16_bf16 v[128:143], v[188:191], v[80:83], v[128:143]
    ds_read_b64_tr_b16 v[176:177], v4 offset:2048
    ds_read_b64_tr_b16 v[178:179], v4 offset:2304
    v_mfma_f32_32x32x16_bf16 v[144:159], v[192:195], v[80:83], v[144:159]
    ds_read_b64_tr_b16 v[180:181], v4 offset:6144
    ds_read_b64_tr_b16 v[182:183], v4 offset:6400
    v_mfma_f32_32x32x16_bf16 v[160:175], v[80:83], v[196:199], v[160:175]
    ds_read_b64_tr_b16 v[184:185], v4 offset:10240
    ds_read_b64_tr_b16 v[186:187], v4 offset:10496
    s_waitcnt lgkmcnt(6)
    s_nop 0
    v_mfma_f32_32x32x16_bf16 v[128:143], v[200:203], v[84:87], v[128:143]
    ds_read_b64_tr_b16 v[188:189], v4 offset:3072
    ds_read_b64_tr_b16 v[190:191], v4 offset:3328
    v_mfma_f32_32x32x16_bf16 v[144:159], v[204:207], v[84:87], v[144:159]
    ds_read_b64_tr_b16 v[192:193], v4 offset:7168
    ds_read_b64_tr_b16 v[194:195], v4 offset:7424
    v_mfma_f32_32x32x16_bf16 v[160:175], v[84:87], v[208:211], v[160:175]
    ds_read_b64_tr_b16 v[196:197], v4 offset:11264
    ds_read_b64_tr_b16 v[198:199], v4 offset:11520
    s_cmp_lt_u32 s48, 2
    s_cbranch_scc1 L_nopb_20
    s_lshl_b32 s51, s44, 10
    s_nop 0
    s_add_u32 m0, s51, 122880
    s_mul_i32 s49, s81, 229376
    s_add_u32 s49, s49, s97
    s_nop 0
    s_add_u32 s49, s49, 128
    buffer_load_dwordx4 v8, s[16:19], s49 offen lds
L_nopb_20:
    s_waitcnt lgkmcnt(6)
    s_nop 0
    v_mfma_f32_32x32x16_bf16 v[128:143], v[176:179], v[88:91], v[128:143]
    ds_read_b64_tr_b16 v[200:201], v4 offset:12288
    ds_read_b64_tr_b16 v[202:203], v4 offset:12544
    v_mfma_f32_32x32x16_bf16 v[144:159], v[180:183], v[88:91], v[144:159]
    ds_read_b64_tr_b16 v[204:205], v4 offset:16384
    ds_read_b64_tr_b16 v[206:207], v4 offset:16640
    v_mfma_f32_32x32x16_bf16 v[160:175], v[88:91], v[184:187], v[160:175]
    ds_read_b64_tr_b16 v[208:209], v4 offset:20480
    ds_read_b64_tr_b16 v[210:211], v4 offset:20736
    s_cmp_lt_u32 s48, 2
    s_cbranch_scc1 L_nopb_21
    s_lshl_b32 s51, s44, 10
    s_nop 0
    s_add_u32 m0, s51, 126976
    s_mul_i32 s49, s81, 229376
    s_add_u32 s49, s49, s97
    s_nop 0
    s_add_u32 s49, s49, 114816
    buffer_load_dwordx4 v8, s[16:19], s49 offen lds
L_nopb_21:
    s_waitcnt lgkmcnt(6)
    s_nop 0
    v_mfma_f32_32x32x16_bf16 v[128:143], v[188:191], v[92:95], v[128:143]
    ds_read_b64_tr_b16 v[176:177], v4 offset:13312
    ds_read_b64_tr_b16 v[178:179], v4 offset:13568
    v_mfma_f32_32x32x16_bf16 v[144:159], v[192:195], v[92:95], v[144:159]
    ds_read_b64_tr_b16 v[180:181], v4 offset:17408
    ds_read_b64_tr_b16 v[182:183], v4 offset:17664
    v_mfma_f32_32x32x16_bf16 v[160:175], v[92:95], v[196:199], v[160:175]
    ds_read_b64_tr_b16 v[184:185], v4 offset:21504
    ds_read_b64_tr_b16 v[186:187], v4 offset:21760
    s_waitcnt lgkmcnt(6)
    s_nop 0
    v_mfma_f32_32x32x16_bf16 v[128:143], v[200:203], v[96:99], v[128:143]
    ds_read_b64_tr_b16 v[188:189], v4 offset:14336
    ds_read_b64_tr_b16 v[190:191], v4 offset:14592
    v_mfma_f32_32x32x16_bf16 v[144:159], v[204:207], v[96:99], v[144:159]
    ds_read_b64_tr_b16 v[192:193], v4 offset:18432
    ds_read_b64_tr_b16 v[194:195], v4 offset:18688
    v_mfma_f32_32x32x16_bf16 v[160:175], v[96:99], v[208:211], v[160:175]
    ds_read_b64_tr_b16 v[196:197], v4 offset:22528
    ds_read_b64_tr_b16 v[198:199], v4 offset:22784
    s_cmp_lt_u32 s48, 2
    s_cbranch_scc1 L_nopb_22
    s_lshl_b32 s51, s44, 10
    s_nop 0
    s_add_u32 m0, s51, 131072
    s_mul_i32 s49, s82, 229376
    s_add_u32 s49, s49, s97
    s_nop 0
    s_add_u32 s49, s49, 128
    buffer_load_dwordx4 v8, s[16:19], s49 offen lds
L_nopb_22:
    s_waitcnt lgkmcnt(6)
    s_nop 0
    v_mfma_f32_32x32x16_bf16 v[128:143], v[176:179], v[100:103], v[128:143]
    ds_read_b64_tr_b16 v[200:201], v4 offset:15360
    ds_read_b64_tr_b16 v[202:203], v4 offset:15616
    v_mfma_f32_32x32x16_bf16 v[144:159], v[180:183], v[100:103], v[144:159]
    ds_read_b64_tr_b16 v[204:205], v4 offset:19456
    ds_read_b64_tr_b16 v[206:207], v4 offset:19712
    v_mfma_f32_32x32x16_bf16 v[160:175], v[100:103], v[184:187], v[160:175]
    ds_read_b64_tr_b16 v[208:209], v4 offset:23552
    ds_read_b64_tr_b16 v[210:211], v4 offset:23808
    s_cmp_lt_u32 s48, 2
    s_cbranch_scc1 L_nopb_23
    s_lshl_b32 s51, s44, 10
    s_nop 0
    s_add_u32 m0, s51, 135168
    s_mul_i32 s49, s82, 229376
    s_add_u32 s49, s49, s97
    s_nop 0
    s_add_u32 s49, s49, 114816
    buffer_load_dwordx4 v8, s[16:19], s49 offen lds
L_nopb_23:
    s_waitcnt lgkmcnt(6)
    s_nop 0
    v_mfma_f32_32x32x16_bf16 v[128:143], v[188:191], v[104:107], v[128:143]
    ds_read_b64_tr_b16 v[176:177], v4 offset:24576
    ds_read_b64_tr_b16 v[178:179], v4 offset:24832
    v_mfma_f32_32x32x16_bf16 v[144:159], v[192:195], v[104:107], v[144:159]
    ds_read_b64_tr_b16 v[180:181], v4 offset:28672
    ds_read_b64_tr_b16 v[182:183], v4 offset:28928
    v_mfma_f32_32x32x16_bf16 v[160:175], v[104:107], v[196:199], v[160:175]
    ds_read_b64_tr_b16 v[184:185], v4 offset:32768
    ds_read_b64_tr_b16 v[186:187], v4 offset:33024
    s_waitcnt lgkmcnt(6)
    s_nop 0
    v_mfma_f32_32x32x16_bf16 v[128:143], v[200:203], v[108:111], v[128:143]
    ds_read_b64_tr_b16 v[188:189], v4 offset:25600
    ds_read_b64_tr_b16 v[190:191], v4 offset:25856
    v_mfma_f32_32x32x16_bf16 v[144:159], v[204:207], v[108:111], v[144:159]
    ds_read_b64_tr_b16 v[192:193], v4 offset:29696
    ds_read_b64_tr_b16 v[194:195], v4 offset:29952
    v_mfma_f32_32x32x16_bf16 v[160:175], v[108:111], v[208:211], v[160:175]
    ds_read_b64_tr_b16 v[196:197], v4 offset:33792
    ds_read_b64_tr_b16 v[198:199], v4 offset:34048
    s_cmp_lt_u32 s48, 2
    s_cbranch_scc1 L_nopb_24
    s_lshl_b32 s51, s44, 10
    s_nop 0
    s_add_u32 m0, s51, 139264
    s_mul_i32 s49, s83, 229376
    s_add_u32 s49, s49, s97
    s_nop 0
    s_add_u32 s49, s49, 128
    buffer_load_dwordx4 v8, s[16:19], s49 offen lds
L_nopb_24:
    s_waitcnt lgkmcnt(6)
    s_nop 0
    v_mfma_f32_32x32x16_bf16 v[128:143], v[176:179], v[112:115], v[128:143]
    ds_read_b64_tr_b16 v[200:201], v4 offset:26624
    ds_read_b64_tr_b16 v[202:203], v4 offset:26880
    v_mfma_f32_32x32x16_bf16 v[144:159], v[180:183], v[112:115], v[144:159]
    ds_read_b64_tr_b16 v[204:205], v4 offset:30720
    ds_read_b64_tr_b16 v[206:207], v4 offset:30976
    v_mfma_f32_32x32x16_bf16 v[160:175], v[112:115], v[184:187], v[160:175]
    ds_read_b64_tr_b16 v[208:209], v4 offset:34816
    ds_read_b64_tr_b16 v[210:211], v4 offset:35072
    s_cmp_lt_u32 s48, 2
    s_cbranch_scc1 L_nopb_25
    s_lshl_b32 s51, s44, 10
    s_nop 0
    s_add_u32 m0, s51, 143360
    s_mul_i32 s49, s83, 229376
    s_add_u32 s49, s49, s97
    s_nop 0
    s_add_u32 s49, s49, 114816
    buffer_load_dwordx4 v8, s[16:19], s49 offen lds
L_nopb_25:
    s_waitcnt lgkmcnt(6)
    s_nop 0
    v_mfma_f32_32x32x16_bf16 v[128:143], v[188:191], v[116:119], v[128:143]
    ds_read_b64_tr_b16 v[176:177], v4 offset:27648
    ds_read_b64_tr_b16 v[178:179], v4 offset:27904
    v_mfma_f32_32x32x16_bf16 v[144:159], v[192:195], v[116:119], v[144:159]
    ds_read_b64_tr_b16 v[180:181], v4 offset:31744
    ds_read_b64_tr_b16 v[182:183], v4 offset:32000
    v_mfma_f32_32x32x16_bf16 v[160:175], v[116:119], v[196:199], v[160:175]
    ds_read_b64_tr_b16 v[184:185], v4 offset:35840
    ds_read_b64_tr_b16 v[186:187], v4 offset:36096
    s_waitcnt lgkmcnt(6)
    s_nop 0
    v_mfma_f32_32x32x16_bf16 v[128:143], v[200:203], v[120:123], v[128:143]
    v_mfma_f32_32x32x16_bf16 v[144:159], v[204:207], v[120:123], v[144:159]
    v_mfma_f32_32x32x16_bf16 v[160:175], v[120:123], v[208:211], v[160:175]
    s_cmp_lt_u32 s48, 2
    s_cbranch_scc1 L_nopb_26
    s_lshl_b32 s51, s44, 10
    s_nop 0
    s_add_u32 m0, s51, 147456
    s_mul_i32 s49, s84, 229376
    s_add_u32 s49, s49, s97
    s_nop 0
    s_add_u32 s49, s49, 128
    buffer_load_dwordx4 v8, s[16:19], s49 offen lds
L_nopb_26:
    s_waitcnt lgkmcnt(0)
    s_nop 0
    v_mfma_f32_32x32x16_bf16 v[128:143], v[176:179], v[124:127], v[128:143]
    v_mfma_f32_32x32x16_bf16 v[144:159], v[180:183], v[124:127], v[144:159]
    v_mfma_f32_32x32x16_bf16 v[160:175], v[124:127], v[184:187], v[160:175]
    s_branch L_gemm_done
L_gemm_vvv:
    s_waitcnt vmcnt(15)
    s_barrier
    s_nop 0
    ds_read_b64_tr_b16 v[176:177], v3 offset:0
    ds_read_b64_tr_b16 v[178:179], v3 offset:256
    ds_read_b64_tr_b16 v[180:181], v3 offset:4096
    ds_read_b64_tr_b16 v[182:183], v3 offset:4352
    ds_read_b64_tr_b16 v[184:185], v3 offset:8192
    ds_read_b64_tr_b16 v[186:187], v3 offset:8448
    ds_read_b64_tr_b16 v[188:189], v3 offset:1024
    ds_read_b64_tr_b16 v[190:191], v3 offset:1280
    ds_read_b64_tr_b16 v[192:193], v3 offset:5120
    ds_read_b64_tr_b16 v[194:195], v3 offset:5376
    ds_read_b64_tr_b16 v[196:197], v3 offset:9216
    ds_read_b64_tr_b16 v[198:199], v3 offset:9472
    s_waitcnt lgkmcnt(6)
    s_nop 0
    v_mfma_f32_32x32x16_bf16 v[128:143], v[16:19], v[176:179], 0
    ds_read_b64_tr_b16 v[200:201], v3 offset:2048
    ds_read_b64_tr_b16 v[202:203], v3 offset:2304
    v_mfma_f32_32x32x16_bf16 v[144:159], v[16:19], v[180:183], 0
    ds_read_b64_tr_b16 v[204:205], v3 offset:6144
    ds_read_b64_tr_b16 v[206:207], v3 offset:6400
    v_mfma_f32_32x32x16_bf16 v[160:175], v[16:19], v[184:187], 0
    ds_read_b64_tr_b16 v[208:209], v3 offset:10240
    ds_read_b64_tr_b16 v[210:211], v3 offset:10496
    s_lshl_b32 s51, s44, 10
    s_nop 0
    s_add_u32 m0, s51, 24576
    s_mul_i32 s49, s83, 229376
    s_add_u32 s49, s49, s97
    s_nop 0
    buffer_load_dwordx4 v8, s[16:19], s49 offen lds
    s_waitcnt lgkmcnt(6)
    s_nop 0
    v_mfma_f32_32x32x16_bf16 v[128:143], v[20:23], v[188:191], v[128:143]
    ds_read_b64_tr_b16 v[176:177], v3 offset:3072
    ds_read_b64_tr_b16 v[178:179], v3 offset:3328
    v_mfma_f32_32x32x16_bf16 v[144:159], v[20:23], v[192:195], v[144:159]
    ds_read_b64_tr_b16 v[180:181], v3 offset:7168
    ds_read_b64_tr_b16 v[182:183], v3 offset:7424
    v_mfma_f32_32x32x16_bf16 v[160:175], v[20:23], v[196:199], v[160:175]
    ds_read_b64_tr_b16 v[184:185], v3 offset:11264
    ds_read_b64_tr_b16 v[186:187], v3 offset:11520
    s_lshl_b32 s51, s44, 10
    s_nop 0
    s_add_u32 m0, s51, 28672
    s_mul_i32 s49, s83, 229376
    s_add_u32 s49, s49, s97
    s_nop 0
    s_add_u32 s49, s49, 114688
    buffer_load_dwordx4 v8, s[16:19], s49 offen lds
    s_waitcnt lgkmcnt(6)
    s_nop 0
    v_mfma_f32_32x32x16_bf16 v[128:143], v[24:27], v[200:203], v[128:143]
    ds_read_b64_tr_b16 v[188:189], v3 offset:12288
    ds_read_b64_tr_b16 v[190:191], v3 offset:12544
    v_mfma_f32_32x32x16_bf16 v[144:159], v[24:27], v[204:207], v[144:159]
    ds_read_b64_tr_b16 v[192:193], v3 offset:16384
    ds_read_b64_tr_b16 v[194:195], v3 offset:16640
    v_mfma_f32_32x32x16_bf16 v[160:175], v[24:27], v[208:211], v[160:175]
    ds_read_b64_tr_b16 v[196:197], v3 offset:20480
    ds_read_b64_tr_b16 v[198:199], v3 offset:20736
    s_lshl_b32 s51, s44, 10
    s_nop 0
    s_add_u32 m0, s51, 32768
    s_mul_i32 s49, s84, 229376
    s_add_u32 s49, s49, s97
    s_nop 0
    buffer_load_dwordx4 v8, s[16:19], s49 offen lds
    s_waitcnt lgkmcnt(6)
    s_nop 0
    v_mfma_f32_32x32x16_bf16 v[128:143], v[28:31], v[176:179], v[128:143]
    ds_read_b64_tr_b16 v[200:201], v3 offset:13312
    ds_read_b64_tr_b16 v[202:203], v3 offset:13568
    v_mfma_f32_32x32x16_bf16 v[144:159], v[28:31], v[180:183], v[144:159]
    ds_read_b64_tr_b16 v[204:205], v3 offset:17408
    ds_read_b64_tr_b16 v[206:207], v3 offset:17664
    v_mfma_f32_32x32x16_bf16 v[160:175], v[28:31], v[184:187], v[160:175]
    ds_read_b64_tr_b16 v[208:209], v3 offset:21504
    ds_read_b64_tr_b16 v[210:211], v3 offset:21760
    s_lshl_b32 s51, s44, 10
    s_nop 0
    s_add_u32 m0, s51, 36864
    s_mul_i32 s49, s84, 229376
    s_add_u32 s49, s49, s97
    s_nop 0
    s_add_u32 s49, s49, 114688
    buffer_load_dwordx4 v8, s[16:19], s49 offen lds
    s_waitcnt lgkmcnt(6)
    s_nop 0
    v_mfma_f32_32x32x16_bf16 v[128:143], v[32:35], v[188:191], v[128:143]
    ds_read_b64_tr_b16 v[176:177], v3 offset:14336
    ds_read_b64_tr_b16 v[178:179], v3 offset:14592
    v_mfma_f32_32x32x16_bf16 v[144:159], v[32:35], v[192:195], v[144:159]
    ds_read_b64_tr_b16 v[180:181], v3 offset:18432
    ds_read_b64_tr_b16 v[182:183], v3 offset:18688
    v_mfma_f32_32x32x16_bf16 v[160:175], v[32:35], v[196:199], v[160:175]
    ds_read_b64_tr_b16 v[184:185], v3 offset:22528
    ds_read_b64_tr_b16 v[186:187], v3 offset:22784
    s_lshl_b32 s51, s44, 10
    s_nop 0
    s_add_u32 m0, s51, 40960
    s_mul_i32 s49, s85, 229376
    s_add_u32 s49, s49, s97
    s_nop 0
    buffer_load_dwordx4 v8, s[16:19], s49 offen lds
    s_waitcnt lgkmcnt(6)
    s_nop 0
    v_mfma_f32_32x32x16_bf16 v[128:143], v[36:39], v[200:203], v[128:143]
    ds_read_b64_tr_b16 v[188:189], v3 offset:15360
    ds_read_b64_tr_b16 v[190:191], v3 offset:15616
    v_mfma_f32_32x32x16_bf16 v[144:159], v[36:39], v[204:207], v[144:159]
    ds_read_b64_tr_b16 v[192:193], v3 offset:19456
    ds_read_b64_tr_b16 v[194:195], v3 offset:19712
    v_mfma_f32_32x32x16_bf16 v[160:175], v[36:39], v[208:211], v[160:175]
    ds_read_b64_tr_b16 v[196:197], v3 offset:23552
    ds_read_b64_tr_b16 v[198:199], v3 offset:23808
    s_lshl_b32 s51, s44, 10
    s_nop 0
    s_add_u32 m0, s51, 45056
    s_mul_i32 s49, s85, 229376
    s_add_u32 s49, s49, s97
    s_nop 0
    s_add_u32 s49, s49, 114688
    buffer_load_dwordx4 v8, s[16:19], s49 offen lds
    s_waitcnt lgkmcnt(6)
    s_nop 0
    v_mfma_f32_32x32x16_bf16 v[128:143], v[40:43], v[176:179], v[128:143]
    ds_read_b64_tr_b16 v[200:201], v3 offset:24576
    ds_read_b64_tr_b16 v[202:203], v3 offset:24832
    v_mfma_f32_32x32x16_bf16 v[144:159], v[40:43], v[180:183], v[144:159]
    ds_read_b64_tr_b16 v[204:205], v3 offset:28672
    ds_read_b64_tr_b16 v[206:207], v3 offset:28928
    v_mfma_f32_32x32x16_bf16 v[160:175], v[40:43], v[184:187], v[160:175]
    ds_read_b64_tr_b16 v[208:209], v3 offset:32768
    ds_read_b64_tr_b16 v[210:211], v3 offset:33024
    s_lshl_b32 s51, s44, 10
    s_nop 0
    s_add_u32 m0, s51, 49152
    s_mul_i32 s49, s86, 229376
    s_add_u32 s49, s49, s97
    s_nop 0
    buffer_load_dwordx4 v8, s[16:19], s49 offen lds
    s_waitcnt lgkmcnt(6)
    s_nop 0
    v_mfma_f32_32x32x16_bf16 v[128:143], v[44:47], v[188:191], v[128:143]
    ds_read_b64_tr_b16 v[176:177], v3 offset:25600
    ds_read_b64_tr_b16 v[178:179], v3 offset:25856
    v_mfma_f32_32x32x16_bf16 v[144:159], v[44:47], v[192:195], v[144:159]
    ds_read_b64_tr_b16 v[180:181], v3 offset:29696
    ds_read_b64_tr_b16 v[182:183], v3 offset:29952
    v_mfma_f32_32x32x16_bf16 v[160:175], v[44:47], v[196:199], v[160:175]
    ds_read_b64_tr_b16 v[184:185], v3 offset:33792
    ds_read_b64_tr_b16 v[186:187], v3 offset:34048
    s_lshl_b32 s51, s44, 10
    s_nop 0
    s_add_u32 m0, s51, 53248
    s_mul_i32 s49, s86, 229376
    s_add_u32 s49, s49, s97
    s_nop 0
    s_add_u32 s49, s49, 114688
    buffer_load_dwordx4 v8, s[16:19], s49 offen lds
    s_waitcnt lgkmcnt(6)
    s_nop 0
    v_mfma_f32_32x32x16_bf16 v[128:143], v[48:51], v[200:203], v[128:143]
    ds_read_b64_tr_b16 v[188:189], v3 offset:26624
    ds_read_b64_tr_b16 v[190:191], v3 offset:26880
    v_mfma_f32_32x32x16_bf16 v[144:159], v[48:51], v[204:207], v[144:159]
    ds_read_b64_tr_b16 v[192:193], v3 offset:30720
    ds_read_b64_tr_b16 v[194:195], v3 offset:30976
    v_mfma_f32_32x32x16_bf16 v[160:175], v[48:51], v[208:211], v[160:175]
    ds_read_b64_tr_b16 v[196:197], v3 offset:34816
    ds_read_b64_tr_b16 v[198:199], v3 offset:35072
    s_waitcnt lgkmcnt(6)
    s_nop 0
    v_mfma_f32_32x32x16_bf16 v[128:143], v[52:55], v[176:179], v[128:143]
    ds_read_b64_tr_b16 v[200:201], v3 offset:27648
    ds_read_b64_tr_b16 v[202:203], v3 offset:27904
    v_mfma_f32_32x32x16_bf16 v[144:159], v[52:55], v[180:183], v[144:159]
    ds_read_b64_tr_b16 v[204:205], v3 offset:31744
    ds_read_b64_tr_b16 v[206:207], v3 offset:32000
    v_mfma_f32_32x32x16_bf16 v[160:175], v[52:55], v[184:187], v[160:175]
    ds_read_b64_tr_b16 v[208:209], v3 offset:35840
    ds_read_b64_tr_b16 v[210:211], v3 offset:36096
    s_cmp_lg_u32 s44, 0
    s_cbranch_scc1 L_nowb_27
    v_lshlrev_b32_e64 v6, 7, v1
    buffer_load_dword a255, v6, s[32:35], 0 offen
L_nowb_27:
    s_waitcnt lgkmcnt(6)
    s_nop 0
    v_mfma_f32_32x32x16_bf16 v[128:143], v[56:59], v[188:191], v[128:143]
    ds_read_b64_tr_b16 v[176:177], v3 offset:36864
    ds_read_b64_tr_b16 v[178:179], v3 offset:37120
    v_mfma_f32_32x32x16_bf16 v[144:159], v[56:59], v[192:195], v[144:159]
    ds_read_b64_tr_b16 v[180:181], v3 offset:40960
    ds_read_b64_tr_b16 v[182:183], v3 offset:41216
    v_mfma_f32_32x32x16_bf16 v[160:175], v[56:59], v[196:199], v[160:175]
    ds_read_b64_tr_b16 v[184:185], v3 offset:45056
    ds_read_b64_tr_b16 v[186:187], v3 offset:45312
    v_and_b32 v11, 31, v0
    v_lshlrev_b32 v11, 1, v11
    v_mov_b32 v244, 0
    v_mov_b32 v245, 0
    v_mov_b32_e64 v246, 0
    v_mov_b32 v247, 0
    s_mov_b32 exec_hi, 0
    buffer_load_ushort v244, v11, s[20:23], s97 offen offset:0
    buffer_load_ushort v245, v11, s[20:23], s97 offen offset:64
    buffer_load_ushort v246, v11, s[20:23], s97 offen offset:128
    buffer_load_ushort v247, v11, s[20:23], s97 offen offset:192
    s_mov_b32 exec_hi, -1
    s_waitcnt lgkmcnt(6)
    v_mfma_f32_32x32x16_bf16 v[128:143], v[60:63], v[200:203], v[128:143]
    ds_read_b64_tr_b16 v[188:189], v3 offset:37888
    ds_read_b64_tr_b16 v[190:191], v3 offset:38144
    v_mfma_f32_32x32x16_bf16 v[144:159], v[60:63], v[204:207], v[144:159]
    ds_read_b64_tr_b16 v[192:193], v3 offset:41984
    ds_read_b64_tr_b16 v[194:195], v3 offset:42240
    v_mfma_f32_32x32x16_bf16 v[160:175], v[60:63], v[208:211], v[160:175]
    ds_read_b64_tr_b16 v[196:197], v3 offset:46080
    ds_read_b64_tr_b16 v[198:199], v3 offset:46336
    s_waitcnt lgkmcnt(6)
    s_nop 0
    v_mfma_f32_32x32x16_bf16 v[128:143], v[64:67], v[176:179], v[128:143]
    ds_read_b64_tr_b16 v[200:201], v3 offset:38912
    ds_read_b64_tr_b16 v[202:203], v3 offset:39168
    v_mfma_f32_32x32x16_bf16 v[144:159], v[64:67], v[180:183], v[144:159]
    ds_read_b64_tr_b16 v[204:205], v3 offset:43008
    ds_read_b64_tr_b16 v[206:207], v3 offset:43264
    v_mfma_f32_32x32x16_bf16 v[160:175], v[64:67], v[184:187], v[160:175]
    ds_read_b64_tr_b16 v[208:209], v3 offset:47104
    ds_read_b64_tr_b16 v[210:211], v3 offset:47360
    s_waitcnt lgkmcnt(6)
    s_nop 0
    v_mfma_f32_32x32x16_bf16 v[128:143], v[68:71], v[188:191], v[128:143]
    ds_read_b64_tr_b16 v[176:177], v3 offset:39936
    ds_read_b64_tr_b16 v[178:179], v3 offset:40192
    v_mfma_f32_32x32x16_bf16 v[144:159], v[68:71], v[192:195], v[144:159]
    ds_read_b64_tr_b16 v[180:181], v3 offset:44032
    ds_read_b64_tr_b16 v[182:183], v3 offset:44288
    v_mfma_f32_32x32x16_bf16 v[160:175], v[68:71], v[196:199], v[160:175]
    ds_read_b64_tr_b16 v[184:185], v3 offset:48128
    ds_read_b64_tr_b16 v[186:187], v3 offset:48384
    s_waitcnt vmcnt(18)
    s_barrier
    s_waitcnt lgkmcnt(6)
    s_nop 0
    v_mfma_f32_32x32x16_bf16 v[128:143], v[72:75], v[200:203], v[128:143]
    ds_read_b64_tr_b16 v[188:189], v4 offset:0
    ds_read_b64_tr_b16 v[190:191], v4 offset:256
    v_mfma_f32_32x32x16_bf16 v[144:159], v[72:75], v[204:207], v[144:159]
    ds_read_b64_tr_b16 v[192:193], v4 offset:4096
    ds_read_b64_tr_b16 v[194:195], v4 offset:4352
    v_mfma_f32_32x32x16_bf16 v[160:175], v[72:75], v[208:211], v[160:175]
    ds_read_b64_tr_b16 v[196:197], v4 offset:8192
    ds_read_b64_tr_b16 v[198:199], v4 offset:8448
    v_lshlrev_b32_e64 v6, 7, v1
    s_cmp_lg_u32 s44, 1
    s_cbranch_scc1 L_nowarm_28
    s_mul_i32 s49, s2, 6272
    s_mov_b32 exec_hi, 0x1ffff
    buffer_load_dword a254, v6, s[16:19], s49 offen
    s_mov_b64 exec, -1
L_nowarm_28:
    s_cmp_lg_u32 s44, 2
    s_cbranch_scc1 L_nowarm_29
    s_nop 0
    s_mul_i32 s49, s2, 6272
    s_mov_b32 exec_hi, 0x1ffff
    buffer_load_dword a252, v6, s[24:27], s49 offen
    s_mov_b64 exec, -1
L_nowarm_29:
    s_cmp_lg_u32 s44, 3
    s_cbranch_scc1 L_nowarm_30
    s_nop 0
    s_mul_i32 s49, s2, 1568
    s_mov_b32 exec_lo, 0x1fff
    s_mov_b32 exec_hi, 0
    s_nop 0
    buffer_load_dword a253, v6, s[28:31], s49 offen
    s_mov_b64 exec, -1
L_nowarm_30:
    s_cmp_lt_u32 s48, 2
    s_cbranch_scc1 L_nopb_31
    s_lshl_b32 s51, s44, 10
    s_add_u32 m0, s51, 114688
    s_mul_i32 s49, s80, 229376
    s_add_u32 s49, s49, s97
    s_nop 0
    s_add_u32 s49, s49, 128
    buffer_load_dwordx4 v8, s[16:19], s49 offen lds
L_nopb_31:
    s_waitcnt lgkmcnt(6)
    s_nop 0
    v_mfma_f32_32x32x16_bf16 v[128:143], v[76:79], v[176:179], v[128:143]
    ds_read_b64_tr_b16 v[200:201], v4 offset:1024
    ds_read_b64_tr_b16 v[202:203], v4 offset:1280
    v_mfma_f32_32x32x16_bf16 v[144:159], v[76:79], v[180:183], v[144:159]
    ds_read_b64_tr_b16 v[204:205], v4 offset:5120
    ds_read_b64_tr_b16 v[206:207], v4 offset:5376
    v_mfma_f32_32x32x16_bf16 v[160:175], v[76:79], v[184:187], v[160:175]
    ds_read_b64_tr_b16 v[208:209], v4 offset:9216
    ds_read_b64_tr_b16 v[210:211], v4 offset:9472
    s_cmp_lt_u32 s48, 2
    s_cbranch_scc1 L_nopb_32
    s_lshl_b32 s51, s44, 10
    s_nop 0
    s_add_u32 m0, s51, 118784
    s_mul_i32 s49, s80, 229376
    s_add_u32 s49, s49, s97
    s_nop 0
    s_add_u32 s49, s49, 114816
    buffer_load_dwordx4 v8, s[16:19], s49 offen lds
L_nopb_32:
    s_waitcnt lgkmcnt(6)
    s_nop 0
    v_mfma_f32_32x32x16_bf16 v[128:143], v[80:83], v[188:191], v[128:143]
    ds_read_b64_tr_b16 v[176:177], v4 offset:2048
    ds_read_b64_tr_b16 v[178:179], v4 offset:2304
    v_mfma_f32_32x32x16_bf16 v[144:159], v[80:83], v[192:195], v[144:159]
    ds_read_b64_tr_b16 v[180:181], v4 offset:6144
    ds_read_b64_tr_b16 v[182:183], v4 offset:6400
    v_mfma_f32_32x32x16_bf16 v[160:175], v[80:83], v[196:199], v[160:175]
    ds_read_b64_tr_b16 v[184:185], v4 offset:10240
    ds_read_b64_tr_b16 v[186:187], v4 offset:10496
    s_waitcnt lgkmcnt(6)
    s_nop 0
    v_mfma_f32_32x32x16_bf16 v[128:143], v[84:87], v[200:203], v[128:143]
    ds_read_b64_tr_b16 v[188:189], v4 offset:3072
    ds_read_b64_tr_b16 v[190:191], v4 offset:3328
    v_mfma_f32_32x32x16_bf16 v[144:159], v[84:87], v[204:207], v[144:159]
    ds_read_b64_tr_b16 v[192:193], v4 offset:7168
    ds_read_b64_tr_b16 v[194:195], v4 offset:7424
    v_mfma_f32_32x32x16_bf16 v[160:175], v[84:87], v[208:211], v[160:175]
    ds_read_b64_tr_b16 v[196:197], v4 offset:11264
    ds_read_b64_tr_b16 v[198:199], v4 offset:11520
    s_cmp_lt_u32 s48, 2
    s_cbranch_scc1 L_nopb_33
    s_lshl_b32 s51, s44, 10
    s_nop 0
    s_add_u32 m0, s51, 122880
    s_mul_i32 s49, s81, 229376
    s_add_u32 s49, s49, s97
    s_nop 0
    s_add_u32 s49, s49, 128
    buffer_load_dwordx4 v8, s[16:19], s49 offen lds
L_nopb_33:
    s_waitcnt lgkmcnt(6)
    s_nop 0
    v_mfma_f32_32x32x16_bf16 v[128:143], v[88:91], v[176:179], v[128:143]
    ds_read_b64_tr_b16 v[200:201], v4 offset:12288
    ds_read_b64_tr_b16 v[202:203], v4 offset:12544
    v_mfma_f32_32x32x16_bf16 v[144:159], v[88:91], v[180:183], v[144:159]
    ds_read_b64_tr_b16 v[204:205], v4 offset:16384
    ds_read_b64_tr_b16 v[206:207], v4 offset:16640
    v_mfma_f32_32x32x16_bf16 v[160:175], v[88:91], v[184:187], v[160:175]
    ds_read_b64_tr_b16 v[208:209], v4 offset:20480
    ds_read_b64_tr_b16 v[210:211], v4 offset:20736
    s_cmp_lt_u32 s48, 2
    s_cbranch_scc1 L_nopb_34
    s_lshl_b32 s51, s44, 10
    s_nop 0
    s_add_u32 m0, s51, 126976
    s_mul_i32 s49, s81, 229376
    s_add_u32 s49, s49, s97
    s_nop 0
    s_add_u32 s49, s49, 114816
    buffer_load_dwordx4 v8, s[16:19], s49 offen lds
L_nopb_34:
    s_waitcnt lgkmcnt(6)
    s_nop 0
    v_mfma_f32_32x32x16_bf16 v[128:143], v[92:95], v[188:191], v[128:143]
    ds_read_b64_tr_b16 v[176:177], v4 offset:13312
    ds_read_b64_tr_b16 v[178:179], v4 offset:13568
    v_mfma_f32_32x32x16_bf16 v[144:159], v[92:95], v[192:195], v[144:159]
    ds_read_b64_tr_b16 v[180:181], v4 offset:17408
    ds_read_b64_tr_b16 v[182:183], v4 offset:17664
    v_mfma_f32_32x32x16_bf16 v[160:175], v[92:95], v[196:199], v[160:175]
    ds_read_b64_tr_b16 v[184:185], v4 offset:21504
    ds_read_b64_tr_b16 v[186:187], v4 offset:21760
    s_waitcnt lgkmcnt(6)
    s_nop 0
    v_mfma_f32_32x32x16_bf16 v[128:143], v[96:99], v[200:203], v[128:143]
    ds_read_b64_tr_b16 v[188:189], v4 offset:14336
    ds_read_b64_tr_b16 v[190:191], v4 offset:14592
    v_mfma_f32_32x32x16_bf16 v[144:159], v[96:99], v[204:207], v[144:159]
    ds_read_b64_tr_b16 v[192:193], v4 offset:18432
    ds_read_b64_tr_b16 v[194:195], v4 offset:18688
    v_mfma_f32_32x32x16_bf16 v[160:175], v[96:99], v[208:211], v[160:175]
    ds_read_b64_tr_b16 v[196:197], v4 offset:22528
    ds_read_b64_tr_b16 v[198:199], v4 offset:22784
    s_cmp_lt_u32 s48, 2
    s_cbranch_scc1 L_nopb_35
    s_lshl_b32 s51, s44, 10
    s_nop 0
    s_add_u32 m0, s51, 131072
    s_mul_i32 s49, s82, 229376
    s_add_u32 s49, s49, s97
    s_nop 0
    s_add_u32 s49, s49, 128
    buffer_load_dwordx4 v8, s[16:19], s49 offen lds
L_nopb_35:
    s_waitcnt lgkmcnt(6)
    s_nop 0
    v_mfma_f32_32x32x16_bf16 v[128:143], v[100:103], v[176:179], v[128:143]
    ds_read_b64_tr_b16 v[200:201], v4 offset:15360
    ds_read_b64_tr_b16 v[202:203], v4 offset:15616
    v_mfma_f32_32x32x16_bf16 v[144:159], v[100:103], v[180:183], v[144:159]
    ds_read_b64_tr_b16 v[204:205], v4 offset:19456
    ds_read_b64_tr_b16 v[206:207], v4 offset:19712
    v_mfma_f32_32x32x16_bf16 v[160:175], v[100:103], v[184:187], v[160:175]
    ds_read_b64_tr_b16 v[208:209], v4 offset:23552
    ds_read_b64_tr_b16 v[210:211], v4 offset:23808
    s_cmp_lt_u32 s48, 2
    s_cbranch_scc1 L_nopb_36
    s_lshl_b32 s51, s44, 10
    s_nop 0
    s_add_u32 m0, s51, 135168
    s_mul_i32 s49, s82, 229376
    s_add_u32 s49, s49, s97
    s_nop 0
    s_add_u32 s49, s49, 114816
    buffer_load_dwordx4 v8, s[16:19], s49 offen lds
L_nopb_36:
    s_waitcnt lgkmcnt(6)
    s_nop 0
    v_mfma_f32_32x32x16_bf16 v[128:143], v[104:107], v[188:191], v[128:143]
    ds_read_b64_tr_b16 v[176:177], v4 offset:24576
    ds_read_b64_tr_b16 v[178:179], v4 offset:24832
    v_mfma_f32_32x32x16_bf16 v[144:159], v[104:107], v[192:195], v[144:159]
    ds_read_b64_tr_b16 v[180:181], v4 offset:28672
    ds_read_b64_tr_b16 v[182:183], v4 offset:28928
    v_mfma_f32_32x32x16_bf16 v[160:175], v[104:107], v[196:199], v[160:175]
    ds_read_b64_tr_b16 v[184:185], v4 offset:32768
    ds_read_b64_tr_b16 v[186:187], v4 offset:33024
    s_waitcnt lgkmcnt(6)
    s_nop 0
    v_mfma_f32_32x32x16_bf16 v[128:143], v[108:111], v[200:203], v[128:143]
    ds_read_b64_tr_b16 v[188:189], v4 offset:25600
    ds_read_b64_tr_b16 v[190:191], v4 offset:25856
    v_mfma_f32_32x32x16_bf16 v[144:159], v[108:111], v[204:207], v[144:159]
    ds_read_b64_tr_b16 v[192:193], v4 offset:29696
    ds_read_b64_tr_b16 v[194:195], v4 offset:29952
    v_mfma_f32_32x32x16_bf16 v[160:175], v[108:111], v[208:211], v[160:175]
    ds_read_b64_tr_b16 v[196:197], v4 offset:33792
    ds_read_b64_tr_b16 v[198:199], v4 offset:34048
    s_cmp_lt_u32 s48, 2
    s_cbranch_scc1 L_nopb_37
    s_lshl_b32 s51, s44, 10
    s_nop 0
    s_add_u32 m0, s51, 139264
    s_mul_i32 s49, s83, 229376
    s_add_u32 s49, s49, s97
    s_nop 0
    s_add_u32 s49, s49, 128
    buffer_load_dwordx4 v8, s[16:19], s49 offen lds
L_nopb_37:
    s_waitcnt lgkmcnt(6)
    s_nop 0
    v_mfma_f32_32x32x16_bf16 v[128:143], v[112:115], v[176:179], v[128:143]
    ds_read_b64_tr_b16 v[200:201], v4 offset:26624
    ds_read_b64_tr_b16 v[202:203], v4 offset:26880
    v_mfma_f32_32x32x16_bf16 v[144:159], v[112:115], v[180:183], v[144:159]
    ds_read_b64_tr_b16 v[204:205], v4 offset:30720
    ds_read_b64_tr_b16 v[206:207], v4 offset:30976
    v_mfma_f32_32x32x16_bf16 v[160:175], v[112:115], v[184:187], v[160:175]
    ds_read_b64_tr_b16 v[208:209], v4 offset:34816
    ds_read_b64_tr_b16 v[210:211], v4 offset:35072
    s_cmp_lt_u32 s48, 2
    s_cbranch_scc1 L_nopb_38
    s_lshl_b32 s51, s44, 10
    s_nop 0
    s_add_u32 m0, s51, 143360
    s_mul_i32 s49, s83, 229376
    s_add_u32 s49, s49, s97
    s_nop 0
    s_add_u32 s49, s49, 114816
    buffer_load_dwordx4 v8, s[16:19], s49 offen lds
L_nopb_38:
    s_waitcnt lgkmcnt(6)
    s_nop 0
    v_mfma_f32_32x32x16_bf16 v[128:143], v[116:119], v[188:191], v[128:143]
    ds_read_b64_tr_b16 v[176:177], v4 offset:27648
    ds_read_b64_tr_b16 v[178:179], v4 offset:27904
    v_mfma_f32_32x32x16_bf16 v[144:159], v[116:119], v[192:195], v[144:159]
    ds_read_b64_tr_b16 v[180:181], v4 offset:31744
    ds_read_b64_tr_b16 v[182:183], v4 offset:32000
    v_mfma_f32_32x32x16_bf16 v[160:175], v[116:119], v[196:199], v[160:175]
    ds_read_b64_tr_b16 v[184:185], v4 offset:35840
    ds_read_b64_tr_b16 v[186:187], v4 offset:36096
    s_waitcnt lgkmcnt(6)
    s_nop 0
    v_mfma_f32_32x32x16_bf16 v[128:143], v[120:123], v[200:203], v[128:143]
    v_mfma_f32_32x32x16_bf16 v[144:159], v[120:123], v[204:207], v[144:159]
    v_mfma_f32_32x32x16_bf16 v[160:175], v[120:123], v[208:211], v[160:175]
    s_cmp_lt_u32 s48, 2
    s_cbranch_scc1 L_nopb_39
    s_lshl_b32 s51, s44, 10
    s_nop 0
    s_add_u32 m0, s51, 147456
    s_mul_i32 s49, s84, 229376
    s_add_u32 s49, s49, s97
    s_nop 0
    s_add_u32 s49, s49, 128
    buffer_load_dwordx4 v8, s[16:19], s49 offen lds
L_nopb_39:
    s_waitcnt lgkmcnt(0)
    s_nop 0
    v_mfma_f32_32x32x16_bf16 v[128:143], v[124:127], v[176:179], v[128:143]
    v_mfma_f32_32x32x16_bf16 v[144:159], v[124:127], v[180:183], v[144:159]
    v_mfma_f32_32x32x16_bf16 v[160:175], v[124:127], v[184:187], v[160:175]
L_gemm_done:
    s_nop 5
    s_cmp_eq_u32 s77, 2
    s_cbranch_scc1 L_noscale_0
    s_cmp_eq_u32 s77, 0
    s_cbranch_scc1 L_qscale_0
    s_nop 0
    v_pk_mul_f32 v[128:129], v[128:129], v[232:233] op_sel_hi:[1,0]
    v_pk_mul_f32 v[130:131], v[130:131], v[232:233] op_sel_hi:[1,0]
    v_pk_mul_f32 v[132:133], v[132:133], v[232:233] op_sel_hi:[1,0]
    v_pk_mul_f32 v[134:135], v[134:135], v[232:233] op_sel_hi:[1,0]
    v_pk_mul_f32 v[136:137], v[136:137], v[232:233] op_sel_hi:[1,0]
    v_pk_mul_f32 v[138:139], v[138:139], v[232:233] op_sel_hi:[1,0]
    v_pk_mul_f32 v[140:141], v[140:141], v[232:233] op_sel_hi:[1,0]
    v_pk_mul_f32 v[142:143], v[142:143], v[232:233] op_sel_hi:[1,0]
    s_branch L_noscale_0
L_qscale_0:
    s_nop 0
    v_pk_mul_f32 v[128:129], v[128:129], v[234:235] op_sel_hi:[1,0]
    v_pk_mul_f32 v[130:131], v[130:131], v[234:235] op_sel_hi:[1,0]
    v_pk_mul_f32 v[132:133], v[132:133], v[234:235] op_sel_hi:[1,0]
    v_pk_mul_f32 v[134:135], v[134:135], v[234:235] op_sel_hi:[1,0]
    v_pk_mul_f32 v[136:137], v[136:137], v[234:235] op_sel_hi:[1,0]
    v_pk_mul_f32 v[138:139], v[138:139], v[234:235] op_sel_hi:[1,0]
    v_pk_mul_f32 v[140:141], v[140:141], v[234:235] op_sel_hi:[1,0]
    v_pk_mul_f32 v[142:143], v[142:143], v[234:235] op_sel_hi:[1,0]
L_noscale_0:
    v_cvt_pk_bf16_f32 v212, v128, v129
    v_cvt_pk_bf16_f32 v213, v130, v131
    v_cvt_pk_bf16_f32 v214, v132, v133
    v_cvt_pk_bf16_f32 v215, v134, v135
    v_cvt_pk_bf16_f32 v216, v136, v137
    v_cvt_pk_bf16_f32 v217, v138, v139
    v_cvt_pk_bf16_f32 v218, v140, v141
    v_cvt_pk_bf16_f32 v219, v142, v143
    s_cmp_eq_u32 s77, 2
    s_cbranch_scc1 L_padv_0
    s_mul_i32 s51, s77, 0x3f80
    s_mov_b32 exec_lo, 0
    v_mov_b32 v218, s51
    v_mov_b32 v219, 0
    s_mov_b32 exec_lo, -1
    s_branch L_padd_0
L_padv_0:
    s_nop 0
    s_mov_b32 exec_lo, 0x10000000
    s_mov_b32 exec_hi, 0x10000000
    v_mov_b32 v212, s54
    v_mov_b32 v213, s54
    v_mov_b32 v214, s54
    v_mov_b32 v215, s54
    v_mov_b32 v216, s54
    v_mov_b32 v217, s54
    v_mov_b32 v218, s54
    v_mov_b32 v219, s54
    s_mov_b64 exec, -1
L_padd_0:
    s_nop 0
    buffer_store_dwordx4 v[212:215], v2, s[4:7], s74 offen sc1
    buffer_store_dwordx4 v[216:219], v2, s[4:7], s74 offen offset:1024 sc1
    s_cmp_eq_u32 s78, 2
    s_cbranch_scc1 L_noscale_1
    s_cmp_eq_u32 s78, 0
    s_cbranch_scc1 L_qscale_1
    v_pk_mul_f32 v[144:145], v[144:145], v[232:233] op_sel_hi:[1,0]
    v_pk_mul_f32 v[146:147], v[146:147], v[232:233] op_sel_hi:[1,0]
    v_pk_mul_f32 v[148:149], v[148:149], v[232:233] op_sel_hi:[1,0]
    v_pk_mul_f32 v[150:151], v[150:151], v[232:233] op_sel_hi:[1,0]
    v_pk_mul_f32 v[152:153], v[152:153], v[232:233] op_sel_hi:[1,0]
    v_pk_mul_f32 v[154:155], v[154:155], v[232:233] op_sel_hi:[1,0]
    v_pk_mul_f32 v[156:157], v[156:157], v[232:233] op_sel_hi:[1,0]
    v_pk_mul_f32 v[158:159], v[158:159], v[232:233] op_sel_hi:[1,0]
    s_branch L_noscale_1
L_qscale_1:
    s_nop 0
    v_pk_mul_f32 v[144:145], v[144:145], v[234:235] op_sel_hi:[1,0]
    v_pk_mul_f32 v[146:147], v[146:147], v[234:235] op_sel_hi:[1,0]
    v_pk_mul_f32 v[148:149], v[148:149], v[234:235] op_sel_hi:[1,0]
    v_pk_mul_f32 v[150:151], v[150:151], v[234:235] op_sel_hi:[1,0]
    v_pk_mul_f32 v[152:153], v[152:153], v[234:235] op_sel_hi:[1,0]
    v_pk_mul_f32 v[154:155], v[154:155], v[234:235] op_sel_hi:[1,0]
    v_pk_mul_f32 v[156:157], v[156:157], v[234:235] op_sel_hi:[1,0]
    v_pk_mul_f32 v[158:159], v[158:159], v[234:235] op_sel_hi:[1,0]
L_noscale_1:
    v_cvt_pk_bf16_f32 v220, v144, v145
    v_cvt_pk_bf16_f32 v221, v146, v147
    v_cvt_pk_bf16_f32 v222, v148, v149
    v_cvt_pk_bf16_f32 v223, v150, v151
    v_cvt_pk_bf16_f32 v224, v152, v153
    v_cvt_pk_bf16_f32 v225, v154, v155
    v_cvt_pk_bf16_f32 v226, v156, v157
    v_cvt_pk_bf16_f32 v227, v158, v159
    s_cmp_eq_u32 s78, 2
    s_cbranch_scc1 L_padv_1
    s_mul_i32 s51, s78, 0x3f80
    s_mov_b32 exec_lo, 0
    v_mov_b32 v226, s51
    v_mov_b32 v227, 0
    s_mov_b32 exec_lo, -1
    s_branch L_padd_1
L_padv_1:
    s_nop 0
    s_mov_b32 exec_lo, 0x10000000
    s_mov_b32 exec_hi, 0x10000000
    v_mov_b32 v220, s54
    v_mov_b32 v221, s54
    v_mov_b32 v222, s54
    v_mov_b32 v223, s54
    v_mov_b32 v224, s54
    v_mov_b32 v225, s54
    v_mov_b32 v226, s54
    v_mov_b32 v227, s54
    s_mov_b64 exec, -1
L_padd_1:
    s_nop 0
    buffer_store_dwordx4 v[220:223], v2, s[4:7], s75 offen sc1
    buffer_store_dwordx4 v[224:227], v2, s[4:7], s75 offen offset:1024 sc1
    s_cmp_eq_u32 s79, 2
    s_cbranch_scc1 L_noscale_2
    s_cmp_eq_u32 s79, 0
    s_cbranch_scc1 L_qscale_2
    v_pk_mul_f32 v[160:161], v[160:161], v[232:233] op_sel_hi:[1,0]
    v_pk_mul_f32 v[162:163], v[162:163], v[232:233] op_sel_hi:[1,0]
    v_pk_mul_f32 v[164:165], v[164:165], v[232:233] op_sel_hi:[1,0]
    v_pk_mul_f32 v[166:167], v[166:167], v[232:233] op_sel_hi:[1,0]
    v_pk_mul_f32 v[168:169], v[168:169], v[232:233] op_sel_hi:[1,0]
    v_pk_mul_f32 v[170:171], v[170:171], v[232:233] op_sel_hi:[1,0]
    v_pk_mul_f32 v[172:173], v[172:173], v[232:233] op_sel_hi:[1,0]
    v_pk_mul_f32 v[174:175], v[174:175], v[232:233] op_sel_hi:[1,0]
    s_branch L_noscale_2
L_qscale_2:
    s_nop 0
    v_pk_mul_f32 v[160:161], v[160:161], v[234:235] op_sel_hi:[1,0]
    v_pk_mul_f32 v[162:163], v[162:163], v[234:235] op_sel_hi:[1,0]
    v_pk_mul_f32 v[164:165], v[164:165], v[234:235] op_sel_hi:[1,0]
    v_pk_mul_f32 v[166:167], v[166:167], v[234:235] op_sel_hi:[1,0]
    v_pk_mul_f32 v[168:169], v[168:169], v[234:235] op_sel_hi:[1,0]
    v_pk_mul_f32 v[170:171], v[170:171], v[234:235] op_sel_hi:[1,0]
    v_pk_mul_f32 v[172:173], v[172:173], v[234:235] op_sel_hi:[1,0]
    v_pk_mul_f32 v[174:175], v[174:175], v[234:235] op_sel_hi:[1,0]
L_noscale_2:
    v_cvt_pk_bf16_f32 v212, v160, v161
    v_cvt_pk_bf16_f32 v213, v162, v163
    v_cvt_pk_bf16_f32 v214, v164, v165
    v_cvt_pk_bf16_f32 v215, v166, v167
    v_cvt_pk_bf16_f32 v216, v168, v169
    v_cvt_pk_bf16_f32 v217, v170, v171
    v_cvt_pk_bf16_f32 v218, v172, v173
    v_cvt_pk_bf16_f32 v219, v174, v175
    s_cmp_eq_u32 s79, 2
    s_cbranch_scc1 L_padv_2
    s_mul_i32 s51, s79, 0x3f80
    s_mov_b32 exec_lo, 0
    v_mov_b32 v218, s51
    v_mov_b32 v219, 0
    s_mov_b32 exec_lo, -1
    s_branch L_padd_2
L_padv_2:
    s_nop 0
    s_mov_b32 exec_lo, 0x10000000
    s_mov_b32 exec_hi, 0x10000000
    v_mov_b32 v212, s54
    v_mov_b32 v213, s54
    v_mov_b32 v214, s54
    v_mov_b32 v215, s54
    v_mov_b32 v216, s54
    v_mov_b32 v217, s54
    v_mov_b32 v218, s54
    v_mov_b32 v219, s54
    s_mov_b64 exec, -1
L_padd_2:
    s_nop 0
    buffer_store_dwordx4 v[212:215], v2, s[4:7], s76 offen sc1
    buffer_store_dwordx4 v[216:219], v2, s[4:7], s76 offen offset:1024 sc1
    v_mov_b32_e64 v12, 0
    buffer_load_dword v13, v12, s[40:43], 0 offen sc1
    v_mov_b32 v232, 0
    v_mov_b32 v233, 0
    v_mov_b32 v234, 0
    v_mov_b32 v235, 0
    v_mov_b32 v236, 0
    v_mov_b32 v237, 0
    v_mov_b32 v238, 0
    v_mov_b32 v239, 0
    v_mov_b32 v240, 0
    v_mov_b32 v241, 0
    v_mov_b32_e64 v242, 0
    v_mov_b32 v243, 0
    s_mov_b32 exec_hi, 0
    v_mov_b32 v240, 0x3f80
    s_mov_b32 exec_hi, -1
    s_nop 0
    v_add_u32 v6, 67584, v5
    v_add_u32 v9, 114688, v5
    s_waitcnt vmcnt(7)
    s_barrier
    ds_read_b64_tr_b16 v[192:193], v5 offset:0
    ds_read_b64_tr_b16 v[194:195], v5 offset:256
    ds_read_b64_tr_b16 v[196:197], v5 offset:512
    ds_read_b64_tr_b16 v[198:199], v5 offset:768
    ds_read_b64_tr_b16 v[200:201], v5 offset:2048
    ds_read_b64_tr_b16 v[202:203], v5 offset:2304
    ds_read_b64_tr_b16 v[204:205], v5 offset:2560
    ds_read_b64_tr_b16 v[206:207], v5 offset:2816
    v_mov_b32_e64 v232, v244
    v_mov_b32 v236, v245
    s_nop 1
    v_mfma_f32_32x32x16_bf16 v[128:143], v[232:235], v[240:243], 0
    v_mfma_f32_32x32x16_bf16 v[144:159], v[236:239], v[240:243], 0
    s_waitcnt lgkmcnt(4)
    s_nop 0
    v_mfma_f32_32x32x16_bf16 v[128:143], v[192:195], v[16:19], v[128:143]
    ds_read_b64_tr_b16 v[208:209], v5 offset:4096
    ds_read_b64_tr_b16 v[210:211], v5 offset:4352
    v_mfma_f32_32x32x16_bf16 v[144:159], v[196:199], v[16:19], v[144:159]
    ds_read_b64_tr_b16 v[212:213], v5 offset:4608
    ds_read_b64_tr_b16 v[214:215], v5 offset:4864
    s_cmp_lt_u32 s48, 2
    s_cbranch_scc1 L_nopb_40
    s_lshl_b32 s51, s44, 10
    s_nop 0
    s_add_u32 m0, s51, 151552
    s_mul_i32 s49, s84, 229376
    s_add_u32 s49, s49, s97
    s_nop 0
    s_add_u32 s49, s49, 114816
    buffer_load_dwordx4 v8, s[16:19], s49 offen lds
L_nopb_40:
    s_waitcnt lgkmcnt(4)
    s_nop 0
    v_mfma_f32_32x32x16_bf16 v[128:143], v[200:203], v[20:23], v[128:143]
    ds_read_b64_tr_b16 v[192:193], v5 offset:6144
    ds_read_b64_tr_b16 v[194:195], v5 offset:6400
    v_mfma_f32_32x32x16_bf16 v[144:159], v[204:207], v[20:23], v[144:159]
    ds_read_b64_tr_b16 v[196:197], v5 offset:6656
    ds_read_b64_tr_b16 v[198:199], v5 offset:6912
    s_waitcnt lgkmcnt(4)
    s_nop 0
    v_mfma_f32_32x32x16_bf16 v[128:143], v[208:211], v[24:27], v[128:143]
    ds_read_b64_tr_b16 v[200:201], v5 offset:8192
    ds_read_b64_tr_b16 v[202:203], v5 offset:8448
    v_mfma_f32_32x32x16_bf16 v[144:159], v[212:215], v[24:27], v[144:159]
    ds_read_b64_tr_b16 v[204:205], v5 offset:8704
    ds_read_b64_tr_b16 v[206:207], v5 offset:8960
    s_cmp_lt_u32 s48, 2
    s_cbranch_scc1 L_nopb_41
    s_lshl_b32 s51, s44, 10
    s_nop 0
    s_add_u32 m0, s51, 155648
    s_mul_i32 s49, s85, 229376
    s_add_u32 s49, s49, s97
    s_nop 0
    s_add_u32 s49, s49, 128
    buffer_load_dwordx4 v8, s[16:19], s49 offen lds
L_nopb_41:
    s_waitcnt lgkmcnt(4)
    s_nop 0
    v_mfma_f32_32x32x16_bf16 v[128:143], v[192:195], v[28:31], v[128:143]
    ds_read_b64_tr_b16 v[208:209], v5 offset:10240
    ds_read_b64_tr_b16 v[210:211], v5 offset:10496
    v_mfma_f32_32x32x16_bf16 v[144:159], v[196:199], v[28:31], v[144:159]
    ds_read_b64_tr_b16 v[212:213], v5 offset:10752
    ds_read_b64_tr_b16 v[214:215], v5 offset:11008
    s_waitcnt lgkmcnt(4)
    s_nop 0
    v_mfma_f32_32x32x16_bf16 v[128:143], v[200:203], v[32:35], v[128:143]
    ds_read_b64_tr_b16 v[192:193], v5 offset:12288
    ds_read_b64_tr_b16 v[194:195], v5 offset:12544
    v_mfma_f32_32x32x16_bf16 v[144:159], v[204:207], v[32:35], v[144:159]
    ds_read_b64_tr_b16 v[196:197], v5 offset:12800
    ds_read_b64_tr_b16 v[198:199], v5 offset:13056
    s_cmp_lt_u32 s48, 2
    s_cbranch_scc1 L_nopb_42
    s_lshl_b32 s51, s44, 10
    s_nop 0
    s_add_u32 m0, s51, 159744
    s_mul_i32 s49, s85, 229376
    s_add_u32 s49, s49, s97
    s_nop 0
    s_add_u32 s49, s49, 114816
    buffer_load_dwordx4 v8, s[16:19], s49 offen lds
L_nopb_42:
    s_waitcnt lgkmcnt(4)
    s_nop 0
    v_mfma_f32_32x32x16_bf16 v[128:143], v[208:211], v[36:39], v[128:143]
    ds_read_b64_tr_b16 v[200:201], v5 offset:14336
    ds_read_b64_tr_b16 v[202:203], v5 offset:14592
    v_mfma_f32_32x32x16_bf16 v[144:159], v[212:215], v[36:39], v[144:159]
    ds_read_b64_tr_b16 v[204:205], v5 offset:14848
    ds_read_b64_tr_b16 v[206:207], v5 offset:15104
    s_waitcnt lgkmcnt(4)
    s_nop 0
    v_mfma_f32_32x32x16_bf16 v[128:143], v[192:195], v[40:43], v[128:143]
    ds_read_b64_tr_b16 v[208:209], v5 offset:16384
    ds_read_b64_tr_b16 v[210:211], v5 offset:16640
    v_mfma_f32_32x32x16_bf16 v[144:159], v[196:199], v[40:43], v[144:159]
    ds_read_b64_tr_b16 v[212:213], v5 offset:16896
    ds_read_b64_tr_b16 v[214:215], v5 offset:17152
    s_cmp_lt_u32 s48, 2
    s_cbranch_scc1 L_nopb_43
    s_lshl_b32 s51, s44, 10
    s_nop 0
    s_add_u32 m0, s51, 67584
    s_mul_i32 s49, s86, 229376
    s_add_u32 s49, s49, s97
    s_nop 0
    s_add_u32 s49, s49, 128
    buffer_load_dwordx4 v8, s[16:19], s49 offen lds
L_nopb_43:
    s_waitcnt lgkmcnt(4)
    s_nop 0
    v_mfma_f32_32x32x16_bf16 v[128:143], v[200:203], v[44:47], v[128:143]
    ds_read_b64_tr_b16 v[192:193], v5 offset:18432
    ds_read_b64_tr_b16 v[194:195], v5 offset:18688
    v_mfma_f32_32x32x16_bf16 v[144:159], v[204:207], v[44:47], v[144:159]
    ds_read_b64_tr_b16 v[196:197], v5 offset:18944
    ds_read_b64_tr_b16 v[198:199], v5 offset:19200
    s_waitcnt lgkmcnt(4)
    s_nop 0
    v_mfma_f32_32x32x16_bf16 v[128:143], v[208:211], v[48:51], v[128:143]
    ds_read_b64_tr_b16 v[200:201], v5 offset:20480
    ds_read_b64_tr_b16 v[202:203], v5 offset:20736
    v_mfma_f32_32x32x16_bf16 v[144:159], v[212:215], v[48:51], v[144:159]
    ds_read_b64_tr_b16 v[204:205], v5 offset:20992
    ds_read_b64_tr_b16 v[206:207], v5 offset:21248
    s_cmp_lt_u32 s48, 2
    s_cbranch_scc1 L_nopb_44
    s_lshl_b32 s51, s44, 10
    s_nop 0
    s_add_u32 m0, s51, 71680
    s_mul_i32 s49, s86, 229376
    s_add_u32 s49, s49, s97
    s_nop 0
    s_add_u32 s49, s49, 114816
    buffer_load_dwordx4 v8, s[16:19], s49 offen lds
L_nopb_44:
    s_waitcnt lgkmcnt(4)
    s_nop 0
    v_mfma_f32_32x32x16_bf16 v[128:143], v[192:195], v[52:55], v[128:143]
    ds_read_b64_tr_b16 v[208:209], v5 offset:22528
    ds_read_b64_tr_b16 v[210:211], v5 offset:22784
    v_mfma_f32_32x32x16_bf16 v[144:159], v[196:199], v[52:55], v[144:159]
    ds_read_b64_tr_b16 v[212:213], v5 offset:23040
    ds_read_b64_tr_b16 v[214:215], v5 offset:23296
    s_waitcnt lgkmcnt(4)
    s_nop 0
    v_mfma_f32_32x32x16_bf16 v[128:143], v[200:203], v[56:59], v[128:143]
    ds_read_b64_tr_b16 v[192:193], v5 offset:24576
    ds_read_b64_tr_b16 v[194:195], v5 offset:24832
    v_mfma_f32_32x32x16_bf16 v[144:159], v[204:207], v[56:59], v[144:159]
    ds_read_b64_tr_b16 v[196:197], v5 offset:25088
    ds_read_b64_tr_b16 v[198:199], v5 offset:25344
    s_waitcnt lgkmcnt(4)
    s_nop 0
    v_mfma_f32_32x32x16_bf16 v[128:143], v[208:211], v[60:63], v[128:143]
    ds_read_b64_tr_b16 v[200:201], v5 offset:26624
    ds_read_b64_tr_b16 v[202:203], v5 offset:26880
    v_mfma_f32_32x32x16_bf16 v[144:159], v[212:215], v[60:63], v[144:159]
    ds_read_b64_tr_b16 v[204:205], v5 offset:27136
    ds_read_b64_tr_b16 v[206:207], v5 offset:27392
    s_waitcnt lgkmcnt(4)
    s_nop 0
    v_mfma_f32_32x32x16_bf16 v[128:143], v[192:195], v[64:67], v[128:143]
    ds_read_b64_tr_b16 v[208:209], v5 offset:28672
    ds_read_b64_tr_b16 v[210:211], v5 offset:28928
    v_mfma_f32_32x32x16_bf16 v[144:159], v[196:199], v[64:67], v[144:159]
    ds_read_b64_tr_b16 v[212:213], v5 offset:29184
    ds_read_b64_tr_b16 v[214:215], v5 offset:29440
    s_waitcnt vmcnt(0)
    s_mov_b32 s72, 0
    v_readfirstlane_b32 s49, v13
    s_cmp_lg_u32 s49, 0
    s_cbranch_scc1 L_dbgspin_45_ok
L_dbgspin_45:
    s_nop 0
    buffer_load_dword v13, v12, s[40:43], 0 offen sc1
    s_waitcnt vmcnt(0)
    v_readfirstlane_b32 s49, v13
    s_cmp_lg_u32 s49, 0
    s_cbranch_scc1 L_dbgspin_45_ok
    s_add_u32 s72, s72, 1
    s_nop 0
    s_cmp_lt_u32 s72, 1000000
    s_cbranch_scc1 L_dbgspin_45
    s_endpgm
L_dbgspin_45_ok:
    s_barrier
    s_cmp_lg_u32 s44, 0
    s_cbranch_scc1 L_dbgspin_45_np
    s_lshl_b32 s49, s46, 7
    s_add_u32 s49, s49, 16777216
    v_mov_b32 v14, 1
    s_mov_b64 exec, 1
    buffer_atomic_add v14, v12, s[4:7], s49 offen sc1
    s_mov_b64 exec, -1
L_dbgspin_45_np:
    s_waitcnt lgkmcnt(4)
    v_mfma_f32_32x32x16_bf16 v[128:143], v[200:203], v[68:71], v[128:143]
    ds_read_b64_tr_b16 v[192:193], v5 offset:30720
    ds_read_b64_tr_b16 v[194:195], v5 offset:30976
    v_mfma_f32_32x32x16_bf16 v[144:159], v[204:207], v[68:71], v[144:159]
    ds_read_b64_tr_b16 v[196:197], v5 offset:31232
    ds_read_b64_tr_b16 v[198:199], v5 offset:31488
    s_waitcnt lgkmcnt(4)
    s_nop 0
    v_mfma_f32_32x32x16_bf16 v[128:143], v[208:211], v[72:75], v[128:143]
    ds_read_b64_tr_b16 v[200:201], v5 offset:32768
    ds_read_b64_tr_b16 v[202:203], v5 offset:33024
    v_mfma_f32_32x32x16_bf16 v[144:159], v[212:215], v[72:75], v[144:159]
    ds_read_b64_tr_b16 v[204:205], v5 offset:33280
    ds_read_b64_tr_b16 v[206:207], v5 offset:33536
    s_waitcnt lgkmcnt(4)
    s_nop 0
    v_mfma_f32_32x32x16_bf16 v[128:143], v[192:195], v[76:79], v[128:143]
    ds_read_b64_tr_b16 v[208:209], v5 offset:34816
    ds_read_b64_tr_b16 v[210:211], v5 offset:35072
    v_mfma_f32_32x32x16_bf16 v[144:159], v[196:199], v[76:79], v[144:159]
    ds_read_b64_tr_b16 v[212:213], v5 offset:35328
    ds_read_b64_tr_b16 v[214:215], v5 offset:35584
    s_waitcnt lgkmcnt(4)
    s_nop 0
    v_mfma_f32_32x32x16_bf16 v[128:143], v[200:203], v[80:83], v[128:143]
    ds_read_b64_tr_b16 v[192:193], v5 offset:36864
    ds_read_b64_tr_b16 v[194:195], v5 offset:37120
    v_mfma_f32_32x32x16_bf16 v[144:159], v[204:207], v[80:83], v[144:159]
    ds_read_b64_tr_b16 v[196:197], v5 offset:37376
    ds_read_b64_tr_b16 v[198:199], v5 offset:37632
    s_waitcnt lgkmcnt(4)
    s_nop 0
    v_mfma_f32_32x32x16_bf16 v[128:143], v[208:211], v[84:87], v[128:143]
    ds_read_b64_tr_b16 v[200:201], v5 offset:38912
    ds_read_b64_tr_b16 v[202:203], v5 offset:39168
    v_mfma_f32_32x32x16_bf16 v[144:159], v[212:215], v[84:87], v[144:159]
    ds_read_b64_tr_b16 v[204:205], v5 offset:39424
    ds_read_b64_tr_b16 v[206:207], v5 offset:39680
    s_waitcnt lgkmcnt(4)
    s_nop 0
    v_mfma_f32_32x32x16_bf16 v[128:143], v[192:195], v[88:91], v[128:143]
    ds_read_b64_tr_b16 v[208:209], v5 offset:40960
    ds_read_b64_tr_b16 v[210:211], v5 offset:41216
    v_mfma_f32_32x32x16_bf16 v[144:159], v[196:199], v[88:91], v[144:159]
    ds_read_b64_tr_b16 v[212:213], v5 offset:41472
    ds_read_b64_tr_b16 v[214:215], v5 offset:41728
    s_waitcnt lgkmcnt(4)
    s_nop 0
    v_mfma_f32_32x32x16_bf16 v[128:143], v[200:203], v[92:95], v[128:143]
    ds_read_b64_tr_b16 v[192:193], v5 offset:43008
    ds_read_b64_tr_b16 v[194:195], v5 offset:43264
    v_mfma_f32_32x32x16_bf16 v[144:159], v[204:207], v[92:95], v[144:159]
    ds_read_b64_tr_b16 v[196:197], v5 offset:43520
    ds_read_b64_tr_b16 v[198:199], v5 offset:43776
    s_waitcnt lgkmcnt(4)
    s_nop 0
    v_mfma_f32_32x32x16_bf16 v[128:143], v[208:211], v[96:99], v[128:143]
    ds_read_b64_tr_b16 v[200:201], v5 offset:45056
    ds_read_b64_tr_b16 v[202:203], v5 offset:45312
    v_mfma_f32_32x32x16_bf16 v[144:159], v[212:215], v[96:99], v[144:159]
    ds_read_b64_tr_b16 v[204:205], v5 offset:45568
    ds_read_b64_tr_b16 v[206:207], v5 offset:45824
    s_waitcnt lgkmcnt(4)
    s_nop 0
    v_mfma_f32_32x32x16_bf16 v[128:143], v[192:195], v[100:103], v[128:143]
    ds_read_b64_tr_b16 v[208:209], v5 offset:47104
    ds_read_b64_tr_b16 v[210:211], v5 offset:47360
    v_mfma_f32_32x32x16_bf16 v[144:159], v[196:199], v[100:103], v[144:159]
    ds_read_b64_tr_b16 v[212:213], v5 offset:47616
    ds_read_b64_tr_b16 v[214:215], v5 offset:47872
    s_waitcnt lgkmcnt(4)
    s_nop 0
    v_mfma_f32_32x32x16_bf16 v[128:143], v[200:203], v[104:107], v[128:143]
    ds_read_b64_tr_b16 v[192:193], v5 offset:49152
    ds_read_b64_tr_b16 v[194:195], v5 offset:49408
    v_mfma_f32_32x32x16_bf16 v[144:159], v[204:207], v[104:107], v[144:159]
    ds_read_b64_tr_b16 v[196:197], v5 offset:49664
    ds_read_b64_tr_b16 v[198:199], v5 offset:49920
    s_waitcnt lgkmcnt(4)
    s_nop 0
    v_mfma_f32_32x32x16_bf16 v[128:143], v[208:211], v[108:111], v[128:143]
    ds_read_b64_tr_b16 v[200:201], v5 offset:51200
    ds_read_b64_tr_b16 v[202:203], v5 offset:51456
    v_mfma_f32_32x32x16_bf16 v[144:159], v[212:215], v[108:111], v[144:159]
    ds_read_b64_tr_b16 v[204:205], v5 offset:51712
    ds_read_b64_tr_b16 v[206:207], v5 offset:51968
    s_lshl_b32 s49, s57, 17
    s_lshl_b32 s50, s58, 13
    s_add_u32 s63, s49, s50
    s_add_u32 s63, s63, 0
    s_lshl_b32 s49, s57, 18
    s_nop 0
    s_add_u32 s73, s49, 2097152
    s_lshl_b32 s50, s44, 16
    s_add_u32 s61, s73, s50
    s_cmp_lt_u32 s48, 2
    s_cbranch_scc1 L_one_pair
    s_waitcnt vmcnt(0)
    s_barrier
    s_waitcnt lgkmcnt(4)
    s_nop 0
    v_mfma_f32_32x32x16_bf16 v[128:143], v[192:195], v[112:115], v[128:143]
    ds_read_b64_tr_b16 v[208:209], v5 offset:53248
    ds_read_b64_tr_b16 v[210:211], v5 offset:53504
    v_mfma_f32_32x32x16_bf16 v[144:159], v[196:199], v[112:115], v[144:159]
    ds_read_b64_tr_b16 v[212:213], v5 offset:53760
    ds_read_b64_tr_b16 v[214:215], v5 offset:54016
    s_waitcnt lgkmcnt(4)
    s_nop 0
    v_mfma_f32_32x32x16_bf16 v[128:143], v[200:203], v[116:119], v[128:143]
    ds_read_b64_tr_b16 v[192:193], v5 offset:55296
    ds_read_b64_tr_b16 v[194:195], v5 offset:55552
    v_mfma_f32_32x32x16_bf16 v[144:159], v[204:207], v[116:119], v[144:159]
    ds_read_b64_tr_b16 v[196:197], v5 offset:55808
    ds_read_b64_tr_b16 v[198:199], v5 offset:56064
    s_waitcnt lgkmcnt(4)
    s_nop 0
    v_mfma_f32_32x32x16_bf16 v[128:143], v[208:211], v[120:123], v[128:143]
    ds_read_b64_tr_b16 v[200:201], v9 offset:0
    ds_read_b64_tr_b16 v[202:203], v9 offset:256
    v_mfma_f32_32x32x16_bf16 v[144:159], v[212:215], v[120:123], v[144:159]
    ds_read_b64_tr_b16 v[204:205], v9 offset:512
    ds_read_b64_tr_b16 v[206:207], v9 offset:768
    v_mov_b32_e64 v232, v246
    v_mov_b32 v236, v247
    s_nop 1
    v_mfma_f32_32x32x16_bf16 v[160:175], v[232:235], v[240:243], 0
    v_mfma_f32_32x32x16_bf16 v[176:191], v[236:239], v[240:243], 0
    s_waitcnt lgkmcnt(4)
    s_nop 0
    v_mfma_f32_32x32x16_bf16 v[128:143], v[192:195], v[124:127], v[128:143]
    ds_read_b64_tr_b16 v[208:209], v9 offset:2048
    ds_read_b64_tr_b16 v[210:211], v9 offset:2304
    v_mfma_f32_32x32x16_bf16 v[144:159], v[196:199], v[124:127], v[144:159]
    ds_read_b64_tr_b16 v[212:213], v9 offset:2560
    ds_read_b64_tr_b16 v[214:215], v9 offset:2816
    s_lshl_b32 s49, s47, 1
    s_lshl_b32 s50, s45, 2
    s_add_u32 s50, s50, s44
    s_mul_i32 s50, s50, 56
    s_add_u32 s49, s49, s50
    s_lshl_b32 s49, s49, 11
    s_add_u32 s53, s49, 8388608
    s_waitcnt lgkmcnt(4)
    s_nop 0
    v_mfma_f32_32x32x16_bf16 v[160:175], v[200:203], v[16:19], v[160:175]
    ds_read_b64_tr_b16 v[192:193], v9 offset:4096
    ds_read_b64_tr_b16 v[194:195], v9 offset:4352
    s_nop 0
    s_nop 0
    s_nop 0
    s_nop 0
    v_mfma_f32_32x32x16_bf16 v[176:191], v[204:207], v[16:19], v[176:191]
    ds_read_b64_tr_b16 v[196:197], v9 offset:4608
    ds_read_b64_tr_b16 v[198:199], v9 offset:4864
    v_max_f32_e64 v128, 0, v128
    v_max_f32 v129, 0, v129
    s_waitcnt lgkmcnt(4)
    v_mfma_f32_32x32x16_bf16 v[160:175], v[208:211], v[20:23], v[160:175]
    ds_read_b64_tr_b16 v[200:201], v9 offset:6144
    ds_read_b64_tr_b16 v[202:203], v9 offset:6400
    v_max_f32 v130, 0, v130
    v_max_f32 v131, 0, v131
    v_max_f32_e64 v132, 0, v132
    v_mfma_f32_32x32x16_bf16 v[176:191], v[212:215], v[20:23], v[176:191]
    ds_read_b64_tr_b16 v[204:205], v9 offset:6656
    ds_read_b64_tr_b16 v[206:207], v9 offset:6912
    v_max_f32_e64 v133, 0, v133
    v_max_f32 v134, 0, v134
    s_waitcnt lgkmcnt(4)
    v_mfma_f32_32x32x16_bf16 v[160:175], v[192:195], v[24:27], v[160:175]
    ds_read_b64_tr_b16 v[208:209], v9 offset:8192
    ds_read_b64_tr_b16 v[210:211], v9 offset:8448
    v_max_f32 v135, 0, v135
    v_max_f32 v136, 0, v136
    v_max_f32_e64 v137, 0, v137
    v_mfma_f32_32x32x16_bf16 v[176:191], v[196:199], v[24:27], v[176:191]
    ds_read_b64_tr_b16 v[212:213], v9 offset:8704
    ds_read_b64_tr_b16 v[214:215], v9 offset:8960
    v_max_f32_e64 v138, 0, v138
    v_max_f32 v139, 0, v139
    s_waitcnt lgkmcnt(4)
    v_mfma_f32_32x32x16_bf16 v[160:175], v[200:203], v[28:31], v[160:175]
    ds_read_b64_tr_b16 v[192:193], v9 offset:10240
    ds_read_b64_tr_b16 v[194:195], v9 offset:10496
    v_max_f32 v140, 0, v140
    v_max_f32 v141, 0, v141
    v_max_f32_e64 v142, 0, v142
    v_mfma_f32_32x32x16_bf16 v[176:191], v[204:207], v[28:31], v[176:191]
    ds_read_b64_tr_b16 v[196:197], v9 offset:10752
    ds_read_b64_tr_b16 v[198:199], v9 offset:11008
    v_max_f32_e64 v143, 0, v143
    v_mul_f32 v128, v128, v128
    s_waitcnt lgkmcnt(4)
    v_mfma_f32_32x32x16_bf16 v[160:175], v[208:211], v[32:35], v[160:175]
    ds_read_b64_tr_b16 v[200:201], v9 offset:12288
    ds_read_b64_tr_b16 v[202:203], v9 offset:12544
    v_mul_f32 v129, v129, v129
    v_mul_f32 v130, v130, v130
    v_mul_f32_e64 v131, v131, v131
    v_mfma_f32_32x32x16_bf16 v[176:191], v[212:215], v[32:35], v[176:191]
    ds_read_b64_tr_b16 v[204:205], v9 offset:12800
    ds_read_b64_tr_b16 v[206:207], v9 offset:13056
    v_mul_f32_e64 v132, v132, v132
    v_mul_f32 v133, v133, v133
    s_waitcnt lgkmcnt(4)
    v_mfma_f32_32x32x16_bf16 v[160:175], v[192:195], v[36:39], v[160:175]
    ds_read_b64_tr_b16 v[208:209], v9 offset:14336
    ds_read_b64_tr_b16 v[210:211], v9 offset:14592
    v_mul_f32 v134, v134, v134
    v_mul_f32 v135, v135, v135
    v_mul_f32_e64 v136, v136, v136
    v_mfma_f32_32x32x16_bf16 v[176:191], v[196:199], v[36:39], v[176:191]
    ds_read_b64_tr_b16 v[212:213], v9 offset:14848
    ds_read_b64_tr_b16 v[214:215], v9 offset:15104
    v_mul_f32_e64 v137, v137, v137
    v_mul_f32 v138, v138, v138
    s_waitcnt lgkmcnt(4)
    v_mfma_f32_32x32x16_bf16 v[160:175], v[200:203], v[40:43], v[160:175]
    ds_read_b64_tr_b16 v[192:193], v9 offset:16384
    ds_read_b64_tr_b16 v[194:195], v9 offset:16640
    v_mul_f32 v139, v139, v139
    v_mul_f32 v140, v140, v140
    v_mul_f32_e64 v141, v141, v141
    v_mfma_f32_32x32x16_bf16 v[176:191], v[204:207], v[40:43], v[176:191]
    ds_read_b64_tr_b16 v[196:197], v9 offset:16896
    ds_read_b64_tr_b16 v[198:199], v9 offset:17152
    v_mul_f32_e64 v142, v142, v142
    v_mul_f32 v143, v143, v143
    s_waitcnt lgkmcnt(4)
    v_mfma_f32_32x32x16_bf16 v[160:175], v[208:211], v[44:47], v[160:175]
    ds_read_b64_tr_b16 v[200:201], v9 offset:18432
    ds_read_b64_tr_b16 v[202:203], v9 offset:18688
    v_cvt_pk_bf16_f32 v216, v128, v129
    v_cvt_pk_bf16_f32 v217, v130, v131
    v_cvt_pk_bf16_f32 v218, v132, v133
    v_mfma_f32_32x32x16_bf16 v[176:191], v[212:215], v[44:47], v[176:191]
    ds_read_b64_tr_b16 v[204:205], v9 offset:18944
    ds_read_b64_tr_b16 v[206:207], v9 offset:19200
    v_cvt_pk_bf16_f32 v219, v134, v135
    v_cvt_pk_bf16_f32 v220, v136, v137
    s_mov_b32 s52, 16777216
    buffer_load_dword v7, v251, s[4:7], s52 offen sc1
    s_waitcnt lgkmcnt(4)
    s_nop 0
    v_mfma_f32_32x32x16_bf16 v[160:175], v[192:195], v[48:51], v[160:175]
    ds_read_b64_tr_b16 v[208:209], v9 offset:20480
    ds_read_b64_tr_b16 v[210:211], v9 offset:20736
    v_cvt_pk_bf16_f32 v221, v138, v139
    v_cvt_pk_bf16_f32 v222, v140, v141
    v_cvt_pk_bf16_f32 v223, v142, v143
    v_mfma_f32_32x32x16_bf16 v[176:191], v[196:199], v[48:51], v[176:191]
    ds_read_b64_tr_b16 v[212:213], v9 offset:20992
    ds_read_b64_tr_b16 v[214:215], v9 offset:21248
    v_max_f32_e64 v144, 0, v144
    v_max_f32 v145, 0, v145
    s_waitcnt lgkmcnt(4)
    v_mfma_f32_32x32x16_bf16 v[160:175], v[200:203], v[52:55], v[160:175]
    ds_read_b64_tr_b16 v[192:193], v9 offset:22528
    ds_read_b64_tr_b16 v[194:195], v9 offset:22784
    v_max_f32 v146, 0, v146
    v_max_f32 v147, 0, v147
    v_max_f32_e64 v148, 0, v148
    v_mfma_f32_32x32x16_bf16 v[176:191], v[204:207], v[52:55], v[176:191]
    ds_read_b64_tr_b16 v[196:197], v9 offset:23040
    ds_read_b64_tr_b16 v[198:199], v9 offset:23296
    v_max_f32_e64 v149, 0, v149
    v_max_f32 v150, 0, v150
    s_waitcnt lgkmcnt(4)
    v_mfma_f32_32x32x16_bf16 v[160:175], v[208:211], v[56:59], v[160:175]
    ds_read_b64_tr_b16 v[200:201], v9 offset:24576
    ds_read_b64_tr_b16 v[202:203], v9 offset:24832
    v_max_f32 v151, 0, v151
    v_max_f32 v152, 0, v152
    v_max_f32_e64 v153, 0, v153
    v_mfma_f32_32x32x16_bf16 v[176:191], v[212:215], v[56:59], v[176:191]
    ds_read_b64_tr_b16 v[204:205], v9 offset:25088
    ds_read_b64_tr_b16 v[206:207], v9 offset:25344
    v_max_f32_e64 v154, 0, v154
    v_max_f32 v155, 0, v155
    s_waitcnt lgkmcnt(4)
    v_mfma_f32_32x32x16_bf16 v[160:175], v[192:195], v[60:63], v[160:175]
    ds_read_b64_tr_b16 v[208:209], v9 offset:26624
    ds_read_b64_tr_b16 v[210:211], v9 offset:26880
    v_max_f32 v156, 0, v156
    v_max_f32 v157, 0, v157
    v_max_f32_e64 v158, 0, v158
    v_mfma_f32_32x32x16_bf16 v[176:191], v[196:199], v[60:63], v[176:191]
    ds_read_b64_tr_b16 v[212:213], v9 offset:27136
    ds_read_b64_tr_b16 v[214:215], v9 offset:27392
    v_max_f32 v159, 0, v159
    v_mul_f32 v144, v144, v144
    s_waitcnt vmcnt(0)
    v_cmp_gt_u32 vcc, 16, v7
    s_cmp_eq_u64 vcc, 0
    s_cbranch_scc1 L_kv_46_ok
    s_mov_b32 s72, 0
L_kv_46:
    s_nop 0
    buffer_load_dword v7, v251, s[4:7], s52 offen sc1
    s_waitcnt vmcnt(0)
    v_cmp_gt_u32 vcc, 16, v7
    s_cmp_eq_u64 vcc, 0
    s_cbranch_scc1 L_kv_46_ok
    s_add_u32 s72, s72, 1
    s_nop 0
    s_cmp_lt_u32 s72, 1000000
    s_cbranch_scc1 L_kv_46
    s_endpgm
L_kv_46_ok:
    s_waitcnt lgkmcnt(4)
    s_nop 0
    v_mfma_f32_32x32x16_bf16 v[160:175], v[200:203], v[64:67], v[160:175]
    ds_read_b64_tr_b16 v[192:193], v9 offset:28672
    ds_read_b64_tr_b16 v[194:195], v9 offset:28928
    v_mul_f32 v145, v145, v145
    v_mul_f32 v146, v146, v146
    v_mul_f32_e64 v147, v147, v147
    v_mfma_f32_32x32x16_bf16 v[176:191], v[204:207], v[64:67], v[176:191]
    ds_read_b64_tr_b16 v[196:197], v9 offset:29184
    ds_read_b64_tr_b16 v[198:199], v9 offset:29440
    v_mul_f32 v148, v148, v148
    v_mul_f32 v149, v149, v149
    s_add_u32 s49, s44, 1
    s_and_b32 s49, s49, 3
    s_lshl_b32 s49, s49, 11
    s_add_u32 s49, s49, s63
    buffer_load_dwordx4 v[16:19], v2, s[4:7], s49 offen sc1
    s_waitcnt lgkmcnt(4)
    s_nop 0
    v_mfma_f32_32x32x16_bf16 v[160:175], v[208:211], v[68:71], v[160:175]
    ds_read_b64_tr_b16 v[200:201], v9 offset:30720
    ds_read_b64_tr_b16 v[202:203], v9 offset:30976
    v_mul_f32 v150, v150, v150
    v_mul_f32 v151, v151, v151
    v_mul_f32_e64 v152, v152, v152
    v_mfma_f32_32x32x16_bf16 v[176:191], v[212:215], v[68:71], v[176:191]
    ds_read_b64_tr_b16 v[204:205], v9 offset:31232
    ds_read_b64_tr_b16 v[206:207], v9 offset:31488
    v_mul_f32 v153, v153, v153
    v_mul_f32 v154, v154, v154
    buffer_load_dwordx4 v[20:23], v2, s[4:7], s49 offen offset:1024 sc1
    s_waitcnt lgkmcnt(4)
    s_nop 0
    v_mfma_f32_32x32x16_bf16 v[160:175], v[192:195], v[72:75], v[160:175]
    ds_read_b64_tr_b16 v[208:209], v9 offset:32768
    ds_read_b64_tr_b16 v[210:211], v9 offset:33024
    v_mul_f32 v155, v155, v155
    v_mul_f32 v156, v156, v156
    v_mul_f32_e64 v157, v157, v157
    v_mfma_f32_32x32x16_bf16 v[176:191], v[196:199], v[72:75], v[176:191]
    ds_read_b64_tr_b16 v[212:213], v9 offset:33280
    ds_read_b64_tr_b16 v[214:215], v9 offset:33536
    v_mul_f32 v158, v158, v158
    v_mul_f32 v159, v159, v159
    s_add_u32 s49, s44, 2
    s_and_b32 s49, s49, 3
    s_lshl_b32 s49, s49, 11
    s_add_u32 s49, s49, s63
    buffer_load_dwordx4 v[24:27], v2, s[4:7], s49 offen sc1
    s_waitcnt lgkmcnt(4)
    s_nop 0
    v_mfma_f32_32x32x16_bf16 v[160:175], v[200:203], v[76:79], v[160:175]
    ds_read_b64_tr_b16 v[192:193], v9 offset:34816
    ds_read_b64_tr_b16 v[194:195], v9 offset:35072
    v_cvt_pk_bf16_f32 v224, v144, v145
    v_cvt_pk_bf16_f32 v225, v146, v147
    v_cvt_pk_bf16_f32 v226, v148, v149
    v_mfma_f32_32x32x16_bf16 v[176:191], v[204:207], v[76:79], v[176:191]
    ds_read_b64_tr_b16 v[196:197], v9 offset:35328
    ds_read_b64_tr_b16 v[198:199], v9 offset:35584
    v_cvt_pk_bf16_f32 v227, v150, v151
    v_cvt_pk_bf16_f32 v228, v152, v153
    buffer_load_dwordx4 v[28:31], v2, s[4:7], s49 offen offset:1024 sc1
    s_waitcnt lgkmcnt(4)
    s_nop 0
    v_mfma_f32_32x32x16_bf16 v[160:175], v[208:211], v[80:83], v[160:175]
    ds_read_b64_tr_b16 v[200:201], v9 offset:36864
    ds_read_b64_tr_b16 v[202:203], v9 offset:37120
    v_cvt_pk_bf16_f32 v229, v154, v155
    v_cvt_pk_bf16_f32 v230, v156, v157
    v_cvt_pk_bf16_f32 v231, v158, v159
    v_mfma_f32_32x32x16_bf16 v[176:191], v[212:215], v[80:83], v[176:191]
    ds_read_b64_tr_b16 v[204:205], v9 offset:37376
    ds_read_b64_tr_b16 v[206:207], v9 offset:37632
    s_add_u32 s49, s44, 3
    s_and_b32 s49, s49, 3
    s_lshl_b32 s49, s49, 11
    s_add_u32 s49, s49, s63
    buffer_load_dwordx4 v[32:35], v2, s[4:7], s49 offen sc1
    s_waitcnt lgkmcnt(4)
    s_nop 0
    v_mfma_f32_32x32x16_bf16 v[160:175], v[192:195], v[84:87], v[160:175]
    ds_read_b64_tr_b16 v[208:209], v9 offset:38912
    ds_read_b64_tr_b16 v[210:211], v9 offset:39168
    v_mfma_f32_32x32x16_bf16 v[176:191], v[196:199], v[84:87], v[176:191]
    ds_read_b64_tr_b16 v[212:213], v9 offset:39424
    ds_read_b64_tr_b16 v[214:215], v9 offset:39680
    buffer_load_dwordx4 v[36:39], v2, s[4:7], s49 offen offset:1024 sc1
    buffer_store_dwordx4 v[216:219], v2, s[4:7], s53 offen offset:0 sc1
    s_waitcnt lgkmcnt(4)
    s_nop 0
    v_mfma_f32_32x32x16_bf16 v[160:175], v[200:203], v[88:91], v[160:175]
    ds_read_b64_tr_b16 v[192:193], v9 offset:40960
    ds_read_b64_tr_b16 v[194:195], v9 offset:41216
    v_mfma_f32_32x32x16_bf16 v[176:191], v[204:207], v[88:91], v[176:191]
    ds_read_b64_tr_b16 v[196:197], v9 offset:41472
    ds_read_b64_tr_b16 v[198:199], v9 offset:41728
    s_add_u32 s49, s44, 4
    s_and_b32 s49, s49, 3
    s_lshl_b32 s49, s49, 11
    s_add_u32 s49, s49, s63
    buffer_load_dwordx4 v[40:43], v2, s[4:7], s49 offen sc1
    s_waitcnt lgkmcnt(4)
    s_nop 0
    v_mfma_f32_32x32x16_bf16 v[160:175], v[208:211], v[92:95], v[160:175]
    ds_read_b64_tr_b16 v[200:201], v9 offset:43008
    ds_read_b64_tr_b16 v[202:203], v9 offset:43264
    v_mfma_f32_32x32x16_bf16 v[176:191], v[212:215], v[92:95], v[176:191]
    ds_read_b64_tr_b16 v[204:205], v9 offset:43520
    ds_read_b64_tr_b16 v[206:207], v9 offset:43776
    buffer_load_dwordx4 v[44:47], v2, s[4:7], s49 offen offset:1024 sc1
    buffer_store_dwordx4 v[220:223], v2, s[4:7], s53 offen offset:1024 sc1
    s_waitcnt lgkmcnt(4)
    s_nop 0
    v_mfma_f32_32x32x16_bf16 v[160:175], v[192:195], v[96:99], v[160:175]
    ds_read_b64_tr_b16 v[208:209], v9 offset:45056
    ds_read_b64_tr_b16 v[210:211], v9 offset:45312
    v_mfma_f32_32x32x16_bf16 v[176:191], v[196:199], v[96:99], v[176:191]
    ds_read_b64_tr_b16 v[212:213], v9 offset:45568
    ds_read_b64_tr_b16 v[214:215], v9 offset:45824
    buffer_load_dwordx4 v[232:235], v2, s[4:7], s73 offen sc1
    s_waitcnt lgkmcnt(4)
    s_nop 0
    v_mfma_f32_32x32x16_bf16 v[160:175], v[200:203], v[100:103], v[160:175]
    ds_read_b64_tr_b16 v[192:193], v9 offset:47104
    ds_read_b64_tr_b16 v[194:195], v9 offset:47360
    v_mfma_f32_32x32x16_bf16 v[176:191], v[204:207], v[100:103], v[176:191]
    ds_read_b64_tr_b16 v[196:197], v9 offset:47616
    ds_read_b64_tr_b16 v[198:199], v9 offset:47872
    buffer_load_dwordx4 v[236:239], v2, s[4:7], s73 offen offset:1024 sc1
    buffer_store_dwordx4 v[224:227], v2, s[4:7], s53 offen offset:2048 sc1
    s_waitcnt lgkmcnt(4)
    s_nop 0
    v_mfma_f32_32x32x16_bf16 v[160:175], v[208:211], v[104:107], v[160:175]
    ds_read_b64_tr_b16 v[200:201], v6 offset:0
    ds_read_b64_tr_b16 v[202:203], v6 offset:256
    v_mfma_f32_32x32x16_bf16 v[176:191], v[212:215], v[104:107], v[176:191]
    ds_read_b64_tr_b16 v[204:205], v6 offset:512
    ds_read_b64_tr_b16 v[206:207], v6 offset:768
    buffer_load_dwordx4 v[48:51], v2, s[4:7], s61 offen sc1
    s_waitcnt lgkmcnt(4)
    s_nop 0
    v_mfma_f32_32x32x16_bf16 v[160:175], v[192:195], v[108:111], v[160:175]
    ds_read_b64_tr_b16 v[208:209], v6 offset:2048
    ds_read_b64_tr_b16 v[210:211], v6 offset:2304
    v_mfma_f32_32x32x16_bf16 v[176:191], v[196:199], v[108:111], v[176:191]
    ds_read_b64_tr_b16 v[212:213], v6 offset:2560
    ds_read_b64_tr_b16 v[214:215], v6 offset:2816
    buffer_load_dwordx4 v[52:55], v2, s[4:7], s61 offen offset:1024 sc1
    buffer_store_dwordx4 v[228:231], v2, s[4:7], s53 offen offset:3072 sc1
    s_waitcnt lgkmcnt(4)
    s_nop 0
    v_mfma_f32_32x32x16_bf16 v[160:175], v[200:203], v[112:115], v[160:175]
    ds_read_b64_tr_b16 v[192:193], v6 offset:4096
    ds_read_b64_tr_b16 v[194:195], v6 offset:4352
    v_mfma_f32_32x32x16_bf16 v[176:191], v[204:207], v[112:115], v[176:191]
    ds_read_b64_tr_b16 v[196:197], v6 offset:4608
    ds_read_b64_tr_b16 v[198:199], v6 offset:4864
    buffer_load_dwordx4 v[56:59], v2, s[4:7], s61 offen offset:2048 sc1
    s_waitcnt lgkmcnt(4)
    s_nop 0
    v_mfma_f32_32x32x16_bf16 v[160:175], v[208:211], v[116:119], v[160:175]
    ds_read_b64_tr_b16 v[200:201], v6 offset:6144
    ds_read_b64_tr_b16 v[202:203], v6 offset:6400
    v_mfma_f32_32x32x16_bf16 v[176:191], v[212:215], v[116:119], v[176:191]
    ds_read_b64_tr_b16 v[204:205], v6 offset:6656
    ds_read_b64_tr_b16 v[206:207], v6 offset:6912
    buffer_load_dwordx4 v[60:63], v2, s[4:7], s61 offen offset:3072 sc1
    s_addk_i32 s61, 4096
    s_waitcnt lgkmcnt(4)
    v_mfma_f32_32x32x16_bf16 v[160:175], v[192:195], v[120:123], v[160:175]
    v_mfma_f32_32x32x16_bf16 v[176:191], v[196:199], v[120:123], v[176:191]
    s_waitcnt lgkmcnt(0)
    s_nop 0
    v_mfma_f32_32x32x16_bf16 v[160:175], v[200:203], v[124:127], v[160:175]
    v_mfma_f32_32x32x16_bf16 v[176:191], v[204:207], v[124:127], v[176:191]
    s_barrier
    s_lshl_b32 s49, s47, 1
    s_add_u32 s49, s49, 2
    s_lshl_b32 s50, s45, 2
    s_add_u32 s50, s50, s44
    s_mul_i32 s50, s50, 56
    s_add_u32 s49, s49, s50
    s_lshl_b32 s49, s49, 11
    s_add_u32 s53, s49, 8388608
    s_nop 1
    s_waitcnt vmcnt(6)
    v_mfma_f32_32x32x16_bf16 v[80:95], v[232:235], v[16:19], 0
    v_max_f32 v160, 0, v160
    v_max_f32 v161, 0, v161
    v_max_f32 v162, 0, v162
    v_max_f32 v163, 0, v163
    v_max_f32 v164, 0, v164
    v_max_f32 v165, 0, v165
    v_max_f32 v166, 0, v166
    v_max_f32 v167, 0, v167
    v_max_f32 v168, 0, v168
    v_max_f32 v169, 0, v169
    v_mfma_f32_32x32x16_bf16 v[80:95], v[236:239], v[20:23], v[80:95]
    buffer_load_dwordx4 v[64:67], v2, s[4:7], s61 offen sc1
    v_max_f32 v170, 0, v170
    v_max_f32 v171, 0, v171
    v_max_f32 v172, 0, v172
    v_max_f32 v173, 0, v173
    v_max_f32 v174, 0, v174
    v_max_f32 v175, 0, v175
    v_mul_f32 v160, v160, v160
    v_mul_f32 v161, v161, v161
    v_mul_f32 v162, v162, v162
    v_mul_f32 v163, v163, v163
    v_mfma_f32_32x32x16_bf16 v[96:111], v[232:235], v[24:27], 0
    v_mul_f32 v164, v164, v164
    v_mul_f32 v165, v165, v165
    v_mul_f32 v166, v166, v166
    v_mul_f32 v167, v167, v167
    v_mul_f32 v168, v168, v168
    v_mul_f32 v169, v169, v169
    v_mul_f32 v170, v170, v170
    v_mul_f32 v171, v171, v171
    v_mul_f32 v172, v172, v172
    v_mul_f32 v173, v173, v173
    v_mfma_f32_32x32x16_bf16 v[96:111], v[236:239], v[28:31], v[96:111]
    buffer_load_dwordx4 v[68:71], v2, s[4:7], s61 offen offset:1024 sc1
    v_mul_f32 v174, v174, v174
    v_mul_f32 v175, v175, v175
    v_cvt_pk_bf16_f32 v216, v160, v161
    v_cvt_pk_bf16_f32 v217, v162, v163
    v_cvt_pk_bf16_f32 v218, v164, v165
    v_cvt_pk_bf16_f32 v219, v166, v167
    v_cvt_pk_bf16_f32 v220, v168, v169
    v_cvt_pk_bf16_f32 v221, v170, v171
    v_cvt_pk_bf16_f32 v222, v172, v173
    v_cvt_pk_bf16_f32 v223, v174, v175
    v_mfma_f32_32x32x16_bf16 v[112:127], v[232:235], v[32:35], 0
    v_max_f32 v176, 0, v176
    v_max_f32 v177, 0, v177
    v_max_f32 v178, 0, v178
    v_max_f32 v179, 0, v179
    v_max_f32 v180, 0, v180
    v_max_f32 v181, 0, v181
    v_max_f32 v182, 0, v182
    v_max_f32 v183, 0, v183
    v_max_f32 v184, 0, v184
    v_max_f32 v185, 0, v185
    v_mfma_f32_32x32x16_bf16 v[112:127], v[236:239], v[36:39], v[112:127]
    buffer_load_dwordx4 v[72:75], v2, s[4:7], s61 offen offset:2048 sc1
    v_max_f32 v186, 0, v186
    v_max_f32 v187, 0, v187
    v_max_f32 v188, 0, v188
    v_max_f32 v189, 0, v189
    v_max_f32 v190, 0, v190
    v_max_f32 v191, 0, v191
    v_mul_f32 v176, v176, v176
    v_mul_f32 v177, v177, v177
    v_mul_f32 v178, v178, v178
    v_mul_f32 v179, v179, v179
    v_mfma_f32_32x32x16_bf16 v[192:207], v[232:235], v[40:43], 0
    v_mul_f32 v180, v180, v180
    v_mul_f32 v181, v181, v181
    v_mul_f32 v182, v182, v182
    v_mul_f32 v183, v183, v183
    v_mul_f32 v184, v184, v184
    v_mul_f32 v185, v185, v185
    v_mul_f32 v186, v186, v186
    v_mul_f32 v187, v187, v187
    v_mul_f32 v188, v188, v188
    v_mul_f32 v189, v189, v189
    v_mfma_f32_32x32x16_bf16 v[192:207], v[236:239], v[44:47], v[192:207]
    buffer_load_dwordx4 v[76:79], v2, s[4:7], s61 offen offset:3072 sc1
    s_addk_i32 s61, 4096
    v_mul_f32 v190, v190, v190
    v_mul_f32_e64 v191, v191, v191
    v_cvt_pk_bf16_f32 v224, v176, v177
    v_cvt_pk_bf16_f32 v225, v178, v179
    v_cvt_pk_bf16_f32 v226, v180, v181
    v_cvt_pk_bf16_f32 v227, v182, v183
    v_cvt_pk_bf16_f32 v228, v184, v185
    v_cvt_pk_bf16_f32 v229, v186, v187
    v_cvt_pk_bf16_f32 v230, v188, v189
    v_cvt_pk_bf16_f32 v231, v190, v191
    buffer_store_dwordx4 v[216:219], v2, s[4:7], s53 offen offset:0 sc1
    buffer_store_dwordx4 v[220:223], v2, s[4:7], s53 offen offset:1024 sc1
    buffer_store_dwordx4 v[224:227], v2, s[4:7], s53 offen offset:2048 sc1
    buffer_store_dwordx4 v[228:231], v2, s[4:7], s53 offen offset:3072 sc1
L_attn_go:
    v_max3_f32 v232, v80, v81, v82
    v_max3_f32 v232, v232, v83, v84
    v_max3_f32 v232, v232, v85, v86
    v_max3_f32 v232, v232, v87, v88
    v_max3_f32 v232, v232, v89, v90
    v_max3_f32 v232, v232, v91, v92
    v_max3_f32 v232, v232, v93, v94
    v_max_f32_e64 v232, v232, v95
    v_max3_f32 v233, v96, v97, v98
    v_max3_f32 v233, v233, v99, v100
    v_max3_f32 v233, v233, v101, v102
    v_max3_f32 v233, v233, v103, v104
    v_max3_f32 v233, v233, v105, v106
    v_max3_f32 v233, v233, v107, v108
    v_max3_f32 v233, v233, v109, v110
    v_max_f32_e64 v233, v233, v111
    v_max3_f32 v234, v112, v113, v114
    v_max3_f32 v234, v234, v115, v116
    v_max3_f32 v234, v234, v117, v118
    v_max3_f32 v234, v234, v119, v120
    v_max3_f32 v234, v234, v121, v122
    v_max3_f32 v234, v234, v123, v124
    v_max3_f32 v234, v234, v125, v126
    v_max_f32_e64 v234, v234, v127
    v_max3_f32 v235, v192, v193, v194
    v_max3_f32 v235, v235, v195, v196
    v_max3_f32 v235, v235, v197, v198
    v_max3_f32 v235, v235, v199, v200
    v_max3_f32 v235, v235, v201, v202
    v_max3_f32 v235, v235, v203, v204
    v_max3_f32 v235, v235, v205, v206
    v_max_f32 v235, v235, v207
    v_mov_b32 v108, 0
    v_mov_b32 v109, 0
    v_mov_b32 v110, 0
    v_mov_b32 v111, 0
    v_mov_b32 v236, v232
    v_mov_b32 v237, v233
    v_mov_b32 v238, v234
    v_mov_b32 v239, v235
    v_mov_b32 v116, 0
    v_mov_b32 v117, 0
    v_mov_b32 v118, 0
    v_mov_b32 v119, 0
    v_permlane32_swap_b32 v232, v236
    v_permlane32_swap_b32 v233, v237
    v_permlane32_swap_b32 v234, v238
    v_permlane32_swap_b32 v235, v239
    v_max_f32 v232, v232, v236
    v_max_f32 v233, v233, v237
    v_max_f32 v234, v234, v238
    v_max_f32_e64 v235, v235, v239
    v_sub_f32 v232, 0xc2b80000, v232
    v_sub_f32 v233, 0xc2b80000, v233
    v_sub_f32 v234, 0xc2b80000, v234
    v_sub_f32 v235, 0xc2b80000, v235
    s_mov_b32 exec_lo, 0
    s_nop 0
    v_cvt_pk_bf16_f32 v22, v232, 0
    v_cvt_pk_bf16_f32 v30, v233, 0
    v_cvt_pk_bf16_f32 v38, v234, 0
    v_cvt_pk_bf16_f32 v46, v235, 0
    s_mov_b32 exec_lo, -1
    s_nop 0
    v_mfma_f32_32x32x16_bf16 v[128:143], v[116:119], v[116:119], 0
    v_mfma_f32_32x32x16_bf16 v[144:159], v[116:119], v[116:119], 0
    v_mfma_f32_32x32x16_bf16 v[160:175], v[116:119], v[116:119], 0
    v_mfma_f32_32x32x16_bf16 v[176:191], v[116:119], v[116:119], 0
    s_waitcnt vmcnt(8)
    s_nop 0
    v_mfma_f32_32x32x16_bf16 v[192:207], v[48:51], v[16:19], 0
    v_mfma_f32_32x32x16_bf16 v[192:207], v[52:55], v[20:23], v[192:207]
    s_nop 7
    s_nop 3
    v_mfma_f32_32x32x16_bf16 v[208:223], v[48:51], v[24:27], 0
    v_exp_f32 v192, v192
    v_exp_f32 v193, v193
    v_exp_f32 v194, v194
    v_exp_f32 v195, v195
    v_cvt_pk_bf16_f32 v112, v192, v193
    v_cvt_pk_bf16_f32 v113, v194, v195
    v_mfma_f32_32x32x16_bf16 v[208:223], v[52:55], v[28:31], v[208:223]
    v_exp_f32 v196, v196
    v_exp_f32 v197, v197
    v_exp_f32 v198, v198
    v_exp_f32 v199, v199
    v_cvt_pk_bf16_f32 v114, v196, v197
    v_cvt_pk_bf16_f32 v115, v198, v199
    v_mfma_f32_32x32x16_bf16 v[176:191], v[108:111], v[116:119], v[176:191]
    buffer_load_dwordx4 v[80:83], v2, s[4:7], s61 offen sc1
    v_exp_f32 v200, v200
    v_exp_f32 v201, v201
    v_exp_f32 v202, v202
    v_exp_f32 v203, v203
    v_cvt_pk_bf16_f32 v116, v200, v201
    v_cvt_pk_bf16_f32 v117, v202, v203
    v_mfma_f32_32x32x16_bf16 v[128:143], v[56:59], v[112:115], v[128:143]
    buffer_load_dwordx4 v[84:87], v2, s[4:7], s61 offen offset:1024 sc1
    v_exp_f32 v204, v204
    v_exp_f32 v205, v205
    v_exp_f32 v206, v206
    v_exp_f32 v207, v207
    v_cvt_pk_bf16_f32 v118, v204, v205
    v_cvt_pk_bf16_f32 v119, v206, v207
    v_mfma_f32_32x32x16_bf16 v[192:207], v[48:51], v[32:35], 0
    v_exp_f32 v208, v208
    v_exp_f32 v209, v209
    v_exp_f32 v210, v210
    v_exp_f32 v211, v211
    v_cvt_pk_bf16_f32 v112, v208, v209
    v_cvt_pk_bf16_f32 v113, v210, v211
    v_mfma_f32_32x32x16_bf16 v[192:207], v[52:55], v[36:39], v[192:207]
    buffer_load_dwordx4 v[88:91], v2, s[4:7], s61 offen offset:2048 sc1
    v_exp_f32 v212, v212
    v_exp_f32 v213, v213
    v_exp_f32 v214, v214
    v_exp_f32 v215, v215
    v_cvt_pk_bf16_f32 v114, v212, v213
    v_cvt_pk_bf16_f32 v115, v214, v215
    v_mfma_f32_32x32x16_bf16 v[128:143], v[60:63], v[116:119], v[128:143]
    v_exp_f32 v216, v216
    v_exp_f32 v217, v217
    v_exp_f32 v218, v218
    v_exp_f32 v219, v219
    v_cvt_pk_bf16_f32 v116, v216, v217
    v_cvt_pk_bf16_f32 v117, v218, v219
    v_mfma_f32_32x32x16_bf16 v[144:159], v[56:59], v[112:115], v[144:159]
    buffer_load_dwordx4 v[92:95], v2, s[4:7], s61 offen offset:3072 sc1
    s_addk_i32 s61, 4096
    v_exp_f32 v220, v220
    v_exp_f32 v221, v221
    v_exp_f32 v222, v222
    v_exp_f32_e64 v223, v223
    v_cvt_pk_bf16_f32 v118, v220, v221
    v_cvt_pk_bf16_f32 v119, v222, v223
    v_mfma_f32_32x32x16_bf16 v[208:223], v[48:51], v[40:43], 0
    v_exp_f32 v192, v192
    v_exp_f32 v193, v193
    v_exp_f32 v194, v194
    v_exp_f32 v195, v195
    v_cvt_pk_bf16_f32 v112, v192, v193
    v_cvt_pk_bf16_f32 v113, v194, v195
    v_mfma_f32_32x32x16_bf16 v[208:223], v[52:55], v[44:47], v[208:223]
    buffer_load_dwordx4 v[96:99], v2, s[4:7], s61 offen sc1
    v_exp_f32 v196, v196
    v_exp_f32 v197, v197
    v_exp_f32 v198, v198
    v_exp_f32 v199, v199
    v_cvt_pk_bf16_f32 v114, v196, v197
    v_cvt_pk_bf16_f32 v115, v198, v199
    v_mfma_f32_32x32x16_bf16 v[144:159], v[60:63], v[116:119], v[144:159]
    buffer_load_dwordx4 v[100:103], v2, s[4:7], s61 offen offset:1024 sc1
    v_exp_f32 v200, v200
    v_exp_f32 v201, v201
    v_exp_f32 v202, v202
    v_exp_f32 v203, v203
    v_cvt_pk_bf16_f32 v116, v200, v201
    v_cvt_pk_bf16_f32 v117, v202, v203
    v_mfma_f32_32x32x16_bf16 v[160:175], v[56:59], v[112:115], v[160:175]
    v_exp_f32 v204, v204
    v_exp_f32 v205, v205
    v_exp_f32 v206, v206
    v_exp_f32 v207, v207
    v_cvt_pk_bf16_f32 v118, v204, v205
    v_cvt_pk_bf16_f32 v119, v206, v207
    s_waitcnt vmcnt(10)
    s_nop 0
    v_mfma_f32_32x32x16_bf16 v[192:207], v[64:67], v[16:19], 0
    buffer_load_dwordx4 v[104:107], v2, s[4:7], s61 offen offset:2048 sc1
    v_exp_f32 v208, v208
    v_exp_f32 v209, v209
    v_exp_f32 v210, v210
    v_exp_f32 v211, v211
    v_cvt_pk_bf16_f32 v112, v208, v209
    v_cvt_pk_bf16_f32 v113, v210, v211
    v_mfma_f32_32x32x16_bf16 v[192:207], v[68:71], v[20:23], v[192:207]
    v_exp_f32 v212, v212
    v_exp_f32 v213, v213
    v_exp_f32 v214, v214
    v_exp_f32 v215, v215
    v_cvt_pk_bf16_f32 v114, v212, v213
    v_cvt_pk_bf16_f32 v115, v214, v215
    v_mfma_f32_32x32x16_bf16 v[160:175], v[60:63], v[116:119], v[160:175]
    buffer_load_dwordx4 v[108:111], v2, s[4:7], s61 offen offset:3072 sc1
    s_addk_i32 s61, 4096
    v_exp_f32 v216, v216
    v_exp_f32 v217, v217
    v_exp_f32 v218, v218
    v_exp_f32_e64 v219, v219
    v_cvt_pk_bf16_f32 v116, v216, v217
    v_cvt_pk_bf16_f32 v117, v218, v219
    v_mfma_f32_32x32x16_bf16 v[176:191], v[56:59], v[112:115], v[176:191]
    v_exp_f32 v220, v220
    v_exp_f32 v221, v221
    v_exp_f32 v222, v222
    v_exp_f32 v223, v223
    v_cvt_pk_bf16_f32 v118, v220, v221
    v_cvt_pk_bf16_f32 v119, v222, v223
    v_mfma_f32_32x32x16_bf16 v[208:223], v[64:67], v[24:27], 0
    v_exp_f32 v192, v192
    v_exp_f32 v193, v193
    v_exp_f32 v194, v194
    v_exp_f32 v195, v195
    v_cvt_pk_bf16_f32 v112, v192, v193
    v_cvt_pk_bf16_f32 v113, v194, v195
    v_mfma_f32_32x32x16_bf16 v[208:223], v[68:71], v[28:31], v[208:223]
    v_exp_f32 v196, v196
    v_exp_f32 v197, v197
    v_exp_f32 v198, v198
    v_exp_f32 v199, v199
    v_cvt_pk_bf16_f32 v114, v196, v197
    v_cvt_pk_bf16_f32 v115, v198, v199
    v_mfma_f32_32x32x16_bf16 v[176:191], v[60:63], v[116:119], v[176:191]
    buffer_load_dwordx4 v[48:51], v2, s[4:7], s61 offen sc1
    v_exp_f32 v200, v200
    v_exp_f32 v201, v201
    v_exp_f32 v202, v202
    v_exp_f32 v203, v203
    v_cvt_pk_bf16_f32 v116, v200, v201
    v_cvt_pk_bf16_f32 v117, v202, v203
    v_mfma_f32_32x32x16_bf16 v[128:143], v[72:75], v[112:115], v[128:143]
    s_add_u32 m0, s67, 0
    s_add_u32 s69, s66, 0
    buffer_load_dwordx4 v249, s[24:27], s69 offen lds
    v_exp_f32 v204, v204
    v_exp_f32 v205, v205
    v_exp_f32 v206, v206
    v_exp_f32 v207, v207
    v_cvt_pk_bf16_f32 v118, v204, v205
    v_cvt_pk_bf16_f32 v119, v206, v207
    v_mfma_f32_32x32x16_bf16 v[192:207], v[64:67], v[32:35], 0
    s_add_u32 m0, s67, 1024
    s_add_u32 s69, s66, 7168
    buffer_load_dwordx4 v249, s[24:27], s69 offen lds
    v_exp_f32 v208, v208
    v_exp_f32 v209, v209
    v_exp_f32 v210, v210
    v_exp_f32 v211, v211
    v_cvt_pk_bf16_f32 v112, v208, v209
    v_cvt_pk_bf16_f32 v113, v210, v211
    v_mfma_f32_32x32x16_bf16 v[192:207], v[68:71], v[36:39], v[192:207]
    v_exp_f32 v212, v212
    v_exp_f32 v213, v213
    v_exp_f32 v214, v214
    v_exp_f32 v215, v215
    v_cvt_pk_bf16_f32 v114, v212, v213
    v_cvt_pk_bf16_f32 v115, v214, v215
    v_mfma_f32_32x32x16_bf16 v[128:143], v[76:79], v[116:119], v[128:143]
    buffer_load_dwordx4 v[52:55], v2, s[4:7], s61 offen offset:1024 sc1
    v_exp_f32 v216, v216
    v_exp_f32 v217, v217
    v_exp_f32 v218, v218
    v_exp_f32 v219, v219
    v_cvt_pk_bf16_f32 v116, v216, v217
    v_cvt_pk_bf16_f32 v117, v218, v219
    v_mfma_f32_32x32x16_bf16 v[144:159], v[72:75], v[112:115], v[144:159]
    s_add_u32 m0, s67, 2048
    s_add_u32 s69, s66, 14336
    buffer_load_dwordx4 v249, s[24:27], s69 offen lds
    v_exp_f32 v220, v220
    v_exp_f32 v221, v221
    v_exp_f32 v222, v222
    v_exp_f32 v223, v223
    v_cvt_pk_bf16_f32 v118, v220, v221
    v_cvt_pk_bf16_f32 v119, v222, v223
    s_waitcnt vmcnt(13)
    s_lshl_b32 s49, s45, 7
    s_add_u32 s49, s49, 16779264
    v_mov_b32_e64 v232, 0
    v_mov_b32 v233, 1
    s_mov_b64 exec, 1
    buffer_atomic_add v233, v232, s[4:7], s49 offen sc1
    s_mov_b64 exec, -1
    s_nop 0
    v_mfma_f32_32x32x16_bf16 v[208:223], v[64:67], v[40:43], 0
    v_exp_f32 v192, v192
    v_exp_f32 v193, v193
    v_exp_f32 v194, v194
    v_exp_f32 v195, v195
    v_cvt_pk_bf16_f32 v112, v192, v193
    v_cvt_pk_bf16_f32 v113, v194, v195
    v_mfma_f32_32x32x16_bf16 v[208:223], v[68:71], v[44:47], v[208:223]
    buffer_load_dwordx4 v[56:59], v2, s[4:7], s61 offen offset:2048 sc1
    v_exp_f32 v196, v196
    v_exp_f32 v197, v197
    v_exp_f32 v198, v198
    v_exp_f32 v199, v199
    v_cvt_pk_bf16_f32 v114, v196, v197
    v_cvt_pk_bf16_f32 v115, v198, v199
    v_mfma_f32_32x32x16_bf16 v[144:159], v[76:79], v[116:119], v[144:159]
    s_add_u32 m0, s67, 3072
    s_add_u32 s69, s66, 21504
    buffer_load_dwordx4 v249, s[24:27], s69 offen lds
    v_exp_f32 v200, v200
    v_exp_f32 v201, v201
    v_exp_f32 v202, v202
    v_exp_f32 v203, v203
    v_cvt_pk_bf16_f32 v116, v200, v201
    v_cvt_pk_bf16_f32 v117, v202, v203
    v_mfma_f32_32x32x16_bf16 v[160:175], v[72:75], v[112:115], v[160:175]
    buffer_load_dwordx4 v[60:63], v2, s[4:7], s61 offen offset:3072 sc1
    s_addk_i32 s61, 4096
    v_exp_f32 v204, v204
    v_exp_f32 v205, v205
    v_exp_f32 v206, v206
    v_exp_f32_e64 v207, v207
    v_cvt_pk_bf16_f32 v118, v204, v205
    v_cvt_pk_bf16_f32 v119, v206, v207
    s_waitcnt vmcnt(13)
    s_nop 0
    v_mfma_f32_32x32x16_bf16 v[192:207], v[80:83], v[16:19], 0
    v_exp_f32 v208, v208
    v_exp_f32 v209, v209
    v_exp_f32 v210, v210
    v_exp_f32 v211, v211
    v_cvt_pk_bf16_f32 v112, v208, v209
    v_cvt_pk_bf16_f32 v113, v210, v211
    v_mfma_f32_32x32x16_bf16 v[192:207], v[84:87], v[20:23], v[192:207]
    s_add_u32 m0, s67, 4096
    s_add_u32 s69, s66, 28672
    buffer_load_dwordx4 v249, s[24:27], s69 offen lds
    v_exp_f32 v212, v212
    v_exp_f32 v213, v213
    v_exp_f32 v214, v214
    v_exp_f32 v215, v215
    v_cvt_pk_bf16_f32 v114, v212, v213
    v_cvt_pk_bf16_f32 v115, v214, v215
    v_mfma_f32_32x32x16_bf16 v[160:175], v[76:79], v[116:119], v[160:175]
    s_add_u32 m0, s67, 5120
    s_add_u32 s69, s66, 35840
    buffer_load_dwordx4 v249, s[24:27], s69 offen lds
    v_exp_f32 v216, v216
    v_exp_f32 v217, v217
    v_exp_f32 v218, v218
    v_exp_f32 v219, v219
    v_cvt_pk_bf16_f32 v116, v216, v217
    v_cvt_pk_bf16_f32 v117, v218, v219
    v_mfma_f32_32x32x16_bf16 v[176:191], v[72:75], v[112:115], v[176:191]
    v_exp_f32 v220, v220
    v_exp_f32 v221, v221
    v_exp_f32 v222, v222
    v_exp_f32 v223, v223
    v_cvt_pk_bf16_f32 v118, v220, v221
    v_cvt_pk_bf16_f32 v119, v222, v223
    v_mfma_f32_32x32x16_bf16 v[208:223], v[80:83], v[24:27], 0
    v_exp_f32 v192, v192
    v_exp_f32 v193, v193
    v_exp_f32 v194, v194
    v_exp_f32 v195, v195
    v_cvt_pk_bf16_f32 v112, v192, v193
    v_cvt_pk_bf16_f32 v113, v194, v195
    v_mfma_f32_32x32x16_bf16 v[208:223], v[84:87], v[28:31], v[208:223]
    v_exp_f32 v196, v196
    v_exp_f32 v197, v197
    v_exp_f32 v198, v198
    v_exp_f32 v199, v199
    v_cvt_pk_bf16_f32 v114, v196, v197
    v_cvt_pk_bf16_f32 v115, v198, v199
    v_mfma_f32_32x32x16_bf16 v[176:191], v[76:79], v[116:119], v[176:191]
    buffer_load_dwordx4 v[64:67], v2, s[4:7], s61 offen sc1
    v_exp_f32 v200, v200
    v_exp_f32 v201, v201
    v_exp_f32 v202, v202
    v_exp_f32 v203, v203
    v_cvt_pk_bf16_f32 v116, v200, v201
    v_cvt_pk_bf16_f32 v117, v202, v203
    v_mfma_f32_32x32x16_bf16 v[128:143], v[88:91], v[112:115], v[128:143]
    s_add_u32 m0, s67, 6144
    s_add_u32 s69, s66, 43008
    buffer_load_dwordx4 v249, s[24:27], s69 offen lds
    v_exp_f32 v204, v204
    v_exp_f32 v205, v205
    v_exp_f32 v206, v206
    v_exp_f32 v207, v207
    v_cvt_pk_bf16_f32 v118, v204, v205
    v_cvt_pk_bf16_f32 v119, v206, v207
    v_mfma_f32_32x32x16_bf16 v[192:207], v[80:83], v[32:35], 0
    s_add_u32 m0, s67, 7168
    s_add_u32 s69, s66, 50176
    buffer_load_dwordx4 v249, s[24:27], s69 offen lds
    v_exp_f32 v208, v208
    v_exp_f32 v209, v209
    v_exp_f32 v210, v210
    v_exp_f32 v211, v211
    v_cvt_pk_bf16_f32 v112, v208, v209
    v_cvt_pk_bf16_f32 v113, v210, v211
    v_mfma_f32_32x32x16_bf16 v[192:207], v[84:87], v[36:39], v[192:207]
    v_exp_f32 v212, v212
    v_exp_f32 v213, v213
    v_exp_f32 v214, v214
    v_exp_f32 v215, v215
    v_cvt_pk_bf16_f32 v114, v212, v213
    v_cvt_pk_bf16_f32 v115, v214, v215
    v_mfma_f32_32x32x16_bf16 v[128:143], v[92:95], v[116:119], v[128:143]
    buffer_load_dwordx4 v[68:71], v2, s[4:7], s61 offen offset:1024 sc1
    v_exp_f32 v216, v216
    v_exp_f32 v217, v217
    v_exp_f32 v218, v218
    v_exp_f32 v219, v219
    v_cvt_pk_bf16_f32 v116, v216, v217
    v_cvt_pk_bf16_f32 v117, v218, v219
    v_mfma_f32_32x32x16_bf16 v[144:159], v[88:91], v[112:115], v[144:159]
    s_add_u32 m0, s67, 8192
    s_add_u32 s69, s66, 57344
    buffer_load_dwordx4 v249, s[24:27], s69 offen lds
    v_exp_f32 v220, v220
    v_exp_f32 v221, v221
    v_exp_f32 v222, v222
    v_exp_f32 v223, v223
    v_cvt_pk_bf16_f32 v118, v220, v221
    v_cvt_pk_bf16_f32 v119, v222, v223
    v_mfma_f32_32x32x16_bf16 v[208:223], v[80:83], v[40:43], 0
    v_exp_f32 v192, v192
    v_exp_f32 v193, v193
    v_exp_f32 v194, v194
    v_exp_f32 v195, v195
    v_cvt_pk_bf16_f32 v112, v192, v193
    v_cvt_pk_bf16_f32 v113, v194, v195
    v_mfma_f32_32x32x16_bf16 v[208:223], v[84:87], v[44:47], v[208:223]
    buffer_load_dwordx4 v[72:75], v2, s[4:7], s61 offen offset:2048 sc1
    v_exp_f32 v196, v196
    v_exp_f32 v197, v197
    v_exp_f32 v198, v198
    v_exp_f32 v199, v199
    v_cvt_pk_bf16_f32 v114, v196, v197
    v_cvt_pk_bf16_f32 v115, v198, v199
    v_mfma_f32_32x32x16_bf16 v[144:159], v[92:95], v[116:119], v[144:159]
    s_add_u32 m0, s67, 9216
    s_add_u32 s69, s66, 64512
    buffer_load_dwordx4 v249, s[24:27], s69 offen lds
    v_exp_f32 v200, v200
    v_exp_f32 v201, v201
    v_exp_f32 v202, v202
    v_exp_f32 v203, v203
    v_cvt_pk_bf16_f32 v116, v200, v201
    v_cvt_pk_bf16_f32 v117, v202, v203
    v_mfma_f32_32x32x16_bf16 v[160:175], v[88:91], v[112:115], v[160:175]
    buffer_load_dwordx4 v[76:79], v2, s[4:7], s61 offen offset:3072 sc1
    s_addk_i32 s61, 4096
    v_exp_f32 v204, v204
    v_exp_f32 v205, v205
    v_exp_f32 v206, v206
    v_exp_f32_e64 v207, v207
    v_cvt_pk_bf16_f32 v118, v204, v205
    v_cvt_pk_bf16_f32 v119, v206, v207
    s_waitcnt vmcnt(19)
    s_nop 0
    v_mfma_f32_32x32x16_bf16 v[192:207], v[96:99], v[16:19], 0
    v_exp_f32 v208, v208
    v_exp_f32 v209, v209
    v_exp_f32 v210, v210
    v_exp_f32 v211, v211
    v_cvt_pk_bf16_f32 v112, v208, v209
    v_cvt_pk_bf16_f32 v113, v210, v211
    v_mfma_f32_32x32x16_bf16 v[192:207], v[100:103], v[20:23], v[192:207]
    s_add_u32 m0, s67, 10240
    s_add_u32 s69, s66, 71680
    buffer_load_dwordx4 v249, s[24:27], s69 offen lds
    v_exp_f32 v212, v212
    v_exp_f32 v213, v213
    v_exp_f32 v214, v214
    v_exp_f32 v215, v215
    v_cvt_pk_bf16_f32 v114, v212, v213
    v_cvt_pk_bf16_f32 v115, v214, v215
    v_mfma_f32_32x32x16_bf16 v[160:175], v[92:95], v[116:119], v[160:175]
    s_add_u32 m0, s67, 11264
    s_add_u32 s69, s66, 78848
    buffer_load_dwordx4 v249, s[24:27], s69 offen lds
    v_exp_f32 v216, v216
    v_exp_f32 v217, v217
    v_exp_f32 v218, v218
    v_exp_f32 v219, v219
    v_cvt_pk_bf16_f32 v116, v216, v217
    v_cvt_pk_bf16_f32 v117, v218, v219
    v_mfma_f32_32x32x16_bf16 v[176:191], v[88:91], v[112:115], v[176:191]
    v_exp_f32 v220, v220
    v_exp_f32 v221, v221
    v_exp_f32 v222, v222
    v_exp_f32 v223, v223
    v_cvt_pk_bf16_f32 v118, v220, v221
    v_cvt_pk_bf16_f32 v119, v222, v223
    v_mfma_f32_32x32x16_bf16 v[208:223], v[96:99], v[24:27], 0
    v_exp_f32 v192, v192
    v_exp_f32 v193, v193
    v_exp_f32 v194, v194
    v_exp_f32 v195, v195
    v_cvt_pk_bf16_f32 v112, v192, v193
    v_cvt_pk_bf16_f32 v113, v194, v195
    v_mfma_f32_32x32x16_bf16 v[208:223], v[100:103], v[28:31], v[208:223]
    v_exp_f32 v196, v196
    v_exp_f32 v197, v197
    v_exp_f32 v198, v198
    v_exp_f32 v199, v199
    v_cvt_pk_bf16_f32 v114, v196, v197
    v_cvt_pk_bf16_f32 v115, v198, v199
    v_mfma_f32_32x32x16_bf16 v[176:191], v[92:95], v[116:119], v[176:191]
    buffer_load_dwordx4 v[80:83], v2, s[4:7], s61 offen sc1
    v_exp_f32 v200, v200
    v_exp_f32 v201, v201
    v_exp_f32 v202, v202
    v_exp_f32 v203, v203
    v_cvt_pk_bf16_f32 v116, v200, v201
    v_cvt_pk_bf16_f32 v117, v202, v203
    v_mfma_f32_32x32x16_bf16 v[128:143], v[104:107], v[112:115], v[128:143]
    s_add_u32 m0, s67, 12288
    s_add_u32 s69, s66, 86016
    buffer_load_dwordx4 v249, s[24:27], s69 offen lds
    v_exp_f32 v204, v204
    v_exp_f32 v205, v205
    v_exp_f32 v206, v206
    v_exp_f32 v207, v207
    v_cvt_pk_bf16_f32 v118, v204, v205
    v_cvt_pk_bf16_f32 v119, v206, v207
    v_mfma_f32_32x32x16_bf16 v[192:207], v[96:99], v[32:35], 0
    s_add_u32 m0, s67, 13312
    s_add_u32 s69, s66, 93184
    buffer_load_dwordx4 v249, s[24:27], s69 offen lds
    v_exp_f32 v208, v208
    v_exp_f32 v209, v209
    v_exp_f32 v210, v210
    v_exp_f32 v211, v211
    v_cvt_pk_bf16_f32 v112, v208, v209
    v_cvt_pk_bf16_f32 v113, v210, v211
    v_mfma_f32_32x32x16_bf16 v[192:207], v[100:103], v[36:39], v[192:207]
    v_exp_f32 v212, v212
    v_exp_f32 v213, v213
    v_exp_f32 v214, v214
    v_exp_f32 v215, v215
    v_cvt_pk_bf16_f32 v114, v212, v213
    v_cvt_pk_bf16_f32 v115, v214, v215
    v_mfma_f32_32x32x16_bf16 v[128:143], v[108:111], v[116:119], v[128:143]
    buffer_load_dwordx4 v[84:87], v2, s[4:7], s61 offen offset:1024 sc1
    v_exp_f32 v216, v216
    v_exp_f32 v217, v217
    v_exp_f32 v218, v218
    v_exp_f32 v219, v219
    v_cvt_pk_bf16_f32 v116, v216, v217
    v_cvt_pk_bf16_f32 v117, v218, v219
    v_mfma_f32_32x32x16_bf16 v[144:159], v[104:107], v[112:115], v[144:159]
    s_add_u32 m0, s67, 14336
    s_add_u32 s69, s66, 100352
    buffer_load_dwordx4 v249, s[24:27], s69 offen lds
    v_exp_f32 v220, v220
    v_exp_f32 v221, v221
    v_exp_f32 v222, v222
    v_exp_f32 v223, v223
    v_cvt_pk_bf16_f32 v118, v220, v221
    v_cvt_pk_bf16_f32 v119, v222, v223
    v_mfma_f32_32x32x16_bf16 v[208:223], v[96:99], v[40:43], 0
    v_exp_f32 v192, v192
    v_exp_f32 v193, v193
    v_exp_f32 v194, v194
    v_exp_f32 v195, v195
    v_cvt_pk_bf16_f32 v112, v192, v193
    v_cvt_pk_bf16_f32 v113, v194, v195
    v_mfma_f32_32x32x16_bf16 v[208:223], v[100:103], v[44:47], v[208:223]
    buffer_load_dwordx4 v[88:91], v2, s[4:7], s61 offen offset:2048 sc1
    v_exp_f32 v196, v196
    v_exp_f32 v197, v197
    v_exp_f32 v198, v198
    v_exp_f32 v199, v199
    v_cvt_pk_bf16_f32 v114, v196, v197
    v_cvt_pk_bf16_f32 v115, v198, v199
    v_mfma_f32_32x32x16_bf16 v[144:159], v[108:111], v[116:119], v[144:159]
    s_add_u32 m0, s67, 15360
    s_add_u32 s69, s66, 107520
    buffer_load_dwordx4 v249, s[24:27], s69 offen lds
    v_exp_f32 v200, v200
    v_exp_f32 v201, v201
    v_exp_f32 v202, v202
    v_exp_f32 v203, v203
    v_cvt_pk_bf16_f32 v116, v200, v201
    v_cvt_pk_bf16_f32 v117, v202, v203
    v_mfma_f32_32x32x16_bf16 v[160:175], v[104:107], v[112:115], v[160:175]
    buffer_load_dwordx4 v[92:95], v2, s[4:7], s61 offen offset:3072 sc1
    s_addk_i32 s61, 4096
    v_exp_f32 v204, v204
    v_exp_f32 v205, v205
    v_exp_f32 v206, v206
    v_exp_f32_e64 v207, v207
    v_cvt_pk_bf16_f32 v118, v204, v205
    v_cvt_pk_bf16_f32 v119, v206, v207
    s_waitcnt vmcnt(20)
    s_nop 0
    v_mfma_f32_32x32x16_bf16 v[192:207], v[48:51], v[16:19], 0
    v_exp_f32 v208, v208
    v_exp_f32 v209, v209
    v_exp_f32 v210, v210
    v_exp_f32 v211, v211
    v_cvt_pk_bf16_f32 v112, v208, v209
    v_cvt_pk_bf16_f32 v113, v210, v211
    v_mfma_f32_32x32x16_bf16 v[192:207], v[52:55], v[20:23], v[192:207]
    s_add_u32 m0, s67, 16384
    s_add_u32 s69, s66, 114688
    buffer_load_dwordx4 v249, s[24:27], s69 offen lds
    v_exp_f32 v212, v212
    v_exp_f32 v213, v213
    v_exp_f32 v214, v214
    v_exp_f32 v215, v215
    v_cvt_pk_bf16_f32 v114, v212, v213
    v_cvt_pk_bf16_f32 v115, v214, v215
    v_mfma_f32_32x32x16_bf16 v[160:175], v[108:111], v[116:119], v[160:175]
    s_add_u32 m0, s67, 17408
    s_add_u32 s69, s66, 121856
    buffer_load_dwordx4 v249, s[24:27], s69 offen lds
    v_exp_f32 v216, v216
    v_exp_f32 v217, v217
    v_exp_f32 v218, v218
    v_exp_f32 v219, v219
    v_cvt_pk_bf16_f32 v116, v216, v217
    v_cvt_pk_bf16_f32 v117, v218, v219
    v_mfma_f32_32x32x16_bf16 v[176:191], v[104:107], v[112:115], v[176:191]
    v_exp_f32 v220, v220
    v_exp_f32 v221, v221
    v_exp_f32 v222, v222
    v_exp_f32 v223, v223
    v_cvt_pk_bf16_f32 v118, v220, v221
    v_cvt_pk_bf16_f32 v119, v222, v223
    v_mfma_f32_32x32x16_bf16 v[208:223], v[48:51], v[24:27], 0
    v_exp_f32 v192, v192
    v_exp_f32 v193, v193
    v_exp_f32 v194, v194
    v_exp_f32 v195, v195
    v_cvt_pk_bf16_f32 v112, v192, v193
    v_cvt_pk_bf16_f32 v113, v194, v195
    v_mfma_f32_32x32x16_bf16 v[208:223], v[52:55], v[28:31], v[208:223]
    v_exp_f32 v196, v196
    v_exp_f32 v197, v197
    v_exp_f32 v198, v198
    v_exp_f32 v199, v199
    v_cvt_pk_bf16_f32 v114, v196, v197
    v_cvt_pk_bf16_f32 v115, v198, v199
    v_mfma_f32_32x32x16_bf16 v[176:191], v[108:111], v[116:119], v[176:191]
    buffer_load_dwordx4 v[96:99], v2, s[4:7], s61 offen sc1
    v_exp_f32 v200, v200
    v_exp_f32 v201, v201
    v_exp_f32 v202, v202
    v_exp_f32 v203, v203
    v_cvt_pk_bf16_f32 v116, v200, v201
    v_cvt_pk_bf16_f32 v117, v202, v203
    v_mfma_f32_32x32x16_bf16 v[128:143], v[56:59], v[112:115], v[128:143]
    s_add_u32 m0, s67, 18432
    s_add_u32 s69, s66, 129024
    buffer_load_dwordx4 v249, s[24:27], s69 offen lds
    v_exp_f32 v204, v204
    v_exp_f32 v205, v205
    v_exp_f32 v206, v206
    v_exp_f32 v207, v207
    v_cvt_pk_bf16_f32 v118, v204, v205
    v_cvt_pk_bf16_f32 v119, v206, v207
    v_mfma_f32_32x32x16_bf16 v[192:207], v[48:51], v[32:35], 0
    s_add_u32 m0, s67, 19456
    s_add_u32 s69, s66, 136192
    buffer_load_dwordx4 v249, s[24:27], s69 offen lds
    v_exp_f32 v208, v208
    v_exp_f32 v209, v209
    v_exp_f32 v210, v210
    v_exp_f32 v211, v211
    v_cvt_pk_bf16_f32 v112, v208, v209
    v_cvt_pk_bf16_f32 v113, v210, v211
    v_mfma_f32_32x32x16_bf16 v[192:207], v[52:55], v[36:39], v[192:207]
    v_exp_f32 v212, v212
    v_exp_f32 v213, v213
    v_exp_f32 v214, v214
    v_exp_f32 v215, v215
    v_cvt_pk_bf16_f32 v114, v212, v213
    v_cvt_pk_bf16_f32 v115, v214, v215
    v_mfma_f32_32x32x16_bf16 v[128:143], v[60:63], v[116:119], v[128:143]
    buffer_load_dwordx4 v[100:103], v2, s[4:7], s61 offen offset:1024 sc1
    v_exp_f32 v216, v216
    v_exp_f32 v217, v217
    v_exp_f32 v218, v218
    v_exp_f32 v219, v219
    v_cvt_pk_bf16_f32 v116, v216, v217
    v_cvt_pk_bf16_f32 v117, v218, v219
    v_mfma_f32_32x32x16_bf16 v[144:159], v[56:59], v[112:115], v[144:159]
    s_add_u32 m0, s67, 20480
    s_add_u32 s69, s66, 143360
    buffer_load_dwordx4 v249, s[24:27], s69 offen lds
    v_exp_f32 v220, v220
    v_exp_f32 v221, v221
    v_exp_f32 v222, v222
    v_exp_f32 v223, v223
    v_cvt_pk_bf16_f32 v118, v220, v221
    v_cvt_pk_bf16_f32 v119, v222, v223
    v_mfma_f32_32x32x16_bf16 v[208:223], v[48:51], v[40:43], 0
    v_exp_f32 v192, v192
    v_exp_f32 v193, v193
    v_exp_f32 v194, v194
    v_exp_f32 v195, v195
    v_cvt_pk_bf16_f32 v112, v192, v193
    v_cvt_pk_bf16_f32 v113, v194, v195
    v_mfma_f32_32x32x16_bf16 v[208:223], v[52:55], v[44:47], v[208:223]
    buffer_load_dwordx4 v[104:107], v2, s[4:7], s61 offen offset:2048 sc1
    v_exp_f32 v196, v196
    v_exp_f32 v197, v197
    v_exp_f32 v198, v198
    v_exp_f32 v199, v199
    v_cvt_pk_bf16_f32 v114, v196, v197
    v_cvt_pk_bf16_f32 v115, v198, v199
    v_mfma_f32_32x32x16_bf16 v[144:159], v[60:63], v[116:119], v[144:159]
    s_add_u32 m0, s67, 21504
    s_add_u32 s69, s66, 150528
    buffer_load_dwordx4 v249, s[24:27], s69 offen lds
    v_exp_f32 v200, v200
    v_exp_f32 v201, v201
    v_exp_f32 v202, v202
    v_exp_f32 v203, v203
    v_cvt_pk_bf16_f32 v116, v200, v201
    v_cvt_pk_bf16_f32 v117, v202, v203
    v_mfma_f32_32x32x16_bf16 v[160:175], v[56:59], v[112:115], v[160:175]
    buffer_load_dwordx4 v[108:111], v2, s[4:7], s61 offen offset:3072 sc1
    s_addk_i32 s61, 4096
    v_exp_f32 v204, v204
    v_exp_f32 v205, v205
    v_exp_f32 v206, v206
    v_exp_f32_e64 v207, v207
    v_cvt_pk_bf16_f32 v118, v204, v205
    v_cvt_pk_bf16_f32 v119, v206, v207
    s_waitcnt vmcnt(20)
    s_lshr_b32 s49, s59, 1
    s_lshl_b32 s49, s49, 7
    s_nop 0
    s_add_u32 s52, s49, 16779264
    buffer_load_dword v7, v252, s[4:7], s52 offen sc1
    v_mfma_f32_32x32x16_bf16 v[192:207], v[64:67], v[16:19], 0
    v_exp_f32 v208, v208
    v_exp_f32 v209, v209
    v_exp_f32 v210, v210
    v_exp_f32 v211, v211
    v_cvt_pk_bf16_f32 v112, v208, v209
    v_cvt_pk_bf16_f32 v113, v210, v211
    v_mfma_f32_32x32x16_bf16 v[192:207], v[68:71], v[20:23], v[192:207]
    s_add_u32 m0, s67, 22528
    s_add_u32 s69, s66, 157696
    buffer_load_dwordx4 v249, s[24:27], s69 offen lds
    v_exp_f32 v212, v212
    v_exp_f32 v213, v213
    v_exp_f32 v214, v214
    v_exp_f32 v215, v215
    v_cvt_pk_bf16_f32 v114, v212, v213
    v_cvt_pk_bf16_f32 v115, v214, v215
    v_mfma_f32_32x32x16_bf16 v[160:175], v[60:63], v[116:119], v[160:175]
    s_add_u32 m0, s67, 23552
    s_add_u32 s69, s66, 164864
    buffer_load_dwordx4 v249, s[24:27], s69 offen lds
    v_exp_f32 v216, v216
    v_exp_f32 v217, v217
    v_exp_f32 v218, v218
    v_exp_f32 v219, v219
    v_cvt_pk_bf16_f32 v116, v216, v217
    v_cvt_pk_bf16_f32 v117, v218, v219
    v_mfma_f32_32x32x16_bf16 v[176:191], v[56:59], v[112:115], v[176:191]
    v_exp_f32 v220, v220
    v_exp_f32 v221, v221
    v_exp_f32 v222, v222
    v_exp_f32 v223, v223
    v_cvt_pk_bf16_f32 v118, v220, v221
    v_cvt_pk_bf16_f32 v119, v222, v223
    v_mfma_f32_32x32x16_bf16 v[208:223], v[64:67], v[24:27], 0
    v_exp_f32 v192, v192
    v_exp_f32 v193, v193
    v_exp_f32 v194, v194
    v_exp_f32 v195, v195
    v_cvt_pk_bf16_f32 v112, v192, v193
    v_cvt_pk_bf16_f32 v113, v194, v195
    v_mfma_f32_32x32x16_bf16 v[208:223], v[68:71], v[28:31], v[208:223]
    v_exp_f32 v196, v196
    v_exp_f32 v197, v197
    v_exp_f32 v198, v198
    v_exp_f32 v199, v199
    v_cvt_pk_bf16_f32 v114, v196, v197
    v_cvt_pk_bf16_f32 v115, v198, v199
    v_mfma_f32_32x32x16_bf16 v[176:191], v[60:63], v[116:119], v[176:191]
    buffer_load_dwordx4 v[48:51], v2, s[4:7], s61 offen sc1
    v_exp_f32 v200, v200
    v_exp_f32 v201, v201
    v_exp_f32 v202, v202
    v_exp_f32 v203, v203
    v_cvt_pk_bf16_f32 v116, v200, v201
    v_cvt_pk_bf16_f32 v117, v202, v203
    v_mfma_f32_32x32x16_bf16 v[128:143], v[72:75], v[112:115], v[128:143]
    s_add_u32 m0, s67, 24576
    s_add_u32 s69, s66, 172032
    buffer_load_dwordx4 v249, s[24:27], s69 offen lds
    v_exp_f32 v204, v204
    v_exp_f32 v205, v205
    v_exp_f32 v206, v206
    v_exp_f32 v207, v207
    v_cvt_pk_bf16_f32 v118, v204, v205
    v_cvt_pk_bf16_f32 v119, v206, v207
    v_mfma_f32_32x32x16_bf16 v[192:207], v[64:67], v[32:35], 0
    v_exp_f32 v208, v208
    v_exp_f32 v209, v209
    v_exp_f32 v210, v210
    v_exp_f32 v211, v211
    v_cvt_pk_bf16_f32 v112, v208, v209
    v_cvt_pk_bf16_f32 v113, v210, v211
    v_mfma_f32_32x32x16_bf16 v[192:207], v[68:71], v[36:39], v[192:207]
    buffer_load_dwordx4 v[52:55], v2, s[4:7], s61 offen offset:1024 sc1
    v_exp_f32 v212, v212
    v_exp_f32 v213, v213
    v_exp_f32 v214, v214
    v_exp_f32 v215, v215
    v_cvt_pk_bf16_f32 v114, v212, v213
    v_cvt_pk_bf16_f32 v115, v214, v215
    v_mfma_f32_32x32x16_bf16 v[128:143], v[76:79], v[116:119], v[128:143]
    v_exp_f32 v216, v216
    v_exp_f32 v217, v217
    v_exp_f32 v218, v218
    v_exp_f32 v219, v219
    v_cvt_pk_bf16_f32 v116, v216, v217
    v_cvt_pk_bf16_f32 v117, v218, v219
    v_mfma_f32_32x32x16_bf16 v[144:159], v[72:75], v[112:115], v[144:159]
    s_add_u32 m0, s67, 25600
    s_add_u32 s69, s66, 179200
    buffer_load_dwordx4 v249, s[24:27], s69 offen lds
    v_exp_f32 v220, v220
    v_exp_f32 v221, v221
    v_exp_f32 v222, v222
    v_exp_f32 v223, v223
    v_cvt_pk_bf16_f32 v118, v220, v221
    v_cvt_pk_bf16_f32 v119, v222, v223
    v_mfma_f32_32x32x16_bf16 v[208:223], v[64:67], v[40:43], 0
    v_exp_f32 v192, v192
    v_exp_f32 v193, v193
    v_exp_f32 v194, v194
    v_exp_f32 v195, v195
    v_cvt_pk_bf16_f32 v112, v192, v193
    v_cvt_pk_bf16_f32 v113, v194, v195
    v_mfma_f32_32x32x16_bf16 v[208:223], v[68:71], v[44:47], v[208:223]
    buffer_load_dwordx4 v[56:59], v2, s[4:7], s61 offen offset:2048 sc1
    v_exp_f32 v196, v196
    v_exp_f32 v197, v197
    v_exp_f32 v198, v198
    v_exp_f32 v199, v199
    v_cvt_pk_bf16_f32 v114, v196, v197
    v_cvt_pk_bf16_f32 v115, v198, v199
    v_mfma_f32_32x32x16_bf16 v[144:159], v[76:79], v[116:119], v[144:159]
    s_add_u32 m0, s67, 26624
    s_add_u32 s69, s66, 186368
    buffer_load_dwordx4 v249, s[24:27], s69 offen lds
    v_exp_f32 v200, v200
    v_exp_f32 v201, v201
    v_exp_f32 v202, v202
    v_exp_f32 v203, v203
    v_cvt_pk_bf16_f32 v116, v200, v201
    v_cvt_pk_bf16_f32 v117, v202, v203
    v_mfma_f32_32x32x16_bf16 v[160:175], v[72:75], v[112:115], v[160:175]
    v_exp_f32 v204, v204
    v_exp_f32 v205, v205
    v_exp_f32 v206, v206
    v_exp_f32 v207, v207
    v_cvt_pk_bf16_f32 v118, v204, v205
    v_cvt_pk_bf16_f32 v119, v206, v207
    s_waitcnt vmcnt(19)
    s_nop 0
    v_mfma_f32_32x32x16_bf16 v[192:207], v[80:83], v[16:19], 0
    buffer_load_dwordx4 v[60:63], v2, s[4:7], s61 offen offset:3072 sc1
    s_addk_i32 s61, 4096
    v_exp_f32 v208, v208
    v_exp_f32 v209, v209
    v_exp_f32 v210, v210
    v_exp_f32_e64 v211, v211
    v_cvt_pk_bf16_f32 v112, v208, v209
    v_cvt_pk_bf16_f32 v113, v210, v211
    v_mfma_f32_32x32x16_bf16 v[192:207], v[84:87], v[20:23], v[192:207]
    v_exp_f32 v212, v212
    v_exp_f32 v213, v213
    v_exp_f32 v214, v214
    v_exp_f32 v215, v215
    v_cvt_pk_bf16_f32 v114, v212, v213
    v_cvt_pk_bf16_f32 v115, v214, v215
    v_mfma_f32_32x32x16_bf16 v[160:175], v[76:79], v[116:119], v[160:175]
    s_add_u32 m0, s67, 27648
    s_add_u32 s69, s66, 193536
    buffer_load_dwordx4 v249, s[24:27], s69 offen lds
    v_exp_f32 v216, v216
    v_exp_f32 v217, v217
    v_exp_f32 v218, v218
    v_exp_f32 v219, v219
    v_cvt_pk_bf16_f32 v116, v216, v217
    v_cvt_pk_bf16_f32 v117, v218, v219
    v_mfma_f32_32x32x16_bf16 v[176:191], v[72:75], v[112:115], v[176:191]
    v_exp_f32 v220, v220
    v_exp_f32 v221, v221
    v_exp_f32 v222, v222
    v_exp_f32 v223, v223
    v_cvt_pk_bf16_f32 v118, v220, v221
    v_cvt_pk_bf16_f32 v119, v222, v223
    s_waitcnt vmcnt(10)
    v_cmp_gt_u32 vcc, 64, v7
    s_cmp_eq_u64 vcc, 0
    s_cbranch_scc1 L_hf_48_ok
    s_mov_b32 s72, 0
L_hf_48:
    s_nop 0
    buffer_load_dword v7, v252, s[4:7], s52 offen sc1
    s_waitcnt vmcnt(0)
    v_cmp_gt_u32 vcc, 64, v7
    s_cmp_eq_u64 vcc, 0
    s_cbranch_scc1 L_hf_48_ok
    s_add_u32 s72, s72, 1
    s_nop 0
    s_cmp_lt_u32 s72, 1000000
    s_cbranch_scc1 L_hf_48
    s_endpgm
L_hf_48_ok:
    v_mfma_f32_32x32x16_bf16 v[208:223], v[80:83], v[24:27], 0
    v_exp_f32 v192, v192
    v_exp_f32 v193, v193
    v_exp_f32 v194, v194
    v_exp_f32 v195, v195
    v_cvt_pk_bf16_f32 v112, v192, v193
    v_cvt_pk_bf16_f32 v113, v194, v195
    v_mfma_f32_32x32x16_bf16 v[208:223], v[84:87], v[28:31], v[208:223]
    v_exp_f32 v196, v196
    v_exp_f32 v197, v197
    v_exp_f32 v198, v198
    v_exp_f32 v199, v199
    v_cvt_pk_bf16_f32 v114, v196, v197
    v_cvt_pk_bf16_f32 v115, v198, v199
    v_mfma_f32_32x32x16_bf16 v[176:191], v[76:79], v[116:119], v[176:191]
    buffer_load_dwordx4 v[64:67], v2, s[4:7], s61 offen sc1
    v_exp_f32 v200, v200
    v_exp_f32 v201, v201
    v_exp_f32 v202, v202
    v_exp_f32 v203, v203
    v_cvt_pk_bf16_f32 v116, v200, v201
    v_cvt_pk_bf16_f32 v117, v202, v203
    v_mfma_f32_32x32x16_bf16 v[128:143], v[88:91], v[112:115], v[128:143]
    s_add_u32 s69, s64, 0
    s_nop 0
    buffer_load_dwordx4 a[0:3], v2, s[4:7], s69 offen offset:0 sc1
    v_exp_f32 v204, v204
    v_exp_f32 v205, v205
    v_exp_f32 v206, v206
    v_exp_f32 v207, v207
    v_cvt_pk_bf16_f32 v118, v204, v205
    v_cvt_pk_bf16_f32 v119, v206, v207
    v_mfma_f32_32x32x16_bf16 v[192:207], v[80:83], v[32:35], 0
    buffer_load_dwordx4 a[8:11], v2, s[4:7], s69 offen offset:1024 sc1
    v_exp_f32 v208, v208
    v_exp_f32 v209, v209
    v_exp_f32 v210, v210
    v_exp_f32 v211, v211
    v_cvt_pk_bf16_f32 v112, v208, v209
    v_cvt_pk_bf16_f32 v113, v210, v211
    v_mfma_f32_32x32x16_bf16 v[192:207], v[84:87], v[36:39], v[192:207]
    v_exp_f32 v212, v212
    v_exp_f32 v213, v213
    v_exp_f32 v214, v214
    v_exp_f32 v215, v215
    v_cvt_pk_bf16_f32 v114, v212, v213
    v_cvt_pk_bf16_f32 v115, v214, v215
    v_mfma_f32_32x32x16_bf16 v[128:143], v[92:95], v[116:119], v[128:143]
    buffer_load_dwordx4 v[68:71], v2, s[4:7], s61 offen offset:1024 sc1
    v_exp_f32 v216, v216
    v_exp_f32 v217, v217
    v_exp_f32 v218, v218
    v_exp_f32 v219, v219
    v_cvt_pk_bf16_f32 v116, v216, v217
    v_cvt_pk_bf16_f32 v117, v218, v219
    v_mfma_f32_32x32x16_bf16 v[144:159], v[88:91], v[112:115], v[144:159]
    buffer_load_dwordx4 a[16:19], v2, s[4:7], s69 offen offset:2048 sc1
    v_exp_f32 v220, v220
    v_exp_f32 v221, v221
    v_exp_f32 v222, v222
    v_exp_f32 v223, v223
    v_cvt_pk_bf16_f32 v118, v220, v221
    v_cvt_pk_bf16_f32 v119, v222, v223
    v_mfma_f32_32x32x16_bf16 v[208:223], v[80:83], v[40:43], 0
    v_exp_f32 v192, v192
    v_exp_f32 v193, v193
    v_exp_f32 v194, v194
    v_exp_f32 v195, v195
    v_cvt_pk_bf16_f32 v112, v192, v193
    v_cvt_pk_bf16_f32 v113, v194, v195
    v_mfma_f32_32x32x16_bf16 v[208:223], v[84:87], v[44:47], v[208:223]
    buffer_load_dwordx4 v[72:75], v2, s[4:7], s61 offen offset:2048 sc1
    v_exp_f32 v196, v196
    v_exp_f32 v197, v197
    v_exp_f32 v198, v198
    v_exp_f32 v199, v199
    v_cvt_pk_bf16_f32 v114, v196, v197
    v_cvt_pk_bf16_f32 v115, v198, v199
    v_mfma_f32_32x32x16_bf16 v[144:159], v[92:95], v[116:119], v[144:159]
    buffer_load_dwordx4 a[24:27], v2, s[4:7], s69 offen offset:3072 sc1
    v_exp_f32 v200, v200
    v_exp_f32 v201, v201
    v_exp_f32 v202, v202
    v_exp_f32 v203, v203
    v_cvt_pk_bf16_f32 v116, v200, v201
    v_cvt_pk_bf16_f32 v117, v202, v203
    v_mfma_f32_32x32x16_bf16 v[160:175], v[88:91], v[112:115], v[160:175]
    buffer_load_dwordx4 v[76:79], v2, s[4:7], s61 offen offset:3072 sc1
    s_addk_i32 s61, 4096
    v_exp_f32 v204, v204
    v_exp_f32 v205, v205
    v_exp_f32 v206, v206
    v_exp_f32_e64 v207, v207
    v_cvt_pk_bf16_f32 v118, v204, v205
    v_cvt_pk_bf16_f32 v119, v206, v207
    v_mfma_f32_32x32x16_bf16 v[192:207], v[96:99], v[16:19], 0
    v_exp_f32 v208, v208
    v_exp_f32 v209, v209
    v_exp_f32 v210, v210
    v_exp_f32 v211, v211
    v_cvt_pk_bf16_f32 v112, v208, v209
    v_cvt_pk_bf16_f32 v113, v210, v211
    v_mfma_f32_32x32x16_bf16 v[192:207], v[100:103], v[20:23], v[192:207]
    s_add_u32 s69, s98, 0
    s_nop 0
    buffer_load_dwordx4 a[4:7], v2, s[4:7], s69 offen offset:0 sc1
    v_exp_f32 v212, v212
    v_exp_f32 v213, v213
    v_exp_f32 v214, v214
    v_exp_f32 v215, v215
    v_cvt_pk_bf16_f32 v114, v212, v213
    v_cvt_pk_bf16_f32 v115, v214, v215
    v_mfma_f32_32x32x16_bf16 v[160:175], v[92:95], v[116:119], v[160:175]
    buffer_load_dwordx4 a[12:15], v2, s[4:7], s69 offen offset:1024 sc1
    v_exp_f32 v216, v216
    v_exp_f32 v217, v217
    v_exp_f32 v218, v218
    v_exp_f32 v219, v219
    v_cvt_pk_bf16_f32 v116, v216, v217
    v_cvt_pk_bf16_f32 v117, v218, v219
    v_mfma_f32_32x32x16_bf16 v[176:191], v[88:91], v[112:115], v[176:191]
    v_exp_f32 v220, v220
    v_exp_f32 v221, v221
    v_exp_f32 v222, v222
    v_exp_f32 v223, v223
    v_cvt_pk_bf16_f32 v118, v220, v221
    v_cvt_pk_bf16_f32 v119, v222, v223
    v_mfma_f32_32x32x16_bf16 v[208:223], v[96:99], v[24:27], 0
    v_exp_f32 v192, v192
    v_exp_f32 v193, v193
    v_exp_f32 v194, v194
    v_exp_f32 v195, v195
    v_cvt_pk_bf16_f32 v112, v192, v193
    v_cvt_pk_bf16_f32 v113, v194, v195
    v_mfma_f32_32x32x16_bf16 v[208:223], v[100:103], v[28:31], v[208:223]
    v_exp_f32 v196, v196
    v_exp_f32 v197, v197
    v_exp_f32 v198, v198
    v_exp_f32 v199, v199
    v_cvt_pk_bf16_f32 v114, v196, v197
    v_cvt_pk_bf16_f32 v115, v198, v199
    v_mfma_f32_32x32x16_bf16 v[176:191], v[92:95], v[116:119], v[176:191]
    buffer_load_dwordx4 v[80:83], v2, s[4:7], s61 offen sc1
    v_exp_f32 v200, v200
    v_exp_f32 v201, v201
    v_exp_f32 v202, v202
    v_exp_f32 v203, v203
    v_cvt_pk_bf16_f32 v116, v200, v201
    v_cvt_pk_bf16_f32 v117, v202, v203
    v_mfma_f32_32x32x16_bf16 v[128:143], v[104:107], v[112:115], v[128:143]
    buffer_load_dwordx4 a[20:23], v2, s[4:7], s69 offen offset:2048 sc1
    v_exp_f32 v204, v204
    v_exp_f32 v205, v205
    v_exp_f32 v206, v206
    v_exp_f32 v207, v207
    v_cvt_pk_bf16_f32 v118, v204, v205
    v_cvt_pk_bf16_f32 v119, v206, v207
    v_mfma_f32_32x32x16_bf16 v[192:207], v[96:99], v[32:35], 0
    buffer_load_dwordx4 a[28:31], v2, s[4:7], s69 offen offset:3072 sc1
    v_exp_f32 v208, v208
    v_exp_f32 v209, v209
    v_exp_f32 v210, v210
    v_exp_f32 v211, v211
    v_cvt_pk_bf16_f32 v112, v208, v209
    v_cvt_pk_bf16_f32 v113, v210, v211
    v_mfma_f32_32x32x16_bf16 v[192:207], v[100:103], v[36:39], v[192:207]
    v_exp_f32 v212, v212
    v_exp_f32 v213, v213
    v_exp_f32 v214, v214
    v_exp_f32 v215, v215
    v_cvt_pk_bf16_f32 v114, v212, v213
    v_cvt_pk_bf16_f32 v115, v214, v215
    v_mfma_f32_32x32x16_bf16 v[128:143], v[108:111], v[116:119], v[128:143]
    buffer_load_dwordx4 v[84:87], v2, s[4:7], s61 offen offset:1024 sc1
    v_exp_f32 v216, v216
    v_exp_f32 v217, v217
    v_exp_f32 v218, v218
    v_exp_f32 v219, v219
    v_cvt_pk_bf16_f32 v116, v216, v217
    v_cvt_pk_bf16_f32 v117, v218, v219
    v_mfma_f32_32x32x16_bf16 v[144:159], v[104:107], v[112:115], v[144:159]
    s_add_u32 s69, s64, 4096
    buffer_load_dwordx4 a[32:35], v2, s[4:7], s69 offen offset:0 sc1
    v_exp_f32 v220, v220
    v_exp_f32 v221, v221
    v_exp_f32 v222, v222
    v_exp_f32 v223, v223
    v_cvt_pk_bf16_f32 v118, v220, v221
    v_cvt_pk_bf16_f32 v119, v222, v223
    v_mfma_f32_32x32x16_bf16 v[208:223], v[96:99], v[40:43], 0
    v_exp_f32 v192, v192
    v_exp_f32 v193, v193
    v_exp_f32 v194, v194
    v_exp_f32 v195, v195
    v_cvt_pk_bf16_f32 v112, v192, v193
    v_cvt_pk_bf16_f32 v113, v194, v195
    v_mfma_f32_32x32x16_bf16 v[208:223], v[100:103], v[44:47], v[208:223]
    buffer_load_dwordx4 v[88:91], v2, s[4:7], s61 offen offset:2048 sc1
    v_exp_f32 v196, v196
    v_exp_f32 v197, v197
    v_exp_f32 v198, v198
    v_exp_f32 v199, v199
    v_cvt_pk_bf16_f32 v114, v196, v197
    v_cvt_pk_bf16_f32 v115, v198, v199
    v_mfma_f32_32x32x16_bf16 v[144:159], v[108:111], v[116:119], v[144:159]
    buffer_load_dwordx4 a[40:43], v2, s[4:7], s69 offen offset:1024 sc1
    v_exp_f32 v200, v200
    v_exp_f32 v201, v201
    v_exp_f32 v202, v202
    v_exp_f32 v203, v203
    v_cvt_pk_bf16_f32 v116, v200, v201
    v_cvt_pk_bf16_f32 v117, v202, v203
    v_mfma_f32_32x32x16_bf16 v[160:175], v[104:107], v[112:115], v[160:175]
    buffer_load_dwordx4 v[92:95], v2, s[4:7], s61 offen offset:3072 sc1
    s_addk_i32 s61, 4096
    v_exp_f32 v204, v204
    v_exp_f32 v205, v205
    v_exp_f32 v206, v206
    v_exp_f32_e64 v207, v207
    v_cvt_pk_bf16_f32 v118, v204, v205
    v_cvt_pk_bf16_f32 v119, v206, v207
    s_waitcnt vmcnt(19)
    s_nop 0
    v_mfma_f32_32x32x16_bf16 v[192:207], v[48:51], v[16:19], 0
    v_exp_f32 v208, v208
    v_exp_f32 v209, v209
    v_exp_f32 v210, v210
    v_exp_f32 v211, v211
    v_cvt_pk_bf16_f32 v112, v208, v209
    v_cvt_pk_bf16_f32 v113, v210, v211
    v_mfma_f32_32x32x16_bf16 v[192:207], v[52:55], v[20:23], v[192:207]
    buffer_load_dwordx4 a[48:51], v2, s[4:7], s69 offen offset:2048 sc1
    v_exp_f32 v212, v212
    v_exp_f32 v213, v213
    v_exp_f32 v214, v214
    v_exp_f32 v215, v215
    v_cvt_pk_bf16_f32 v114, v212, v213
    v_cvt_pk_bf16_f32 v115, v214, v215
    v_mfma_f32_32x32x16_bf16 v[160:175], v[108:111], v[116:119], v[160:175]
    buffer_load_dwordx4 a[56:59], v2, s[4:7], s69 offen offset:3072 sc1
    s_add_u32 s69, s98, 4096
    v_exp_f32 v216, v216
    v_exp_f32 v217, v217
    v_exp_f32 v218, v218
    v_exp_f32 v219, v219
    v_cvt_pk_bf16_f32 v116, v216, v217
    v_cvt_pk_bf16_f32 v117, v218, v219
    v_mfma_f32_32x32x16_bf16 v[176:191], v[104:107], v[112:115], v[176:191]
    v_exp_f32 v220, v220
    v_exp_f32 v221, v221
    v_exp_f32 v222, v222
    v_exp_f32 v223, v223
    v_cvt_pk_bf16_f32 v118, v220, v221
    v_cvt_pk_bf16_f32 v119, v222, v223
    v_mfma_f32_32x32x16_bf16 v[208:223], v[48:51], v[24:27], 0
    v_exp_f32 v192, v192
    v_exp_f32 v193, v193
    v_exp_f32 v194, v194
    v_exp_f32 v195, v195
    v_cvt_pk_bf16_f32 v112, v192, v193
    v_cvt_pk_bf16_f32 v113, v194, v195
    v_mfma_f32_32x32x16_bf16 v[208:223], v[52:55], v[28:31], v[208:223]
    v_exp_f32 v196, v196
    v_exp_f32 v197, v197
    v_exp_f32 v198, v198
    v_exp_f32 v199, v199
    v_cvt_pk_bf16_f32 v114, v196, v197
    v_cvt_pk_bf16_f32 v115, v198, v199
    v_mfma_f32_32x32x16_bf16 v[176:191], v[108:111], v[116:119], v[176:191]
    buffer_load_dwordx4 v[96:99], v2, s[4:7], s61 offen sc1
    v_exp_f32 v200, v200
    v_exp_f32 v201, v201
    v_exp_f32 v202, v202
    v_exp_f32 v203, v203
    v_cvt_pk_bf16_f32 v116, v200, v201
    v_cvt_pk_bf16_f32 v117, v202, v203
    v_mfma_f32_32x32x16_bf16 v[128:143], v[56:59], v[112:115], v[128:143]
    buffer_load_dwordx4 a[36:39], v2, s[4:7], s69 offen offset:0 sc1
    v_exp_f32 v204, v204
    v_exp_f32 v205, v205
    v_exp_f32 v206, v206
    v_exp_f32 v207, v207
    v_cvt_pk_bf16_f32 v118, v204, v205
    v_cvt_pk_bf16_f32 v119, v206, v207
    v_mfma_f32_32x32x16_bf16 v[192:207], v[48:51], v[32:35], 0
    buffer_load_dwordx4 a[44:47], v2, s[4:7], s69 offen offset:1024 sc1
    v_exp_f32 v208, v208
    v_exp_f32 v209, v209
    v_exp_f32 v210, v210
    v_exp_f32 v211, v211
    v_cvt_pk_bf16_f32 v112, v208, v209
    v_cvt_pk_bf16_f32 v113, v210, v211
    v_mfma_f32_32x32x16_bf16 v[192:207], v[52:55], v[36:39], v[192:207]
    buffer_load_dwordx4 v[100:103], v2, s[4:7], s61 offen offset:1024 sc1
    v_exp_f32 v212, v212
    v_exp_f32 v213, v213
    v_exp_f32 v214, v214
    v_exp_f32 v215, v215
    v_cvt_pk_bf16_f32 v114, v212, v213
    v_cvt_pk_bf16_f32 v115, v214, v215
    v_mfma_f32_32x32x16_bf16 v[128:143], v[60:63], v[116:119], v[128:143]
    v_exp_f32 v216, v216
    v_exp_f32 v217, v217
    v_exp_f32 v218, v218
    v_exp_f32 v219, v219
    v_cvt_pk_bf16_f32 v116, v216, v217
    v_cvt_pk_bf16_f32 v117, v218, v219
    v_mfma_f32_32x32x16_bf16 v[144:159], v[56:59], v[112:115], v[144:159]
    buffer_load_dwordx4 a[52:55], v2, s[4:7], s69 offen offset:2048 sc1
    v_exp_f32 v220, v220
    v_exp_f32 v221, v221
    v_exp_f32 v222, v222
    v_exp_f32 v223, v223
    v_cvt_pk_bf16_f32 v118, v220, v221
    v_cvt_pk_bf16_f32 v119, v222, v223
    v_mfma_f32_32x32x16_bf16 v[208:223], v[48:51], v[40:43], 0
    buffer_load_dwordx4 a[60:63], v2, s[4:7], s69 offen offset:3072 sc1
    v_exp_f32 v192, v192
    v_exp_f32 v193, v193
    v_exp_f32 v194, v194
    v_exp_f32 v195, v195
    v_cvt_pk_bf16_f32 v112, v192, v193
    v_cvt_pk_bf16_f32 v113, v194, v195
    v_mfma_f32_32x32x16_bf16 v[208:223], v[52:55], v[44:47], v[208:223]
    buffer_load_dwordx4 v[104:107], v2, s[4:7], s61 offen offset:2048 sc1
    v_exp_f32 v196, v196
    v_exp_f32 v197, v197
    v_exp_f32 v198, v198
    v_exp_f32 v199, v199
    v_cvt_pk_bf16_f32 v114, v196, v197
    v_cvt_pk_bf16_f32 v115, v198, v199
    v_mfma_f32_32x32x16_bf16 v[144:159], v[60:63], v[116:119], v[144:159]
    s_add_u32 s69, s64, 8192
    buffer_load_dwordx4 a[64:67], v2, s[4:7], s69 offen offset:0 sc1
    v_exp_f32 v200, v200
    v_exp_f32 v201, v201
    v_exp_f32 v202, v202
    v_exp_f32 v203, v203
    v_cvt_pk_bf16_f32 v116, v200, v201
    v_cvt_pk_bf16_f32 v117, v202, v203
    v_mfma_f32_32x32x16_bf16 v[160:175], v[56:59], v[112:115], v[160:175]
    v_exp_f32 v204, v204
    v_exp_f32 v205, v205
    v_exp_f32 v206, v206
    v_exp_f32 v207, v207
    v_cvt_pk_bf16_f32 v118, v204, v205
    v_cvt_pk_bf16_f32 v119, v206, v207
    s_waitcnt vmcnt(20)
    s_nop 0
    v_mfma_f32_32x32x16_bf16 v[192:207], v[64:67], v[16:19], 0
    buffer_load_dwordx4 v[108:111], v2, s[4:7], s61 offen offset:3072 sc1
    s_addk_i32 s61, 4096
    v_exp_f32 v208, v208
    v_exp_f32 v209, v209
    v_exp_f32 v210, v210
    v_exp_f32_e64 v211, v211
    v_cvt_pk_bf16_f32 v112, v208, v209
    v_cvt_pk_bf16_f32 v113, v210, v211
    v_mfma_f32_32x32x16_bf16 v[192:207], v[68:71], v[20:23], v[192:207]
    buffer_load_dwordx4 a[72:75], v2, s[4:7], s69 offen offset:1024 sc1
    v_exp_f32 v212, v212
    v_exp_f32 v213, v213
    v_exp_f32 v214, v214
    v_exp_f32 v215, v215
    v_cvt_pk_bf16_f32 v114, v212, v213
    v_cvt_pk_bf16_f32 v115, v214, v215
    v_mfma_f32_32x32x16_bf16 v[160:175], v[60:63], v[116:119], v[160:175]
    buffer_load_dwordx4 a[80:83], v2, s[4:7], s69 offen offset:2048 sc1
    v_exp_f32 v216, v216
    v_exp_f32 v217, v217
    v_exp_f32 v218, v218
    v_exp_f32 v219, v219
    v_cvt_pk_bf16_f32 v116, v216, v217
    v_cvt_pk_bf16_f32 v117, v218, v219
    v_mfma_f32_32x32x16_bf16 v[176:191], v[56:59], v[112:115], v[176:191]
    v_exp_f32 v220, v220
    v_exp_f32 v221, v221
    v_exp_f32 v222, v222
    v_exp_f32 v223, v223
    v_cvt_pk_bf16_f32 v118, v220, v221
    v_cvt_pk_bf16_f32 v119, v222, v223
    v_mfma_f32_32x32x16_bf16 v[208:223], v[64:67], v[24:27], 0
    v_exp_f32 v192, v192
    v_exp_f32 v193, v193
    v_exp_f32 v194, v194
    v_exp_f32 v195, v195
    v_cvt_pk_bf16_f32 v112, v192, v193
    v_cvt_pk_bf16_f32 v113, v194, v195
    v_mfma_f32_32x32x16_bf16 v[208:223], v[68:71], v[28:31], v[208:223]
    v_exp_f32 v196, v196
    v_exp_f32 v197, v197
    v_exp_f32 v198, v198
    v_exp_f32 v199, v199
    v_cvt_pk_bf16_f32 v114, v196, v197
    v_cvt_pk_bf16_f32 v115, v198, v199
    v_mfma_f32_32x32x16_bf16 v[176:191], v[60:63], v[116:119], v[176:191]
    buffer_load_dwordx4 v[48:51], v2, s[4:7], s61 offen sc1
    v_exp_f32 v200, v200
    v_exp_f32 v201, v201
    v_exp_f32 v202, v202
    v_exp_f32 v203, v203
    v_cvt_pk_bf16_f32 v116, v200, v201
    v_cvt_pk_bf16_f32 v117, v202, v203
    v_mfma_f32_32x32x16_bf16 v[128:143], v[72:75], v[112:115], v[128:143]
    buffer_load_dwordx4 a[88:91], v2, s[4:7], s69 offen offset:3072 sc1
    v_exp_f32 v204, v204
    v_exp_f32 v205, v205
    v_exp_f32 v206, v206
    v_exp_f32 v207, v207
    v_cvt_pk_bf16_f32 v118, v204, v205
    v_cvt_pk_bf16_f32 v119, v206, v207
    v_mfma_f32_32x32x16_bf16 v[192:207], v[64:67], v[32:35], 0
    s_add_u32 s69, s98, 8192
    buffer_load_dwordx4 a[68:71], v2, s[4:7], s69 offen offset:0 sc1
    v_exp_f32 v208, v208
    v_exp_f32 v209, v209
    v_exp_f32 v210, v210
    v_exp_f32 v211, v211
    v_cvt_pk_bf16_f32 v112, v208, v209
    v_cvt_pk_bf16_f32 v113, v210, v211
    v_mfma_f32_32x32x16_bf16 v[192:207], v[68:71], v[36:39], v[192:207]
    v_exp_f32 v212, v212
    v_exp_f32 v213, v213
    v_exp_f32 v214, v214
    v_exp_f32 v215, v215
    v_cvt_pk_bf16_f32 v114, v212, v213
    v_cvt_pk_bf16_f32 v115, v214, v215
    v_mfma_f32_32x32x16_bf16 v[128:143], v[76:79], v[116:119], v[128:143]
    buffer_load_dwordx4 v[52:55], v2, s[4:7], s61 offen offset:1024 sc1
    v_exp_f32 v216, v216
    v_exp_f32 v217, v217
    v_exp_f32 v218, v218
    v_exp_f32 v219, v219
    v_cvt_pk_bf16_f32 v116, v216, v217
    v_cvt_pk_bf16_f32 v117, v218, v219
    v_mfma_f32_32x32x16_bf16 v[144:159], v[72:75], v[112:115], v[144:159]
    buffer_load_dwordx4 a[76:79], v2, s[4:7], s69 offen offset:1024 sc1
    v_exp_f32 v220, v220
    v_exp_f32 v221, v221
    v_exp_f32 v222, v222
    v_exp_f32 v223, v223
    v_cvt_pk_bf16_f32 v118, v220, v221
    v_cvt_pk_bf16_f32 v119, v222, v223
    v_mfma_f32_32x32x16_bf16 v[208:223], v[64:67], v[40:43], 0
    v_exp_f32 v192, v192
    v_exp_f32 v193, v193
    v_exp_f32 v194, v194
    v_exp_f32 v195, v195
    v_cvt_pk_bf16_f32 v112, v192, v193
    v_cvt_pk_bf16_f32 v113, v194, v195
    v_mfma_f32_32x32x16_bf16 v[208:223], v[68:71], v[44:47], v[208:223]
    buffer_load_dwordx4 v[56:59], v2, s[4:7], s61 offen offset:2048 sc1
    v_exp_f32 v196, v196
    v_exp_f32 v197, v197
    v_exp_f32 v198, v198
    v_exp_f32 v199, v199
    v_cvt_pk_bf16_f32 v114, v196, v197
    v_cvt_pk_bf16_f32 v115, v198, v199
    v_mfma_f32_32x32x16_bf16 v[144:159], v[76:79], v[116:119], v[144:159]
    buffer_load_dwordx4 a[84:87], v2, s[4:7], s69 offen offset:2048 sc1
    v_exp_f32 v200, v200
    v_exp_f32 v201, v201
    v_exp_f32 v202, v202
    v_exp_f32 v203, v203
    v_cvt_pk_bf16_f32 v116, v200, v201
    v_cvt_pk_bf16_f32 v117, v202, v203
    v_mfma_f32_32x32x16_bf16 v[160:175], v[72:75], v[112:115], v[160:175]
    buffer_load_dwordx4 v[60:63], v2, s[4:7], s61 offen offset:3072 sc1
    s_addk_i32 s61, 4096
    v_exp_f32 v204, v204
    v_exp_f32 v205, v205
    v_exp_f32 v206, v206
    v_exp_f32_e64 v207, v207
    v_cvt_pk_bf16_f32 v118, v204, v205
    v_cvt_pk_bf16_f32 v119, v206, v207
    s_waitcnt vmcnt(21)
    s_nop 0
    v_mfma_f32_32x32x16_bf16 v[192:207], v[80:83], v[16:19], 0
    v_exp_f32 v208, v208
    v_exp_f32 v209, v209
    v_exp_f32 v210, v210
    v_exp_f32 v211, v211
    v_cvt_pk_bf16_f32 v112, v208, v209
    v_cvt_pk_bf16_f32 v113, v210, v211
    v_mfma_f32_32x32x16_bf16 v[192:207], v[84:87], v[20:23], v[192:207]
    buffer_load_dwordx4 a[92:95], v2, s[4:7], s69 offen offset:3072 sc1
    v_exp_f32 v212, v212
    v_exp_f32 v213, v213
    v_exp_f32 v214, v214
    v_exp_f32 v215, v215
    v_cvt_pk_bf16_f32 v114, v212, v213
    v_cvt_pk_bf16_f32 v115, v214, v215
    v_mfma_f32_32x32x16_bf16 v[160:175], v[76:79], v[116:119], v[160:175]
    s_add_u32 s69, s64, 12288
    buffer_load_dwordx4 a[96:99], v2, s[4:7], s69 offen offset:0 sc1
    v_exp_f32 v216, v216
    v_exp_f32 v217, v217
    v_exp_f32 v218, v218
    v_exp_f32 v219, v219
    v_cvt_pk_bf16_f32 v116, v216, v217
    v_cvt_pk_bf16_f32 v117, v218, v219
    v_mfma_f32_32x32x16_bf16 v[176:191], v[72:75], v[112:115], v[176:191]
    v_exp_f32 v220, v220
    v_exp_f32 v221, v221
    v_exp_f32 v222, v222
    v_exp_f32 v223, v223
    v_cvt_pk_bf16_f32 v118, v220, v221
    v_cvt_pk_bf16_f32 v119, v222, v223
    v_mfma_f32_32x32x16_bf16 v[208:223], v[80:83], v[24:27], 0
    v_exp_f32 v192, v192
    v_exp_f32 v193, v193
    v_exp_f32 v194, v194
    v_exp_f32 v195, v195
    v_cvt_pk_bf16_f32 v112, v192, v193
    v_cvt_pk_bf16_f32 v113, v194, v195
    v_mfma_f32_32x32x16_bf16 v[208:223], v[84:87], v[28:31], v[208:223]
    v_exp_f32 v196, v196
    v_exp_f32 v197, v197
    v_exp_f32 v198, v198
    v_exp_f32 v199, v199
    v_cvt_pk_bf16_f32 v114, v196, v197
    v_cvt_pk_bf16_f32 v115, v198, v199
    v_mfma_f32_32x32x16_bf16 v[176:191], v[76:79], v[116:119], v[176:191]
    buffer_load_dwordx4 v[64:67], v2, s[4:7], s61 offen sc1
    v_exp_f32 v200, v200
    v_exp_f32 v201, v201
    v_exp_f32 v202, v202
    v_exp_f32 v203, v203
    v_cvt_pk_bf16_f32 v116, v200, v201
    v_cvt_pk_bf16_f32 v117, v202, v203
    v_mfma_f32_32x32x16_bf16 v[128:143], v[88:91], v[112:115], v[128:143]
    buffer_load_dwordx4 a[104:107], v2, s[4:7], s69 offen offset:1024 sc1
    v_exp_f32 v204, v204
    v_exp_f32 v205, v205
    v_exp_f32 v206, v206
    v_exp_f32 v207, v207
    v_cvt_pk_bf16_f32 v118, v204, v205
    v_cvt_pk_bf16_f32 v119, v206, v207
    v_mfma_f32_32x32x16_bf16 v[192:207], v[80:83], v[32:35], 0
    buffer_load_dwordx4 a[112:115], v2, s[4:7], s69 offen offset:2048 sc1
    v_exp_f32 v208, v208
    v_exp_f32 v209, v209
    v_exp_f32 v210, v210
    v_exp_f32 v211, v211
    v_cvt_pk_bf16_f32 v112, v208, v209
    v_cvt_pk_bf16_f32 v113, v210, v211
    v_mfma_f32_32x32x16_bf16 v[192:207], v[84:87], v[36:39], v[192:207]
    buffer_load_dwordx4 v[68:71], v2, s[4:7], s61 offen offset:1024 sc1
    v_exp_f32 v212, v212
    v_exp_f32 v213, v213
    v_exp_f32 v214, v214
    v_exp_f32 v215, v215
    v_cvt_pk_bf16_f32 v114, v212, v213
    v_cvt_pk_bf16_f32 v115, v214, v215
    v_mfma_f32_32x32x16_bf16 v[128:143], v[92:95], v[116:119], v[128:143]
    v_exp_f32 v216, v216
    v_exp_f32 v217, v217
    v_exp_f32 v218, v218
    v_exp_f32 v219, v219
    v_cvt_pk_bf16_f32 v116, v216, v217
    v_cvt_pk_bf16_f32 v117, v218, v219
    v_mfma_f32_32x32x16_bf16 v[144:159], v[88:91], v[112:115], v[144:159]
    buffer_load_dwordx4 a[120:123], v2, s[4:7], s69 offen offset:3072 sc1
    v_exp_f32 v220, v220
    v_exp_f32 v221, v221
    v_exp_f32 v222, v222
    v_exp_f32 v223, v223
    v_cvt_pk_bf16_f32 v118, v220, v221
    v_cvt_pk_bf16_f32 v119, v222, v223
    v_mfma_f32_32x32x16_bf16 v[208:223], v[80:83], v[40:43], 0
    s_add_u32 s69, s98, 12288
    buffer_load_dwordx4 a[100:103], v2, s[4:7], s69 offen offset:0 sc1
    v_exp_f32 v192, v192
    v_exp_f32 v193, v193
    v_exp_f32 v194, v194
    v_exp_f32 v195, v195
    v_cvt_pk_bf16_f32 v112, v192, v193
    v_cvt_pk_bf16_f32 v113, v194, v195
    v_mfma_f32_32x32x16_bf16 v[208:223], v[84:87], v[44:47], v[208:223]
    buffer_load_dwordx4 v[72:75], v2, s[4:7], s61 offen offset:2048 sc1
    v_exp_f32 v196, v196
    v_exp_f32 v197, v197
    v_exp_f32 v198, v198
    v_exp_f32 v199, v199
    v_cvt_pk_bf16_f32 v114, v196, v197
    v_cvt_pk_bf16_f32 v115, v198, v199
    v_mfma_f32_32x32x16_bf16 v[144:159], v[92:95], v[116:119], v[144:159]
    buffer_load_dwordx4 a[108:111], v2, s[4:7], s69 offen offset:1024 sc1
    v_exp_f32 v200, v200
    v_exp_f32 v201, v201
    v_exp_f32 v202, v202
    v_exp_f32 v203, v203
    v_cvt_pk_bf16_f32 v116, v200, v201
    v_cvt_pk_bf16_f32 v117, v202, v203
    v_mfma_f32_32x32x16_bf16 v[160:175], v[88:91], v[112:115], v[160:175]
    v_exp_f32 v204, v204
    v_exp_f32 v205, v205
    v_exp_f32 v206, v206
    v_exp_f32 v207, v207
    v_cvt_pk_bf16_f32 v118, v204, v205
    v_cvt_pk_bf16_f32 v119, v206, v207
    s_waitcnt vmcnt(20)
    s_nop 0
    v_mfma_f32_32x32x16_bf16 v[192:207], v[96:99], v[16:19], 0
    buffer_load_dwordx4 v[76:79], v2, s[4:7], s61 offen offset:3072 sc1
    s_addk_i32 s61, 4096
    v_exp_f32 v208, v208
    v_exp_f32 v209, v209
    v_exp_f32 v210, v210
    v_exp_f32_e64 v211, v211
    v_cvt_pk_bf16_f32 v112, v208, v209
    v_cvt_pk_bf16_f32 v113, v210, v211
    v_mfma_f32_32x32x16_bf16 v[192:207], v[100:103], v[20:23], v[192:207]
    buffer_load_dwordx4 a[116:119], v2, s[4:7], s69 offen offset:2048 sc1
    v_exp_f32 v212, v212
    v_exp_f32 v213, v213
    v_exp_f32 v214, v214
    v_exp_f32 v215, v215
    v_cvt_pk_bf16_f32 v114, v212, v213
    v_cvt_pk_bf16_f32 v115, v214, v215
    v_mfma_f32_32x32x16_bf16 v[160:175], v[92:95], v[116:119], v[160:175]
    buffer_load_dwordx4 a[124:127], v2, s[4:7], s69 offen offset:3072 sc1
    v_exp_f32 v216, v216
    v_exp_f32 v217, v217
    v_exp_f32 v218, v218
    v_exp_f32 v219, v219
    v_cvt_pk_bf16_f32 v116, v216, v217
    v_cvt_pk_bf16_f32 v117, v218, v219
    v_mfma_f32_32x32x16_bf16 v[176:191], v[88:91], v[112:115], v[176:191]
    v_exp_f32 v220, v220
    v_exp_f32 v221, v221
    v_exp_f32 v222, v222
    v_exp_f32 v223, v223
    v_cvt_pk_bf16_f32 v118, v220, v221
    v_cvt_pk_bf16_f32 v119, v222, v223
    v_mfma_f32_32x32x16_bf16 v[208:223], v[96:99], v[24:27], 0
    v_exp_f32 v192, v192
    v_exp_f32 v193, v193
    v_exp_f32 v194, v194
    v_exp_f32 v195, v195
    v_cvt_pk_bf16_f32 v112, v192, v193
    v_cvt_pk_bf16_f32 v113, v194, v195
    v_mfma_f32_32x32x16_bf16 v[208:223], v[100:103], v[28:31], v[208:223]
    v_exp_f32 v196, v196
    v_exp_f32 v197, v197
    v_exp_f32 v198, v198
    v_exp_f32 v199, v199
    v_cvt_pk_bf16_f32 v114, v196, v197
    v_cvt_pk_bf16_f32 v115, v198, v199
    v_mfma_f32_32x32x16_bf16 v[176:191], v[92:95], v[116:119], v[176:191]
    buffer_load_dwordx4 v[80:83], v2, s[4:7], s61 offen sc1
    v_exp_f32 v200, v200
    v_exp_f32 v201, v201
    v_exp_f32 v202, v202
    v_exp_f32 v203, v203
    v_cvt_pk_bf16_f32 v116, v200, v201
    v_cvt_pk_bf16_f32 v117, v202, v203
    v_mfma_f32_32x32x16_bf16 v[128:143], v[104:107], v[112:115], v[128:143]
    s_add_u32 s69, s64, 16384
    buffer_load_dwordx4 a[128:131], v2, s[4:7], s69 offen offset:0 sc1
    v_exp_f32 v204, v204
    v_exp_f32 v205, v205
    v_exp_f32 v206, v206
    v_exp_f32 v207, v207
    v_cvt_pk_bf16_f32 v118, v204, v205
    v_cvt_pk_bf16_f32 v119, v206, v207
    v_mfma_f32_32x32x16_bf16 v[192:207], v[96:99], v[32:35], 0
    buffer_load_dwordx4 a[136:139], v2, s[4:7], s69 offen offset:1024 sc1
    v_exp_f32 v208, v208
    v_exp_f32 v209, v209
    v_exp_f32 v210, v210
    v_exp_f32 v211, v211
    v_cvt_pk_bf16_f32 v112, v208, v209
    v_cvt_pk_bf16_f32 v113, v210, v211
    v_mfma_f32_32x32x16_bf16 v[192:207], v[100:103], v[36:39], v[192:207]
    v_exp_f32 v212, v212
    v_exp_f32 v213, v213
    v_exp_f32 v214, v214
    v_exp_f32 v215, v215
    v_cvt_pk_bf16_f32 v114, v212, v213
    v_cvt_pk_bf16_f32 v115, v214, v215
    v_mfma_f32_32x32x16_bf16 v[128:143], v[108:111], v[116:119], v[128:143]
    buffer_load_dwordx4 v[84:87], v2, s[4:7], s61 offen offset:1024 sc1
    v_exp_f32 v216, v216
    v_exp_f32 v217, v217
    v_exp_f32 v218, v218
    v_exp_f32 v219, v219
    v_cvt_pk_bf16_f32 v116, v216, v217
    v_cvt_pk_bf16_f32 v117, v218, v219
    v_mfma_f32_32x32x16_bf16 v[144:159], v[104:107], v[112:115], v[144:159]
    buffer_load_dwordx4 a[144:147], v2, s[4:7], s69 offen offset:2048 sc1
    v_exp_f32 v220, v220
    v_exp_f32 v221, v221
    v_exp_f32 v222, v222
    v_exp_f32 v223, v223
    v_cvt_pk_bf16_f32 v118, v220, v221
    v_cvt_pk_bf16_f32 v119, v222, v223
    v_mfma_f32_32x32x16_bf16 v[208:223], v[96:99], v[40:43], 0
    v_exp_f32 v192, v192
    v_exp_f32 v193, v193
    v_exp_f32 v194, v194
    v_exp_f32 v195, v195
    v_cvt_pk_bf16_f32 v112, v192, v193
    v_cvt_pk_bf16_f32 v113, v194, v195
    v_mfma_f32_32x32x16_bf16 v[208:223], v[100:103], v[44:47], v[208:223]
    buffer_load_dwordx4 v[88:91], v2, s[4:7], s61 offen offset:2048 sc1
    v_exp_f32 v196, v196
    v_exp_f32 v197, v197
    v_exp_f32 v198, v198
    v_exp_f32 v199, v199
    v_cvt_pk_bf16_f32 v114, v196, v197
    v_cvt_pk_bf16_f32 v115, v198, v199
    v_mfma_f32_32x32x16_bf16 v[144:159], v[108:111], v[116:119], v[144:159]
    buffer_load_dwordx4 a[152:155], v2, s[4:7], s69 offen offset:3072 sc1
    v_exp_f32 v200, v200
    v_exp_f32 v201, v201
    v_exp_f32 v202, v202
    v_exp_f32 v203, v203
    v_cvt_pk_bf16_f32 v116, v200, v201
    v_cvt_pk_bf16_f32 v117, v202, v203
    v_mfma_f32_32x32x16_bf16 v[160:175], v[104:107], v[112:115], v[160:175]
    buffer_load_dwordx4 v[92:95], v2, s[4:7], s61 offen offset:3072 sc1
    s_addk_i32 s61, 4096
    v_exp_f32 v204, v204
    v_exp_f32 v205, v205
    v_exp_f32 v206, v206
    v_exp_f32_e64 v207, v207
    v_cvt_pk_bf16_f32 v118, v204, v205
    v_cvt_pk_bf16_f32 v119, v206, v207
    s_waitcnt vmcnt(21)
    s_nop 0
    v_mfma_f32_32x32x16_bf16 v[192:207], v[48:51], v[16:19], 0
    v_exp_f32 v208, v208
    v_exp_f32 v209, v209
    v_exp_f32 v210, v210
    v_exp_f32 v211, v211
    v_cvt_pk_bf16_f32 v112, v208, v209
    v_cvt_pk_bf16_f32 v113, v210, v211
    v_mfma_f32_32x32x16_bf16 v[192:207], v[52:55], v[20:23], v[192:207]
    s_add_u32 s69, s98, 16384
    buffer_load_dwordx4 a[132:135], v2, s[4:7], s69 offen offset:0 sc1
    v_exp_f32 v212, v212
    v_exp_f32 v213, v213
    v_exp_f32 v214, v214
    v_exp_f32 v215, v215
    v_cvt_pk_bf16_f32 v114, v212, v213
    v_cvt_pk_bf16_f32 v115, v214, v215
    v_mfma_f32_32x32x16_bf16 v[160:175], v[108:111], v[116:119], v[160:175]
    buffer_load_dwordx4 a[140:143], v2, s[4:7], s69 offen offset:1024 sc1
    v_exp_f32 v216, v216
    v_exp_f32 v217, v217
    v_exp_f32 v218, v218
    v_exp_f32 v219, v219
    v_cvt_pk_bf16_f32 v116, v216, v217
    v_cvt_pk_bf16_f32 v117, v218, v219
    v_mfma_f32_32x32x16_bf16 v[176:191], v[104:107], v[112:115], v[176:191]
    v_exp_f32 v220, v220
    v_exp_f32 v221, v221
    v_exp_f32 v222, v222
    v_exp_f32 v223, v223
    v_cvt_pk_bf16_f32 v118, v220, v221
    v_cvt_pk_bf16_f32 v119, v222, v223
    v_mfma_f32_32x32x16_bf16 v[208:223], v[48:51], v[24:27], 0
    v_exp_f32 v192, v192
    v_exp_f32 v193, v193
    v_exp_f32 v194, v194
    v_exp_f32 v195, v195
    v_cvt_pk_bf16_f32 v112, v192, v193
    v_cvt_pk_bf16_f32 v113, v194, v195
    v_mfma_f32_32x32x16_bf16 v[208:223], v[52:55], v[28:31], v[208:223]
    v_exp_f32 v196, v196
    v_exp_f32 v197, v197
    v_exp_f32 v198, v198
    v_exp_f32 v199, v199
    v_cvt_pk_bf16_f32 v114, v196, v197
    v_cvt_pk_bf16_f32 v115, v198, v199
    v_mfma_f32_32x32x16_bf16 v[176:191], v[108:111], v[116:119], v[176:191]
    buffer_load_dwordx4 v[96:99], v2, s[4:7], s61 offen sc1
    v_exp_f32 v200, v200
    v_exp_f32 v201, v201
    v_exp_f32 v202, v202
    v_exp_f32 v203, v203
    v_cvt_pk_bf16_f32 v116, v200, v201
    v_cvt_pk_bf16_f32 v117, v202, v203
    v_mfma_f32_32x32x16_bf16 v[128:143], v[56:59], v[112:115], v[128:143]
    buffer_load_dwordx4 a[148:151], v2, s[4:7], s69 offen offset:2048 sc1
    v_exp_f32 v204, v204
    v_exp_f32 v205, v205
    v_exp_f32 v206, v206
    v_exp_f32 v207, v207
    v_cvt_pk_bf16_f32 v118, v204, v205
    v_cvt_pk_bf16_f32 v119, v206, v207
    v_mfma_f32_32x32x16_bf16 v[192:207], v[48:51], v[32:35], 0
    buffer_load_dwordx4 a[156:159], v2, s[4:7], s69 offen offset:3072 sc1
    v_exp_f32 v208, v208
    v_exp_f32 v209, v209
    v_exp_f32 v210, v210
    v_exp_f32 v211, v211
    v_cvt_pk_bf16_f32 v112, v208, v209
    v_cvt_pk_bf16_f32 v113, v210, v211
    v_mfma_f32_32x32x16_bf16 v[192:207], v[52:55], v[36:39], v[192:207]
    v_exp_f32 v212, v212
    v_exp_f32 v213, v213
    v_exp_f32 v214, v214
    v_exp_f32 v215, v215
    v_cvt_pk_bf16_f32 v114, v212, v213
    v_cvt_pk_bf16_f32 v115, v214, v215
    v_mfma_f32_32x32x16_bf16 v[128:143], v[60:63], v[116:119], v[128:143]
    buffer_load_dwordx4 v[100:103], v2, s[4:7], s61 offen offset:1024 sc1
    v_exp_f32 v216, v216
    v_exp_f32 v217, v217
    v_exp_f32 v218, v218
    v_exp_f32 v219, v219
    v_cvt_pk_bf16_f32 v116, v216, v217
    v_cvt_pk_bf16_f32 v117, v218, v219
    v_mfma_f32_32x32x16_bf16 v[144:159], v[56:59], v[112:115], v[144:159]
    s_add_u32 s69, s64, 20480
    buffer_load_dwordx4 a[160:163], v2, s[4:7], s69 offen offset:0 sc1
    v_exp_f32 v220, v220
    v_exp_f32 v221, v221
    v_exp_f32 v222, v222
    v_exp_f32 v223, v223
    v_cvt_pk_bf16_f32 v118, v220, v221
    v_cvt_pk_bf16_f32 v119, v222, v223
    v_mfma_f32_32x32x16_bf16 v[208:223], v[48:51], v[40:43], 0
    v_exp_f32 v192, v192
    v_exp_f32 v193, v193
    v_exp_f32 v194, v194
    v_exp_f32 v195, v195
    v_cvt_pk_bf16_f32 v112, v192, v193
    v_cvt_pk_bf16_f32 v113, v194, v195
    v_mfma_f32_32x32x16_bf16 v[208:223], v[52:55], v[44:47], v[208:223]
    buffer_load_dwordx4 v[104:107], v2, s[4:7], s61 offen offset:2048 sc1
    v_exp_f32 v196, v196
    v_exp_f32 v197, v197
    v_exp_f32 v198, v198
    v_exp_f32 v199, v199
    v_cvt_pk_bf16_f32 v114, v196, v197
    v_cvt_pk_bf16_f32 v115, v198, v199
    v_mfma_f32_32x32x16_bf16 v[144:159], v[60:63], v[116:119], v[144:159]
    buffer_load_dwordx4 a[168:171], v2, s[4:7], s69 offen offset:1024 sc1
    v_exp_f32 v200, v200
    v_exp_f32 v201, v201
    v_exp_f32 v202, v202
    v_exp_f32 v203, v203
    v_cvt_pk_bf16_f32 v116, v200, v201
    v_cvt_pk_bf16_f32 v117, v202, v203
    v_mfma_f32_32x32x16_bf16 v[160:175], v[56:59], v[112:115], v[160:175]
    buffer_load_dwordx4 v[108:111], v2, s[4:7], s61 offen offset:3072 sc1
    v_exp_f32 v204, v204
    v_exp_f32 v205, v205
    v_exp_f32 v206, v206
    v_exp_f32 v207, v207
    v_cvt_pk_bf16_f32 v118, v204, v205
    v_cvt_pk_bf16_f32 v119, v206, v207
    s_waitcnt vmcnt(20)
    s_nop 0
    v_mfma_f32_32x32x16_bf16 v[192:207], v[64:67], v[16:19], 0
    v_exp_f32 v208, v208
    v_exp_f32 v209, v209
    v_exp_f32 v210, v210
    v_exp_f32 v211, v211
    v_cvt_pk_bf16_f32 v112, v208, v209
    v_cvt_pk_bf16_f32 v113, v210, v211
    v_mfma_f32_32x32x16_bf16 v[192:207], v[68:71], v[20:23], v[192:207]
    buffer_load_dwordx4 a[176:179], v2, s[4:7], s69 offen offset:2048 sc1
    v_exp_f32 v212, v212
    v_exp_f32 v213, v213
    v_exp_f32 v214, v214
    v_exp_f32 v215, v215
    v_cvt_pk_bf16_f32 v114, v212, v213
    v_cvt_pk_bf16_f32 v115, v214, v215
    v_mfma_f32_32x32x16_bf16 v[160:175], v[60:63], v[116:119], v[160:175]
    buffer_load_dwordx4 a[184:187], v2, s[4:7], s69 offen offset:3072 sc1
    s_add_u32 s69, s98, 20480
    v_exp_f32 v216, v216
    v_exp_f32 v217, v217
    v_exp_f32 v218, v218
    v_exp_f32 v219, v219
    v_cvt_pk_bf16_f32 v116, v216, v217
    v_cvt_pk_bf16_f32 v117, v218, v219
    v_mfma_f32_32x32x16_bf16 v[176:191], v[56:59], v[112:115], v[176:191]
    v_exp_f32 v220, v220
    v_exp_f32 v221, v221
    v_exp_f32 v222, v222
    v_exp_f32 v223, v223
    v_cvt_pk_bf16_f32 v118, v220, v221
    v_cvt_pk_bf16_f32 v119, v222, v223
    v_mfma_f32_32x32x16_bf16 v[208:223], v[64:67], v[24:27], 0
    v_exp_f32 v192, v192
    v_exp_f32 v193, v193
    v_exp_f32 v194, v194
    v_exp_f32 v195, v195
    v_cvt_pk_bf16_f32 v112, v192, v193
    v_cvt_pk_bf16_f32 v113, v194, v195
    v_mfma_f32_32x32x16_bf16 v[208:223], v[68:71], v[28:31], v[208:223]
    v_exp_f32 v196, v196
    v_exp_f32 v197, v197
    v_exp_f32 v198, v198
    v_exp_f32 v199, v199
    v_cvt_pk_bf16_f32 v114, v196, v197
    v_cvt_pk_bf16_f32 v115, v198, v199
    v_mfma_f32_32x32x16_bf16 v[176:191], v[60:63], v[116:119], v[176:191]
    buffer_load_dwordx4 a[164:167], v2, s[4:7], s69 offen offset:0 sc1
    v_exp_f32 v200, v200
    v_exp_f32 v201, v201
    v_exp_f32 v202, v202
    v_exp_f32 v203, v203
    v_cvt_pk_bf16_f32 v116, v200, v201
    v_cvt_pk_bf16_f32 v117, v202, v203
    v_mfma_f32_32x32x16_bf16 v[128:143], v[72:75], v[112:115], v[128:143]
    v_exp_f32 v204, v204
    v_exp_f32 v205, v205
    v_exp_f32 v206, v206
    v_exp_f32 v207, v207
    v_cvt_pk_bf16_f32 v118, v204, v205
    v_cvt_pk_bf16_f32 v119, v206, v207
    v_mfma_f32_32x32x16_bf16 v[192:207], v[64:67], v[32:35], 0
    buffer_load_dwordx4 a[172:175], v2, s[4:7], s69 offen offset:1024 sc1
    v_exp_f32 v208, v208
    v_exp_f32 v209, v209
    v_exp_f32 v210, v210
    v_exp_f32 v211, v211
    v_cvt_pk_bf16_f32 v112, v208, v209
    v_cvt_pk_bf16_f32 v113, v210, v211
    v_mfma_f32_32x32x16_bf16 v[192:207], v[68:71], v[36:39], v[192:207]
    v_exp_f32 v212, v212
    v_exp_f32 v213, v213
    v_exp_f32 v214, v214
    v_exp_f32 v215, v215
    v_cvt_pk_bf16_f32 v114, v212, v213
    v_cvt_pk_bf16_f32 v115, v214, v215
    v_mfma_f32_32x32x16_bf16 v[128:143], v[76:79], v[116:119], v[128:143]
    buffer_load_dwordx4 a[180:183], v2, s[4:7], s69 offen offset:2048 sc1
    v_exp_f32 v216, v216
    v_exp_f32 v217, v217
    v_exp_f32 v218, v218
    v_exp_f32 v219, v219
    v_cvt_pk_bf16_f32 v116, v216, v217
    v_cvt_pk_bf16_f32 v117, v218, v219
    v_mfma_f32_32x32x16_bf16 v[144:159], v[72:75], v[112:115], v[144:159]
    v_exp_f32 v220, v220
    v_exp_f32 v221, v221
    v_exp_f32 v222, v222
    v_exp_f32 v223, v223
    v_cvt_pk_bf16_f32 v118, v220, v221
    v_cvt_pk_bf16_f32 v119, v222, v223
    v_mfma_f32_32x32x16_bf16 v[208:223], v[64:67], v[40:43], 0
    buffer_load_dwordx4 a[188:191], v2, s[4:7], s69 offen offset:3072 sc1
    v_exp_f32 v192, v192
    v_exp_f32 v193, v193
    v_exp_f32 v194, v194
    v_exp_f32 v195, v195
    v_cvt_pk_bf16_f32 v112, v192, v193
    v_cvt_pk_bf16_f32 v113, v194, v195
    v_mfma_f32_32x32x16_bf16 v[208:223], v[68:71], v[44:47], v[208:223]
    v_exp_f32 v196, v196
    v_exp_f32 v197, v197
    v_exp_f32 v198, v198
    v_exp_f32 v199, v199
    v_cvt_pk_bf16_f32 v114, v196, v197
    v_cvt_pk_bf16_f32 v115, v198, v199
    v_mfma_f32_32x32x16_bf16 v[144:159], v[76:79], v[116:119], v[144:159]
    s_add_u32 s69, s64, 24576
    buffer_load_dwordx4 a[192:195], v2, s[4:7], s69 offen offset:0 sc1
    v_exp_f32 v200, v200
    v_exp_f32 v201, v201
    v_exp_f32 v202, v202
    v_exp_f32 v203, v203
    v_cvt_pk_bf16_f32 v116, v200, v201
    v_cvt_pk_bf16_f32 v117, v202, v203
    v_mfma_f32_32x32x16_bf16 v[160:175], v[72:75], v[112:115], v[160:175]
    v_exp_f32 v204, v204
    v_exp_f32 v205, v205
    v_exp_f32 v206, v206
    v_exp_f32 v207, v207
    v_cvt_pk_bf16_f32 v118, v204, v205
    v_cvt_pk_bf16_f32 v119, v206, v207
    s_waitcnt vmcnt(17)
    s_nop 0
    v_mfma_f32_32x32x16_bf16 v[192:207], v[80:83], v[16:19], 0
    buffer_load_dwordx4 a[200:203], v2, s[4:7], s69 offen offset:1024 sc1
    v_exp_f32 v208, v208
    v_exp_f32 v209, v209
    v_exp_f32 v210, v210
    v_exp_f32 v211, v211
    v_cvt_pk_bf16_f32 v112, v208, v209
    v_cvt_pk_bf16_f32 v113, v210, v211
    v_mfma_f32_32x32x16_bf16 v[192:207], v[84:87], v[20:23], v[192:207]
    v_exp_f32 v212, v212
    v_exp_f32 v213, v213
    v_exp_f32 v214, v214
    v_exp_f32 v215, v215
    v_cvt_pk_bf16_f32 v114, v212, v213
    v_cvt_pk_bf16_f32 v115, v214, v215
    v_mfma_f32_32x32x16_bf16 v[160:175], v[76:79], v[116:119], v[160:175]
    buffer_load_dwordx4 a[208:211], v2, s[4:7], s69 offen offset:2048 sc1
    v_exp_f32 v216, v216
    v_exp_f32 v217, v217
    v_exp_f32 v218, v218
    v_exp_f32 v219, v219
    v_cvt_pk_bf16_f32 v116, v216, v217
    v_cvt_pk_bf16_f32 v117, v218, v219
    v_mfma_f32_32x32x16_bf16 v[176:191], v[72:75], v[112:115], v[176:191]
    v_exp_f32 v220, v220
    v_exp_f32 v221, v221
    v_exp_f32 v222, v222
    v_exp_f32 v223, v223
    v_cvt_pk_bf16_f32 v118, v220, v221
    v_cvt_pk_bf16_f32 v119, v222, v223
    v_mfma_f32_32x32x16_bf16 v[208:223], v[80:83], v[24:27], 0
    v_exp_f32 v192, v192
    v_exp_f32 v193, v193
    v_exp_f32 v194, v194
    v_exp_f32 v195, v195
    v_cvt_pk_bf16_f32 v112, v192, v193
    v_cvt_pk_bf16_f32 v113, v194, v195
    v_mfma_f32_32x32x16_bf16 v[208:223], v[84:87], v[28:31], v[208:223]
    v_exp_f32 v196, v196
    v_exp_f32 v197, v197
    v_exp_f32 v198, v198
    v_exp_f32 v199, v199
    v_cvt_pk_bf16_f32 v114, v196, v197
    v_cvt_pk_bf16_f32 v115, v198, v199
    v_mfma_f32_32x32x16_bf16 v[176:191], v[76:79], v[116:119], v[176:191]
    buffer_load_dwordx4 a[216:219], v2, s[4:7], s69 offen offset:3072 sc1
    v_exp_f32 v200, v200
    v_exp_f32 v201, v201
    v_exp_f32 v202, v202
    v_exp_f32 v203, v203
    v_cvt_pk_bf16_f32 v116, v200, v201
    v_cvt_pk_bf16_f32 v117, v202, v203
    v_mfma_f32_32x32x16_bf16 v[128:143], v[88:91], v[112:115], v[128:143]
    v_exp_f32 v204, v204
    v_exp_f32 v205, v205
    v_exp_f32 v206, v206
    v_exp_f32 v207, v207
    v_cvt_pk_bf16_f32 v118, v204, v205
    v_cvt_pk_bf16_f32 v119, v206, v207
    v_mfma_f32_32x32x16_bf16 v[192:207], v[80:83], v[32:35], 0
    s_add_u32 s69, s98, 24576
    buffer_load_dwordx4 a[196:199], v2, s[4:7], s69 offen offset:0 sc1
    v_exp_f32 v208, v208
    v_exp_f32 v209, v209
    v_exp_f32 v210, v210
    v_exp_f32 v211, v211
    v_cvt_pk_bf16_f32 v112, v208, v209
    v_cvt_pk_bf16_f32 v113, v210, v211
    v_mfma_f32_32x32x16_bf16 v[192:207], v[84:87], v[36:39], v[192:207]
    v_exp_f32 v212, v212
    v_exp_f32 v213, v213
    v_exp_f32 v214, v214
    v_exp_f32 v215, v215
    v_cvt_pk_bf16_f32 v114, v212, v213
    v_cvt_pk_bf16_f32 v115, v214, v215
    v_mfma_f32_32x32x16_bf16 v[128:143], v[92:95], v[116:119], v[128:143]
    buffer_load_dwordx4 a[204:207], v2, s[4:7], s69 offen offset:1024 sc1
    v_exp_f32 v216, v216
    v_exp_f32 v217, v217
    v_exp_f32 v218, v218
    v_exp_f32 v219, v219
    v_cvt_pk_bf16_f32 v116, v216, v217
    v_cvt_pk_bf16_f32 v117, v218, v219
    v_mfma_f32_32x32x16_bf16 v[144:159], v[88:91], v[112:115], v[144:159]
    v_exp_f32 v220, v220
    v_exp_f32 v221, v221
    v_exp_f32 v222, v222
    v_exp_f32 v223, v223
    v_cvt_pk_bf16_f32 v118, v220, v221
    v_cvt_pk_bf16_f32 v119, v222, v223
    v_mfma_f32_32x32x16_bf16 v[208:223], v[80:83], v[40:43], 0
    v_exp_f32 v192, v192
    v_exp_f32 v193, v193
    v_exp_f32 v194, v194
    v_exp_f32 v195, v195
    v_cvt_pk_bf16_f32 v112, v192, v193
    v_cvt_pk_bf16_f32 v113, v194, v195
    v_mfma_f32_32x32x16_bf16 v[208:223], v[84:87], v[44:47], v[208:223]
    buffer_load_dwordx4 a[212:215], v2, s[4:7], s69 offen offset:2048 sc1
    v_exp_f32 v196, v196
    v_exp_f32 v197, v197
    v_exp_f32 v198, v198
    v_exp_f32 v199, v199
    v_cvt_pk_bf16_f32 v114, v196, v197
    v_cvt_pk_bf16_f32 v115, v198, v199
    v_mfma_f32_32x32x16_bf16 v[144:159], v[92:95], v[116:119], v[144:159]
    v_exp_f32 v200, v200
    v_exp_f32 v201, v201
    v_exp_f32 v202, v202
    v_exp_f32 v203, v203
    v_cvt_pk_bf16_f32 v116, v200, v201
    v_cvt_pk_bf16_f32 v117, v202, v203
    v_mfma_f32_32x32x16_bf16 v[160:175], v[88:91], v[112:115], v[160:175]
    buffer_load_dwordx4 a[220:223], v2, s[4:7], s69 offen offset:3072 sc1
    v_exp_f32 v204, v204
    v_exp_f32 v205, v205
    v_exp_f32 v206, v206
    v_exp_f32 v207, v207
    v_cvt_pk_bf16_f32 v118, v204, v205
    v_cvt_pk_bf16_f32 v119, v206, v207
    s_waitcnt vmcnt(14)
    s_nop 0
    v_mfma_f32_32x32x16_bf16 v[192:207], v[96:99], v[16:19], 0
    v_exp_f32 v208, v208
    v_exp_f32 v209, v209
    v_exp_f32 v210, v210
    v_exp_f32 v211, v211
    v_cvt_pk_bf16_f32 v112, v208, v209
    v_cvt_pk_bf16_f32 v113, v210, v211
    v_mfma_f32_32x32x16_bf16 v[192:207], v[100:103], v[20:23], v[192:207]
    buffer_load_dwordx4 v[240:243], v250, s[8:11], 0 offen offset:0
    v_exp_f32 v212, v212
    v_exp_f32 v213, v213
    v_exp_f32 v214, v214
    v_exp_f32 v215, v215
    v_cvt_pk_bf16_f32 v114, v212, v213
    v_cvt_pk_bf16_f32 v115, v214, v215
    v_mfma_f32_32x32x16_bf16 v[160:175], v[92:95], v[116:119], v[160:175]
    v_exp_f32 v216, v216
    v_exp_f32 v217, v217
    v_exp_f32 v218, v218
    v_exp_f32 v219, v219
    v_cvt_pk_bf16_f32 v116, v216, v217
    v_cvt_pk_bf16_f32 v117, v218, v219
    v_mfma_f32_32x32x16_bf16 v[176:191], v[88:91], v[112:115], v[176:191]
    v_exp_f32 v220, v220
    v_exp_f32 v221, v221
    v_exp_f32 v222, v222
    v_exp_f32 v223, v223
    v_cvt_pk_bf16_f32 v118, v220, v221
    v_cvt_pk_bf16_f32 v119, v222, v223
    v_mfma_f32_32x32x16_bf16 v[208:223], v[96:99], v[24:27], 0
    v_exp_f32 v192, v192
    v_exp_f32 v193, v193
    v_exp_f32 v194, v194
    v_exp_f32 v195, v195
    v_cvt_pk_bf16_f32 v112, v192, v193
    v_cvt_pk_bf16_f32 v113, v194, v195
    v_mfma_f32_32x32x16_bf16 v[208:223], v[100:103], v[28:31], v[208:223]
    v_exp_f32 v196, v196
    v_exp_f32 v197, v197
    v_exp_f32 v198, v198
    v_exp_f32 v199, v199
    v_cvt_pk_bf16_f32 v114, v196, v197
    v_cvt_pk_bf16_f32 v115, v198, v199
    v_mfma_f32_32x32x16_bf16 v[176:191], v[92:95], v[116:119], v[176:191]
    buffer_load_dwordx4 v[244:247], v250, s[8:11], 0 offen offset:32
    v_exp_f32 v200, v200
    v_exp_f32 v201, v201
    v_exp_f32 v202, v202
    v_exp_f32 v203, v203
    v_cvt_pk_bf16_f32 v116, v200, v201
    v_cvt_pk_bf16_f32 v117, v202, v203
    v_mfma_f32_32x32x16_bf16 v[128:143], v[104:107], v[112:115], v[128:143]
    v_exp_f32 v204, v204
    v_exp_f32 v205, v205
    v_exp_f32 v206, v206
    v_exp_f32 v207, v207
    v_cvt_pk_bf16_f32 v118, v204, v205
    v_cvt_pk_bf16_f32 v119, v206, v207
    v_mfma_f32_32x32x16_bf16 v[192:207], v[96:99], v[32:35], 0
    v_exp_f32 v208, v208
    v_exp_f32 v209, v209
    v_exp_f32 v210, v210
    v_exp_f32 v211, v211
    v_cvt_pk_bf16_f32 v112, v208, v209
    v_cvt_pk_bf16_f32 v113, v210, v211
    v_mfma_f32_32x32x16_bf16 v[192:207], v[100:103], v[36:39], v[192:207]
    v_exp_f32 v212, v212
    v_exp_f32 v213, v213
    v_exp_f32 v214, v214
    v_exp_f32 v215, v215
    v_cvt_pk_bf16_f32 v114, v212, v213
    v_cvt_pk_bf16_f32 v115, v214, v215
    v_mfma_f32_32x32x16_bf16 v[128:143], v[108:111], v[116:119], v[128:143]
    s_add_u32 s49, s44, 1
    s_and_b32 s49, s49, 3
    s_mul_i32 s49, s49, 12288
    s_add_u32 s49, s49, 114688
    v_add_u32_e64 v224, s49, v2
    s_add_u32 s49, s44, 2
    s_and_b32 s49, s49, 3
    s_mul_i32 s49, s49, 12288
    s_add_u32 s49, s49, 118784
    v_add_u32_e64 v225, s49, v2
    s_add_u32 s49, s44, 3
    s_and_b32 s49, s49, 3
    s_mul_i32 s49, s49, 12288
    s_add_u32 s49, s49, 122880
    v_add_u32_e64 v226, s49, v2
    s_mul_i32 s49, s44, 12288
    s_add_u32 s49, s49, 114688
    v_add_u32 v227, s49, v2
    v_exp_f32 v216, v216
    v_exp_f32 v217, v217
    v_exp_f32 v218, v218
    v_exp_f32_e64 v219, v219
    v_cvt_pk_bf16_f32 v116, v216, v217
    v_cvt_pk_bf16_f32 v117, v218, v219
    v_mfma_f32_32x32x16_bf16 v[144:159], v[104:107], v[112:115], v[144:159]
    v_exp_f32 v220, v220
    v_exp_f32 v221, v221
    v_exp_f32 v222, v222
    v_exp_f32 v223, v223
    v_cvt_pk_bf16_f32 v118, v220, v221
    v_cvt_pk_bf16_f32 v119, v222, v223
    v_mfma_f32_32x32x16_bf16 v[208:223], v[96:99], v[40:43], 0
    v_exp_f32 v192, v192
    v_exp_f32 v193, v193
    v_exp_f32 v194, v194
    v_exp_f32 v195, v195
    v_cvt_pk_bf16_f32 v112, v192, v193
    v_cvt_pk_bf16_f32 v113, v194, v195
    v_mfma_f32_32x32x16_bf16 v[208:223], v[100:103], v[44:47], v[208:223]
    v_exp_f32 v196, v196
    v_exp_f32 v197, v197
    v_exp_f32 v198, v198
    v_exp_f32 v199, v199
    v_cvt_pk_bf16_f32 v114, v196, v197
    v_cvt_pk_bf16_f32 v115, v198, v199
    v_mfma_f32_32x32x16_bf16 v[144:159], v[108:111], v[116:119], v[144:159]
    v_exp_f32 v200, v200
    v_exp_f32 v201, v201
    v_exp_f32 v202, v202
    v_exp_f32 v203, v203
    v_cvt_pk_bf16_f32 v116, v200, v201
    v_cvt_pk_bf16_f32 v117, v202, v203
    v_mfma_f32_32x32x16_bf16 v[160:175], v[104:107], v[112:115], v[160:175]
    ds_write_b128 v224, v[128:131] offset:0
    ds_write_b128 v224, v[132:135] offset:1024
    ds_write_b128 v224, v[136:139] offset:2048
    ds_write_b128 v224, v[140:143] offset:3072
    v_exp_f32 v204, v204
    v_exp_f32 v205, v205
    v_exp_f32 v206, v206
    v_exp_f32 v207, v207
    v_cvt_pk_bf16_f32 v118, v204, v205
    v_cvt_pk_bf16_f32 v119, v206, v207
    v_exp_f32 v208, v208
    v_exp_f32 v209, v209
    v_exp_f32 v210, v210
    v_exp_f32 v211, v211
    v_cvt_pk_bf16_f32 v112, v208, v209
    v_cvt_pk_bf16_f32 v113, v210, v211
    v_exp_f32 v212, v212
    v_exp_f32 v213, v213
    v_exp_f32 v214, v214
    v_exp_f32 v215, v215
    v_cvt_pk_bf16_f32 v114, v212, v213
    v_cvt_pk_bf16_f32 v115, v214, v215
    v_mfma_f32_32x32x16_bf16 v[160:175], v[108:111], v[116:119], v[160:175]
    v_exp_f32 v216, v216
    v_exp_f32 v217, v217
    v_exp_f32 v218, v218
    v_exp_f32 v219, v219
    v_cvt_pk_bf16_f32 v116, v216, v217
    v_cvt_pk_bf16_f32 v117, v218, v219
    v_mfma_f32_32x32x16_bf16 v[176:191], v[104:107], v[112:115], v[176:191]
    ds_write_b128 v225, v[144:147] offset:0
    ds_write_b128 v225, v[148:151] offset:1024
    ds_write_b128 v225, v[152:155] offset:2048
    ds_write_b128 v225, v[156:159] offset:3072
    v_exp_f32 v220, v220
    v_exp_f32 v221, v221
    v_exp_f32 v222, v222
    v_exp_f32 v223, v223
    v_cvt_pk_bf16_f32 v118, v220, v221
    v_cvt_pk_bf16_f32 v119, v222, v223
    s_nop 1
    s_nop 0
    v_mfma_f32_32x32x16_bf16 v[176:191], v[108:111], v[116:119], v[176:191]
    s_nop 3
    s_nop 0
    ds_write_b128 v226, v[160:163] offset:0
    ds_write_b128 v226, v[164:167] offset:1024
    ds_write_b128 v226, v[168:171] offset:2048
    ds_write_b128 v226, v[172:175] offset:3072
    s_lshl_b32 s53, s58, 2
    s_add_u32 s53, s53, s44
    s_lshl_b32 s53, s53, 4
    s_add_u32 s53, s53, s57
    s_lshl_b32 s53, s53, 11
    s_nop 0
    s_add_u32 s53, s53, 6291456
    s_waitcnt lgkmcnt(0)
    s_barrier
    ds_read_b128 v[192:195], v227 offset:0
    ds_read_b128 v[196:199], v227 offset:1024
    ds_read_b128 v[200:203], v227 offset:2048
    ds_read_b128 v[204:207], v227 offset:3072
    ds_read_b128 v[208:211], v227 offset:4096
    ds_read_b128 v[212:215], v227 offset:5120
    ds_read_b128 v[216:219], v227 offset:6144
    ds_read_b128 v[220:223], v227 offset:7168
    ds_read_b128 v[48:51], v227 offset:8192
    ds_read_b128 v[52:55], v227 offset:9216
    ds_read_b128 v[56:59], v227 offset:10240
    ds_read_b128 v[60:63], v227 offset:11264
    s_waitcnt lgkmcnt(8)
    s_nop 0
    v_pk_add_f32 v[176:177], v[176:177], v[192:193]
    v_pk_add_f32 v[178:179], v[178:179], v[194:195]
    v_pk_add_f32 v[180:181], v[180:181], v[196:197]
    v_pk_add_f32 v[182:183], v[182:183], v[198:199]
    v_pk_add_f32 v[184:185], v[184:185], v[200:201]
    v_pk_add_f32 v[186:187], v[186:187], v[202:203]
    v_pk_add_f32 v[188:189], v[188:189], v[204:205]
    v_pk_add_f32 v[190:191], v[190:191], v[206:207]
    s_waitcnt lgkmcnt(4)
    s_nop 0
    v_pk_add_f32 v[176:177], v[176:177], v[208:209]
    v_pk_add_f32 v[178:179], v[178:179], v[210:211]
    v_pk_add_f32 v[180:181], v[180:181], v[212:213]
    v_pk_add_f32 v[182:183], v[182:183], v[214:215]
    v_pk_add_f32 v[184:185], v[184:185], v[216:217]
    v_pk_add_f32 v[186:187], v[186:187], v[218:219]
    v_pk_add_f32 v[188:189], v[188:189], v[220:221]
    v_pk_add_f32 v[190:191], v[190:191], v[222:223]
    s_waitcnt lgkmcnt(0)
    s_nop 0
    v_pk_add_f32 v[176:177], v[176:177], v[48:49]
    v_pk_add_f32 v[178:179], v[178:179], v[50:51]
    v_pk_add_f32 v[180:181], v[180:181], v[52:53]
    v_pk_add_f32 v[182:183], v[182:183], v[54:55]
    v_pk_add_f32 v[184:185], v[184:185], v[56:57]
    v_pk_add_f32 v[186:187], v[186:187], v[58:59]
    v_pk_add_f32 v[188:189], v[188:189], v[60:61]
    v_pk_add_f32 v[190:191], v[190:191], v[62:63]
    v_mov_b32 v224, v188
    v_mov_b32 v225, v188
    v_mov_b32_e64 v228, 0
    v_mov_b32 v229, 0
    v_permlane32_swap_b32 v224, v225
    v_pk_mul_f32 v[226:227], v[176:177], v[228:229]
    v_pk_fma_f32 v[226:227], v[178:179], v[228:229], v[226:227]
    v_pk_fma_f32 v[226:227], v[180:181], v[228:229], v[226:227]
    v_pk_fma_f32 v[226:227], v[182:183], v[228:229], v[226:227]
    v_pk_fma_f32 v[226:227], v[184:185], v[228:229], v[226:227]
    v_pk_fma_f32 v[226:227], v[186:187], v[228:229], v[226:227]
    v_pk_fma_f32 v[226:227], v[188:189], v[228:229], v[226:227]
    v_pk_fma_f32 v[226:227], v[190:191], v[228:229], v[226:227]
    v_add_f32_e64 v226, v226, v227
    v_rcp_f32 v224, v225
    v_cmp_eq_f32 vcc, 0, v226
    s_mov_b32 s49, 0xe800000
    v_cmp_le_f32 s[74:75], s49, v225
    s_mov_b32 s49, 0x76800000
    v_cmp_ge_f32 s[76:77], s49, v225
    s_and_b64 vcc, vcc, s[74:75]
    s_and_b64 vcc, vcc, s[76:77]
    s_cmp_eq_u64 vcc, exec
    s_cbranch_scc0 L_attn_slow
L_attn_fin:
    v_pk_mul_f32 v[176:177], v[176:177], v[224:225] op_sel_hi:[1,0]
    v_pk_mul_f32 v[178:179], v[178:179], v[224:225] op_sel_hi:[1,0]
    v_pk_mul_f32 v[180:181], v[180:181], v[224:225] op_sel_hi:[1,0]
    v_pk_mul_f32 v[182:183], v[182:183], v[224:225] op_sel_hi:[1,0]
    v_pk_mul_f32 v[184:185], v[184:185], v[224:225] op_sel_hi:[1,0]
    v_pk_mul_f32 v[186:187], v[186:187], v[224:225] op_sel_hi:[1,0]
    v_pk_mul_f32 v[188:189], v[188:189], v[224:225] op_sel_hi:[1,0]
    v_pk_mul_f32 v[190:191], v[190:191], v[224:225] op_sel_hi:[1,0]
    v_cvt_pk_bf16_f32 v192, v176, v177
    v_cvt_pk_bf16_f32 v193, v178, v179
    v_cvt_pk_bf16_f32 v194, v180, v181
    v_cvt_pk_bf16_f32 v195, v182, v183
    v_cvt_pk_bf16_f32 v196, v184, v185
    v_cvt_pk_bf16_f32 v197, v186, v187
    v_cvt_pk_bf16_f32 v198, v188, v189
    v_cvt_pk_bf16_f32 v199, v190, v191
    s_mov_b32 exec_lo, 0
    v_mov_b32 v198, 0
    v_mov_b32 v199, 0
    s_mov_b32 exec_lo, -1
    buffer_store_dwordx4 v[192:195], v2, s[4:7], s53 offen sc1
    buffer_store_dwordx4 v[196:199], v2, s[4:7], s53 offen offset:1024 sc1
    s_lshr_b32 s49, s2, 3
    s_cmp_ge_u32 s49, 28
    s_cbranch_scc1 L_tail_publish
    s_waitcnt vmcnt(4)
    ds_read_b64_tr_b16 v[80:81], v248 offset:0
    ds_read_b64_tr_b16 v[82:83], v248 offset:1024
    ds_read_b64_tr_b16 v[84:85], v253 offset:0
    ds_read_b64_tr_b16 v[86:87], v253 offset:1024
    ds_read_b64_tr_b16 v[88:89], v248 offset:2048
    ds_read_b64_tr_b16 v[90:91], v248 offset:3072
    ds_read_b64_tr_b16 v[92:93], v253 offset:2048
    ds_read_b64_tr_b16 v[94:95], v253 offset:3072
    s_waitcnt lgkmcnt(6)
    s_nop 0
    v_mfma_f32_32x32x16_bf16 v[16:31], v[80:83], a[0:3], 0
    ds_read_b64_tr_b16 v[96:97], v248 offset:4096
    ds_read_b64_tr_b16 v[98:99], v248 offset:5120
    v_mfma_f32_32x32x16_bf16 v[32:47], v[80:83], a[4:7], 0
    s_waitcnt lgkmcnt(6)
    s_nop 0
    v_mfma_f32_32x32x16_bf16 v[48:63], v[84:87], a[0:3], 0
    ds_read_b64_tr_b16 v[100:101], v253 offset:4096
    ds_read_b64_tr_b16 v[102:103], v253 offset:5120
    v_mfma_f32_32x32x16_bf16 v[64:79], v[84:87], a[4:7], 0
    s_add_u32 m0, s67, 0
    s_nop 0
    s_add_u32 s69, s66, 200704
    buffer_load_dwordx4 v249, s[24:27], s69 offen lds
    s_add_u32 m0, s67, 1024
    s_add_u32 s69, s66, 207872
    buffer_load_dwordx4 v249, s[24:27], s69 offen lds
    s_waitcnt lgkmcnt(6)
    s_nop 0
    v_mfma_f32_32x32x16_bf16 v[16:31], v[88:91], a[8:11], v[16:31]
    ds_read_b64_tr_b16 v[80:81], v248 offset:6144
    ds_read_b64_tr_b16 v[82:83], v248 offset:7168
    v_mfma_f32_32x32x16_bf16 v[32:47], v[88:91], a[12:15], v[32:47]
    s_waitcnt lgkmcnt(6)
    s_nop 0
    v_mfma_f32_32x32x16_bf16 v[48:63], v[92:95], a[8:11], v[48:63]
    ds_read_b64_tr_b16 v[84:85], v253 offset:6144
    ds_read_b64_tr_b16 v[86:87], v253 offset:7168
    v_mfma_f32_32x32x16_bf16 v[64:79], v[92:95], a[12:15], v[64:79]
    s_add_u32 m0, s67, 2048
    s_add_u32 s69, s66, 215040
    buffer_load_dwordx4 v249, s[24:27], s69 offen lds
    s_add_u32 m0, s67, 3072
    s_add_u32 s69, s66, 222208
    buffer_load_dwordx4 v249, s[24:27], s69 offen lds
    s_waitcnt lgkmcnt(6)
    s_nop 0
    v_mfma_f32_32x32x16_bf16 v[16:31], v[96:99], a[16:19], v[16:31]
    ds_read_b64_tr_b16 v[88:89], v248 offset:8192
    ds_read_b64_tr_b16 v[90:91], v248 offset:9216
    v_mfma_f32_32x32x16_bf16 v[32:47], v[96:99], a[20:23], v[32:47]
    s_waitcnt lgkmcnt(6)
    s_nop 0
    v_mfma_f32_32x32x16_bf16 v[48:63], v[100:103], a[16:19], v[48:63]
    ds_read_b64_tr_b16 v[92:93], v253 offset:8192
    ds_read_b64_tr_b16 v[94:95], v253 offset:9216
    v_mfma_f32_32x32x16_bf16 v[64:79], v[100:103], a[20:23], v[64:79]
    s_add_u32 m0, s67, 4096
    s_add_u32 s69, s66, 229376
    buffer_load_dwordx4 v249, s[24:27], s69 offen lds
    s_add_u32 m0, s67, 5120
    s_add_u32 s69, s66, 236544
    buffer_load_dwordx4 v249, s[24:27], s69 offen lds
    s_waitcnt lgkmcnt(6)
    s_nop 0
    v_mfma_f32_32x32x16_bf16 v[16:31], v[80:83], a[24:27], v[16:31]
    ds_read_b64_tr_b16 v[96:97], v248 offset:10240
    ds_read_b64_tr_b16 v[98:99], v248 offset:11264
    v_mfma_f32_32x32x16_bf16 v[32:47], v[80:83], a[28:31], v[32:47]
    s_waitcnt lgkmcnt(6)
    s_nop 0
    v_mfma_f32_32x32x16_bf16 v[48:63], v[84:87], a[24:27], v[48:63]
    ds_read_b64_tr_b16 v[100:101], v253 offset:10240
    ds_read_b64_tr_b16 v[102:103], v253 offset:11264
    v_mfma_f32_32x32x16_bf16 v[64:79], v[84:87], a[28:31], v[64:79]
    s_add_u32 m0, s67, 6144
    s_add_u32 s69, s66, 243712
    buffer_load_dwordx4 v249, s[24:27], s69 offen lds
    s_add_u32 m0, s67, 7168
    s_add_u32 s69, s66, 250880
    buffer_load_dwordx4 v249, s[24:27], s69 offen lds
    s_waitcnt lgkmcnt(6)
    s_nop 0
    v_mfma_f32_32x32x16_bf16 v[16:31], v[88:91], a[32:35], v[16:31]
    ds_read_b64_tr_b16 v[80:81], v248 offset:12288
    ds_read_b64_tr_b16 v[82:83], v248 offset:13312
    v_mfma_f32_32x32x16_bf16 v[32:47], v[88:91], a[36:39], v[32:47]
    s_waitcnt lgkmcnt(6)
    s_nop 0
    v_mfma_f32_32x32x16_bf16 v[48:63], v[92:95], a[32:35], v[48:63]
    ds_read_b64_tr_b16 v[84:85], v253 offset:12288
    ds_read_b64_tr_b16 v[86:87], v253 offset:13312
    v_mfma_f32_32x32x16_bf16 v[64:79], v[92:95], a[36:39], v[64:79]
    s_add_u32 m0, s67, 8192
    s_add_u32 s69, s66, 258048
    buffer_load_dwordx4 v249, s[24:27], s69 offen lds
    s_add_u32 m0, s67, 9216
    s_add_u32 s69, s66, 265216
    buffer_load_dwordx4 v249, s[24:27], s69 offen lds
    s_waitcnt lgkmcnt(6)
    s_nop 0
    v_mfma_f32_32x32x16_bf16 v[16:31], v[96:99], a[40:43], v[16:31]
    ds_read_b64_tr_b16 v[88:89], v248 offset:14336
    ds_read_b64_tr_b16 v[90:91], v248 offset:15360
    v_mfma_f32_32x32x16_bf16 v[32:47], v[96:99], a[44:47], v[32:47]
    s_waitcnt lgkmcnt(6)
    s_nop 0
    v_mfma_f32_32x32x16_bf16 v[48:63], v[100:103], a[40:43], v[48:63]
    ds_read_b64_tr_b16 v[92:93], v253 offset:14336
    ds_read_b64_tr_b16 v[94:95], v253 offset:15360
    v_mfma_f32_32x32x16_bf16 v[64:79], v[100:103], a[44:47], v[64:79]
    s_add_u32 m0, s67, 10240
    s_add_u32 s69, s66, 272384
    buffer_load_dwordx4 v249, s[24:27], s69 offen lds
    s_add_u32 m0, s67, 11264
    s_add_u32 s69, s66, 279552
    buffer_load_dwordx4 v249, s[24:27], s69 offen lds
    s_waitcnt vmcnt(12)
    s_barrier
    s_cmp_lg_u32 s44, 0
    s_cbranch_scc1 L_po_49
    s_lshl_b32 s49, s58, 7
    s_nop 0
    s_add_u32 s49, s49, 16781312
    v_mov_b32 v14, 1
    s_mov_b64 exec, 1
    buffer_atomic_add v14, v252, s[4:7], s49 offen sc1
    s_mov_b64 exec, -1
L_po_49:
    s_waitcnt lgkmcnt(6)
    v_mfma_f32_32x32x16_bf16 v[16:31], v[80:83], a[48:51], v[16:31]
    ds_read_b64_tr_b16 v[96:97], v248 offset:16384
    ds_read_b64_tr_b16 v[98:99], v248 offset:17408
    v_mfma_f32_32x32x16_bf16 v[32:47], v[80:83], a[52:55], v[32:47]
    s_waitcnt lgkmcnt(6)
    s_nop 0
    v_mfma_f32_32x32x16_bf16 v[48:63], v[84:87], a[48:51], v[48:63]
    ds_read_b64_tr_b16 v[100:101], v253 offset:16384
    ds_read_b64_tr_b16 v[102:103], v253 offset:17408
    v_mfma_f32_32x32x16_bf16 v[64:79], v[84:87], a[52:55], v[64:79]
    s_add_u32 m0, s67, 12288
    s_add_u32 s69, s66, 286720
    buffer_load_dwordx4 v249, s[24:27], s69 offen lds
    s_add_u32 m0, s67, 13312
    s_add_u32 s69, s66, 293888
    buffer_load_dwordx4 v249, s[24:27], s69 offen lds
    s_waitcnt lgkmcnt(6)
    s_nop 0
    v_mfma_f32_32x32x16_bf16 v[16:31], v[88:91], a[56:59], v[16:31]
    ds_read_b64_tr_b16 v[80:81], v248 offset:18432
    ds_read_b64_tr_b16 v[82:83], v248 offset:19456
    v_mfma_f32_32x32x16_bf16 v[32:47], v[88:91], a[60:63], v[32:47]
    s_waitcnt lgkmcnt(6)
    s_nop 0
    v_mfma_f32_32x32x16_bf16 v[48:63], v[92:95], a[56:59], v[48:63]
    ds_read_b64_tr_b16 v[84:85], v253 offset:18432
    ds_read_b64_tr_b16 v[86:87], v253 offset:19456
    v_mfma_f32_32x32x16_bf16 v[64:79], v[92:95], a[60:63], v[64:79]
    s_add_u32 m0, s67, 14336
    s_add_u32 s69, s66, 301056
    buffer_load_dwordx4 v249, s[24:27], s69 offen lds
    s_add_u32 m0, s67, 15360
    s_add_u32 s69, s66, 308224
    buffer_load_dwordx4 v249, s[24:27], s69 offen lds
    s_waitcnt lgkmcnt(6)
    s_nop 0
    v_mfma_f32_32x32x16_bf16 v[16:31], v[96:99], a[64:67], v[16:31]
    ds_read_b64_tr_b16 v[88:89], v248 offset:20480
    ds_read_b64_tr_b16 v[90:91], v248 offset:21504
    v_mfma_f32_32x32x16_bf16 v[32:47], v[96:99], a[68:71], v[32:47]
    s_waitcnt lgkmcnt(6)
    s_nop 0
    v_mfma_f32_32x32x16_bf16 v[48:63], v[100:103], a[64:67], v[48:63]
    ds_read_b64_tr_b16 v[92:93], v253 offset:20480
    ds_read_b64_tr_b16 v[94:95], v253 offset:21504
    v_mfma_f32_32x32x16_bf16 v[64:79], v[100:103], a[68:71], v[64:79]
    s_add_u32 m0, s67, 16384
    s_add_u32 s69, s66, 315392
    buffer_load_dwordx4 v249, s[24:27], s69 offen lds
    s_add_u32 m0, s67, 17408
    s_add_u32 s69, s66, 322560
    buffer_load_dwordx4 v249, s[24:27], s69 offen lds
    s_waitcnt lgkmcnt(6)
    s_nop 0
    v_mfma_f32_32x32x16_bf16 v[16:31], v[80:83], a[72:75], v[16:31]
    ds_read_b64_tr_b16 v[96:97], v248 offset:22528
    ds_read_b64_tr_b16 v[98:99], v248 offset:23552
    v_mfma_f32_32x32x16_bf16 v[32:47], v[80:83], a[76:79], v[32:47]
    s_waitcnt lgkmcnt(6)
    s_nop 0
    v_mfma_f32_32x32x16_bf16 v[48:63], v[84:87], a[72:75], v[48:63]
    ds_read_b64_tr_b16 v[100:101], v253 offset:22528
    ds_read_b64_tr_b16 v[102:103], v253 offset:23552
    v_mfma_f32_32x32x16_bf16 v[64:79], v[84:87], a[76:79], v[64:79]
    s_add_u32 m0, s67, 18432
    s_add_u32 s69, s66, 329728
    buffer_load_dwordx4 v249, s[24:27], s69 offen lds
    s_add_u32 m0, s67, 19456
    s_add_u32 s69, s66, 336896
    buffer_load_dwordx4 v249, s[24:27], s69 offen lds
    s_waitcnt lgkmcnt(6)
    s_nop 0
    v_mfma_f32_32x32x16_bf16 v[16:31], v[88:91], a[80:83], v[16:31]
    ds_read_b64_tr_b16 v[80:81], v248 offset:24576
    ds_read_b64_tr_b16 v[82:83], v248 offset:25600
    v_mfma_f32_32x32x16_bf16 v[32:47], v[88:91], a[84:87], v[32:47]
    s_waitcnt lgkmcnt(6)
    s_nop 0
    v_mfma_f32_32x32x16_bf16 v[48:63], v[92:95], a[80:83], v[48:63]
    ds_read_b64_tr_b16 v[84:85], v253 offset:24576
    ds_read_b64_tr_b16 v[86:87], v253 offset:25600
    v_mfma_f32_32x32x16_bf16 v[64:79], v[92:95], a[84:87], v[64:79]
    s_add_u32 m0, s67, 20480
    s_add_u32 s69, s66, 344064
    buffer_load_dwordx4 v249, s[24:27], s69 offen lds
    s_add_u32 m0, s67, 21504
    s_add_u32 s69, s66, 351232
    buffer_load_dwordx4 v249, s[24:27], s69 offen lds
    s_waitcnt lgkmcnt(6)
    s_nop 0
    v_mfma_f32_32x32x16_bf16 v[16:31], v[96:99], a[88:91], v[16:31]
    ds_read_b64_tr_b16 v[88:89], v248 offset:26624
    ds_read_b64_tr_b16 v[90:91], v248 offset:27648
    v_mfma_f32_32x32x16_bf16 v[32:47], v[96:99], a[92:95], v[32:47]
    s_waitcnt lgkmcnt(6)
    s_nop 0
    v_mfma_f32_32x32x16_bf16 v[48:63], v[100:103], a[88:91], v[48:63]
    ds_read_b64_tr_b16 v[92:93], v253 offset:26624
    ds_read_b64_tr_b16 v[94:95], v253 offset:27648
    v_mfma_f32_32x32x16_bf16 v[64:79], v[100:103], a[92:95], v[64:79]
    s_add_u32 m0, s67, 22528
    s_add_u32 s69, s66, 358400
    buffer_load_dwordx4 v249, s[24:27], s69 offen lds
    s_add_u32 m0, s67, 23552
    s_add_u32 s69, s66, 365568
    buffer_load_dwordx4 v249, s[24:27], s69 offen lds
    s_waitcnt vmcnt(22)
    s_waitcnt lgkmcnt(6)
    v_mfma_f32_32x32x16_bf16 v[16:31], v[80:83], a[96:99], v[16:31]
    ds_read_b64_tr_b16 v[96:97], v248 offset:0
    ds_read_b64_tr_b16 v[98:99], v248 offset:1024
    v_mfma_f32_32x32x16_bf16 v[32:47], v[80:83], a[100:103], v[32:47]
    s_waitcnt lgkmcnt(6)
    s_nop 0
    v_mfma_f32_32x32x16_bf16 v[48:63], v[84:87], a[96:99], v[48:63]
    ds_read_b64_tr_b16 v[100:101], v253 offset:0
    ds_read_b64_tr_b16 v[102:103], v253 offset:1024
    v_mfma_f32_32x32x16_bf16 v[64:79], v[84:87], a[100:103], v[64:79]
    s_add_u32 m0, s67, 24576
    s_add_u32 s69, s66, 372736
    buffer_load_dwordx4 v249, s[24:27], s69 offen lds
    s_add_u32 m0, s67, 25600
    s_add_u32 s69, s66, 379904
    buffer_load_dwordx4 v249, s[24:27], s69 offen lds
    s_waitcnt vmcnt(22)
    s_waitcnt lgkmcnt(6)
    v_mfma_f32_32x32x16_bf16 v[16:31], v[88:91], a[104:107], v[16:31]
    ds_read_b64_tr_b16 v[80:81], v248 offset:2048
    ds_read_b64_tr_b16 v[82:83], v248 offset:3072
    v_mfma_f32_32x32x16_bf16 v[32:47], v[88:91], a[108:111], v[32:47]
    s_waitcnt lgkmcnt(6)
    s_nop 0
    v_mfma_f32_32x32x16_bf16 v[48:63], v[92:95], a[104:107], v[48:63]
    ds_read_b64_tr_b16 v[84:85], v253 offset:2048
    ds_read_b64_tr_b16 v[86:87], v253 offset:3072
    v_mfma_f32_32x32x16_bf16 v[64:79], v[92:95], a[108:111], v[64:79]
    s_add_u32 m0, s67, 26624
    s_add_u32 s69, s66, 387072
    buffer_load_dwordx4 v249, s[24:27], s69 offen lds
    s_add_u32 m0, s67, 27648
    s_add_u32 s69, s66, 394240
    buffer_load_dwordx4 v249, s[24:27], s69 offen lds
    s_waitcnt vmcnt(22)
    s_waitcnt lgkmcnt(6)
    v_mfma_f32_32x32x16_bf16 v[16:31], v[96:99], a[112:115], v[16:31]
    ds_read_b64_tr_b16 v[88:89], v248 offset:4096
    ds_read_b64_tr_b16 v[90:91], v248 offset:5120
    v_mfma_f32_32x32x16_bf16 v[32:47], v[96:99], a[116:119], v[32:47]
    s_waitcnt lgkmcnt(6)
    s_nop 0
    v_mfma_f32_32x32x16_bf16 v[48:63], v[100:103], a[112:115], v[48:63]
    ds_read_b64_tr_b16 v[92:93], v253 offset:4096
    ds_read_b64_tr_b16 v[94:95], v253 offset:5120
    v_mfma_f32_32x32x16_bf16 v[64:79], v[100:103], a[116:119], v[64:79]
    s_add_u32 m0, s67, 0
    s_add_u32 s69, s68, 0
    buffer_load_dwordx4 v249, s[28:31], s69 offen lds
    s_add_u32 m0, s67, 1024
    s_add_u32 s69, s68, 7168
    buffer_load_dwordx4 v249, s[28:31], s69 offen lds
    s_waitcnt vmcnt(22)
    s_waitcnt lgkmcnt(6)
    v_mfma_f32_32x32x16_bf16 v[16:31], v[80:83], a[120:123], v[16:31]
    ds_read_b64_tr_b16 v[96:97], v248 offset:6144
    ds_read_b64_tr_b16 v[98:99], v248 offset:7168
    v_mfma_f32_32x32x16_bf16 v[32:47], v[80:83], a[124:127], v[32:47]
    s_waitcnt lgkmcnt(6)
    s_nop 0
    v_mfma_f32_32x32x16_bf16 v[48:63], v[84:87], a[120:123], v[48:63]
    ds_read_b64_tr_b16 v[100:101], v253 offset:6144
    ds_read_b64_tr_b16 v[102:103], v253 offset:7168
    v_mfma_f32_32x32x16_bf16 v[64:79], v[84:87], a[124:127], v[64:79]
    s_add_u32 m0, s67, 2048
    s_add_u32 s69, s68, 14336
    buffer_load_dwordx4 v249, s[28:31], s69 offen lds
    s_add_u32 m0, s67, 3072
    s_add_u32 s69, s68, 21504
    buffer_load_dwordx4 v249, s[28:31], s69 offen lds
    s_waitcnt vmcnt(22)
    s_waitcnt lgkmcnt(6)
    v_mfma_f32_32x32x16_bf16 v[16:31], v[88:91], a[128:131], v[16:31]
    ds_read_b64_tr_b16 v[80:81], v248 offset:8192
    ds_read_b64_tr_b16 v[82:83], v248 offset:9216
    v_mfma_f32_32x32x16_bf16 v[32:47], v[88:91], a[132:135], v[32:47]
    s_waitcnt lgkmcnt(6)
    s_nop 0
    v_mfma_f32_32x32x16_bf16 v[48:63], v[92:95], a[128:131], v[48:63]
    ds_read_b64_tr_b16 v[84:85], v253 offset:8192
    ds_read_b64_tr_b16 v[86:87], v253 offset:9216
    v_mfma_f32_32x32x16_bf16 v[64:79], v[92:95], a[132:135], v[64:79]
    s_add_u32 m0, s67, 4096
    s_add_u32 s69, s68, 25088
    buffer_load_dwordx4 v249, s[28:31], s69 offen lds
    s_add_u32 m0, s67, 5120
    s_add_u32 s69, s68, 32256
    buffer_load_dwordx4 v249, s[28:31], s69 offen lds
    s_waitcnt vmcnt(22)
    s_waitcnt lgkmcnt(6)
    v_mfma_f32_32x32x16_bf16 v[16:31], v[96:99], a[136:139], v[16:31]
    ds_read_b64_tr_b16 v[88:89], v248 offset:10240
    ds_read_b64_tr_b16 v[90:91], v248 offset:11264
    v_mfma_f32_32x32x16_bf16 v[32:47], v[96:99], a[140:143], v[32:47]
    s_waitcnt lgkmcnt(6)
    s_nop 0
    v_mfma_f32_32x32x16_bf16 v[48:63], v[100:103], a[136:139], v[48:63]
    ds_read_b64_tr_b16 v[92:93], v253 offset:10240
    ds_read_b64_tr_b16 v[94:95], v253 offset:11264
    v_mfma_f32_32x32x16_bf16 v[64:79], v[100:103], a[140:143], v[64:79]
    s_add_u32 m0, s67, 6144
    s_add_u32 s69, s68, 39424
    buffer_load_dwordx4 v249, s[28:31], s69 offen lds
    s_add_u32 m0, s67, 7168
    s_add_u32 s69, s68, 46592
    buffer_load_dwordx4 v249, s[28:31], s69 offen lds
    s_lshr_b32 s49, s59, 1
    s_lshl_b32 s49, s49, 7
    s_add_u32 s52, s49, 16781312
    buffer_load_dword v7, v252, s[4:7], s52 offen sc1
    s_waitcnt vmcnt(23)
    s_waitcnt lgkmcnt(6)
    v_mfma_f32_32x32x16_bf16 v[16:31], v[80:83], a[144:147], v[16:31]
    ds_read_b64_tr_b16 v[96:97], v248 offset:12288
    ds_read_b64_tr_b16 v[98:99], v248 offset:13312
    v_mfma_f32_32x32x16_bf16 v[32:47], v[80:83], a[148:151], v[32:47]
    s_waitcnt lgkmcnt(6)
    s_nop 0
    v_mfma_f32_32x32x16_bf16 v[48:63], v[84:87], a[144:147], v[48:63]
    ds_read_b64_tr_b16 v[100:101], v253 offset:12288
    ds_read_b64_tr_b16 v[102:103], v253 offset:13312
    v_mfma_f32_32x32x16_bf16 v[64:79], v[84:87], a[148:151], v[64:79]
    s_add_u32 m0, s67, 8192
    s_add_u32 s69, s68, 50176
    buffer_load_dwordx4 v249, s[28:31], s69 offen lds
    s_add_u32 m0, s67, 9216
    s_add_u32 s69, s68, 57344
    buffer_load_dwordx4 v249, s[28:31], s69 offen lds
    s_waitcnt vmcnt(23)
    s_waitcnt lgkmcnt(6)
    v_mfma_f32_32x32x16_bf16 v[16:31], v[88:91], a[152:155], v[16:31]
    ds_read_b64_tr_b16 v[80:81], v248 offset:14336
    ds_read_b64_tr_b16 v[82:83], v248 offset:15360
    v_mfma_f32_32x32x16_bf16 v[32:47], v[88:91], a[156:159], v[32:47]
    s_waitcnt lgkmcnt(6)
    s_nop 0
    v_mfma_f32_32x32x16_bf16 v[48:63], v[92:95], a[152:155], v[48:63]
    ds_read_b64_tr_b16 v[84:85], v253 offset:14336
    ds_read_b64_tr_b16 v[86:87], v253 offset:15360
    v_mfma_f32_32x32x16_bf16 v[64:79], v[92:95], a[156:159], v[64:79]
    s_add_u32 m0, s67, 10240
    s_add_u32 s69, s68, 64512
    buffer_load_dwordx4 v249, s[28:31], s69 offen lds
    s_add_u32 m0, s67, 11264
    s_add_u32 s69, s68, 71680
    buffer_load_dwordx4 v249, s[28:31], s69 offen lds
    s_waitcnt vmcnt(23)
    s_waitcnt lgkmcnt(6)
    v_mfma_f32_32x32x16_bf16 v[16:31], v[96:99], a[160:163], v[16:31]
    ds_read_b64_tr_b16 v[88:89], v248 offset:16384
    ds_read_b64_tr_b16 v[90:91], v248 offset:17408
    v_mfma_f32_32x32x16_bf16 v[32:47], v[96:99], a[164:167], v[32:47]
    s_waitcnt lgkmcnt(6)
    s_nop 0
    v_mfma_f32_32x32x16_bf16 v[48:63], v[100:103], a[160:163], v[48:63]
    ds_read_b64_tr_b16 v[92:93], v253 offset:16384
    ds_read_b64_tr_b16 v[94:95], v253 offset:17408
    v_mfma_f32_32x32x16_bf16 v[64:79], v[100:103], a[164:167], v[64:79]
    s_add_u32 m0, s67, 12288
    s_add_u32 s69, s68, 75264
    buffer_load_dwordx4 v249, s[28:31], s69 offen lds
    s_add_u32 m0, s67, 13312
    s_add_u32 s69, s68, 82432
    buffer_load_dwordx4 v249, s[28:31], s69 offen lds
    s_waitcnt vmcnt(23)
    s_waitcnt lgkmcnt(6)
    v_mfma_f32_32x32x16_bf16 v[16:31], v[80:83], a[168:171], v[16:31]
    ds_read_b64_tr_b16 v[96:97], v248 offset:18432
    ds_read_b64_tr_b16 v[98:99], v248 offset:19456
    v_mfma_f32_32x32x16_bf16 v[32:47], v[80:83], a[172:175], v[32:47]
    s_waitcnt lgkmcnt(6)
    s_nop 0
    v_mfma_f32_32x32x16_bf16 v[48:63], v[84:87], a[168:171], v[48:63]
    ds_read_b64_tr_b16 v[100:101], v253 offset:18432
    ds_read_b64_tr_b16 v[102:103], v253 offset:19456
    v_mfma_f32_32x32x16_bf16 v[64:79], v[84:87], a[172:175], v[64:79]
    s_add_u32 m0, s67, 14336
    s_add_u32 s69, s68, 89600
    buffer_load_dwordx4 v249, s[28:31], s69 offen lds
    s_add_u32 m0, s67, 15360
    s_add_u32 s69, s68, 96768
    buffer_load_dwordx4 v249, s[28:31], s69 offen lds
    s_waitcnt vmcnt(8)
    v_cmp_gt_u32 vcc, 16, v7
    s_cmp_eq_u64 vcc, 0
    s_cbranch_scc1 L_of_50_ok
    s_mov_b32 s72, 0
L_of_50:
    s_nop 0
    buffer_load_dword v7, v252, s[4:7], s52 offen sc1
    s_waitcnt vmcnt(0)
    v_cmp_gt_u32 vcc, 16, v7
    s_cmp_eq_u64 vcc, 0
    s_cbranch_scc1 L_of_50_ok
    s_add_u32 s72, s72, 1
    s_nop 0
    s_cmp_lt_u32 s72, 1000000
    s_cbranch_scc1 L_of_50
    s_endpgm
L_of_50_ok:
    s_add_u32 s50, s65, 0
    s_nop 0
    buffer_load_dwordx4 v[104:107], v2, s[4:7], s50 offen sc1
    s_add_u32 s50, s99, 0
    s_nop 0
    buffer_load_dwordx4 v[108:111], v2, s[4:7], s50 offen sc1
    s_waitcnt lgkmcnt(6)
    s_nop 0
    v_mfma_f32_32x32x16_bf16 v[16:31], v[88:91], a[176:179], v[16:31]
    ds_read_b64_tr_b16 v[80:81], v248 offset:20480
    ds_read_b64_tr_b16 v[82:83], v248 offset:21504
    v_mfma_f32_32x32x16_bf16 v[32:47], v[88:91], a[180:183], v[32:47]
    s_waitcnt lgkmcnt(6)
    s_nop 0
    v_mfma_f32_32x32x16_bf16 v[48:63], v[92:95], a[176:179], v[48:63]
    ds_read_b64_tr_b16 v[84:85], v253 offset:20480
    ds_read_b64_tr_b16 v[86:87], v253 offset:21504
    v_mfma_f32_32x32x16_bf16 v[64:79], v[92:95], a[180:183], v[64:79]
    s_add_u32 s50, s65, 1024
    buffer_load_dwordx4 v[112:115], v2, s[4:7], s50 offen sc1
    s_add_u32 s50, s99, 1024
    buffer_load_dwordx4 v[116:119], v2, s[4:7], s50 offen sc1
    s_waitcnt lgkmcnt(6)
    s_nop 0
    v_mfma_f32_32x32x16_bf16 v[16:31], v[96:99], a[184:187], v[16:31]
    ds_read_b64_tr_b16 v[88:89], v248 offset:22528
    ds_read_b64_tr_b16 v[90:91], v248 offset:23552
    v_mfma_f32_32x32x16_bf16 v[32:47], v[96:99], a[188:191], v[32:47]
    s_waitcnt lgkmcnt(6)
    s_nop 0
    v_mfma_f32_32x32x16_bf16 v[48:63], v[100:103], a[184:187], v[48:63]
    ds_read_b64_tr_b16 v[92:93], v253 offset:22528
    ds_read_b64_tr_b16 v[94:95], v253 offset:23552
    v_mfma_f32_32x32x16_bf16 v[64:79], v[100:103], a[188:191], v[64:79]
    s_add_u32 s50, s65, 2048
    buffer_load_dwordx4 v[120:123], v2, s[4:7], s50 offen sc1
    s_add_u32 s50, s99, 2048
    buffer_load_dwordx4 v[124:127], v2, s[4:7], s50 offen sc1
    s_waitcnt lgkmcnt(6)
    s_nop 0
    v_mfma_f32_32x32x16_bf16 v[16:31], v[80:83], a[192:195], v[16:31]
    ds_read_b64_tr_b16 v[96:97], v248 offset:24576
    ds_read_b64_tr_b16 v[98:99], v248 offset:25600
    v_mfma_f32_32x32x16_bf16 v[32:47], v[80:83], a[196:199], v[32:47]
    s_waitcnt lgkmcnt(6)
    s_nop 0
    v_mfma_f32_32x32x16_bf16 v[48:63], v[84:87], a[192:195], v[48:63]
    ds_read_b64_tr_b16 v[100:101], v253 offset:24576
    ds_read_b64_tr_b16 v[102:103], v253 offset:25600
    v_mfma_f32_32x32x16_bf16 v[64:79], v[84:87], a[196:199], v[64:79]
    s_add_u32 s50, s65, 3072
    buffer_load_dwordx4 v[128:131], v2, s[4:7], s50 offen sc1
    s_add_u32 s50, s99, 3072
    buffer_load_dwordx4 v[132:135], v2, s[4:7], s50 offen sc1
    s_waitcnt lgkmcnt(6)
    s_nop 0
    v_mfma_f32_32x32x16_bf16 v[16:31], v[88:91], a[200:203], v[16:31]
    ds_read_b64_tr_b16 v[80:81], v248 offset:26624
    ds_read_b64_tr_b16 v[82:83], v248 offset:27648
    v_mfma_f32_32x32x16_bf16 v[32:47], v[88:91], a[204:207], v[32:47]
    s_waitcnt lgkmcnt(6)
    s_nop 0
    v_mfma_f32_32x32x16_bf16 v[48:63], v[92:95], a[200:203], v[48:63]
    ds_read_b64_tr_b16 v[84:85], v253 offset:26624
    ds_read_b64_tr_b16 v[86:87], v253 offset:27648
    v_mfma_f32_32x32x16_bf16 v[64:79], v[92:95], a[204:207], v[64:79]
    s_add_u32 s50, s65, 4096
    buffer_load_dwordx4 v[136:139], v2, s[4:7], s50 offen sc1
    s_add_u32 s50, s99, 4096
    buffer_load_dwordx4 v[140:143], v2, s[4:7], s50 offen sc1
    s_waitcnt lgkmcnt(6)
    s_nop 0
    v_mfma_f32_32x32x16_bf16 v[16:31], v[96:99], a[208:211], v[16:31]
    ds_read_b64_tr_b16 v[88:89], v248 offset:0
    ds_read_b64_tr_b16 v[90:91], v248 offset:1024
    v_mfma_f32_32x32x16_bf16 v[32:47], v[96:99], a[212:215], v[32:47]
    s_waitcnt lgkmcnt(6)
    s_nop 0
    v_mfma_f32_32x32x16_bf16 v[48:63], v[100:103], a[208:211], v[48:63]
    ds_read_b64_tr_b16 v[92:93], v253 offset:0
    ds_read_b64_tr_b16 v[94:95], v253 offset:1024
    v_mfma_f32_32x32x16_bf16 v[64:79], v[100:103], a[212:215], v[64:79]
    s_add_u32 s50, s65, 5120
    buffer_load_dwordx4 v[144:147], v2, s[4:7], s50 offen sc1
    s_add_u32 s50, s99, 5120
    buffer_load_dwordx4 v[148:151], v2, s[4:7], s50 offen sc1
    s_lshl_b32 s49, s60, 7
    s_lshr_b32 s51, s44, 1
    s_lshl_b32 s51, s51, 6
    s_add_u32 s49, s49, s51
    v_lshrrev_b32 v15, 9, v2
    v_lshlrev_b32 v15, 4, v15
    v_add_u32 v15, s49, v15
    s_waitcnt lgkmcnt(6)
    v_mfma_f32_32x32x16_bf16 v[16:31], v[80:83], a[216:219], v[16:31]
    ds_read_b64_tr_b16 v[96:97], v248 offset:2048
    ds_read_b64_tr_b16 v[98:99], v248 offset:3072
    v_mfma_f32_32x32x16_bf16 v[32:47], v[80:83], a[220:223], v[32:47]
    s_waitcnt lgkmcnt(6)
    s_nop 0
    v_mfma_f32_32x32x16_bf16 v[48:63], v[84:87], a[216:219], v[48:63]
    ds_read_b64_tr_b16 v[100:101], v253 offset:2048
    ds_read_b64_tr_b16 v[102:103], v253 offset:3072
    v_mfma_f32_32x32x16_bf16 v[64:79], v[84:87], a[220:223], v[64:79]
    s_add_u32 s50, s65, 6144
    buffer_load_dwordx4 v[152:155], v2, s[4:7], s50 offen sc1
    s_add_u32 s50, s99, 6144
    buffer_load_dwordx4 v[156:159], v2, s[4:7], s50 offen sc1
    s_waitcnt vmcnt(12)
    s_waitcnt lgkmcnt(6)
    v_mfma_f32_32x32x16_bf16 v[16:31], v[88:91], v[104:107], v[16:31]
    ds_read_b64_tr_b16 v[80:81], v248 offset:4096
    ds_read_b64_tr_b16 v[82:83], v248 offset:5120
    v_mfma_f32_32x32x16_bf16 v[32:47], v[88:91], v[108:111], v[32:47]
    s_waitcnt lgkmcnt(6)
    s_nop 0
    v_mfma_f32_32x32x16_bf16 v[48:63], v[92:95], v[104:107], v[48:63]
    ds_read_b64_tr_b16 v[84:85], v253 offset:4096
    ds_read_b64_tr_b16 v[86:87], v253 offset:5120
    v_mfma_f32_32x32x16_bf16 v[64:79], v[92:95], v[108:111], v[64:79]
    s_add_u32 s50, s65, 7168
    buffer_load_dwordx4 v[160:163], v2, s[4:7], s50 offen sc1
    s_add_u32 s50, s99, 7168
    buffer_load_dwordx4 v[164:167], v2, s[4:7], s50 offen sc1
    s_waitcnt vmcnt(12)
    s_waitcnt lgkmcnt(6)
    v_mfma_f32_32x32x16_bf16 v[16:31], v[96:99], v[112:115], v[16:31]
    ds_read_b64_tr_b16 v[88:89], v248 offset:6144
    ds_read_b64_tr_b16 v[90:91], v248 offset:7168
    v_mfma_f32_32x32x16_bf16 v[32:47], v[96:99], v[116:119], v[32:47]
    s_waitcnt lgkmcnt(6)
    s_nop 0
    v_mfma_f32_32x32x16_bf16 v[48:63], v[100:103], v[112:115], v[48:63]
    ds_read_b64_tr_b16 v[92:93], v253 offset:6144
    ds_read_b64_tr_b16 v[94:95], v253 offset:7168
    v_mfma_f32_32x32x16_bf16 v[64:79], v[100:103], v[116:119], v[64:79]
    buffer_load_dwordx4 v[176:179], v15, s[32:35], 0 offen offset:0
    s_xor_b32 s49, s44, 1
    s_nop 0
    s_mul_i32 s49, s49, 12288
    s_add_u32 s49, s49, 114688
    v_add_u32 v10, s49, v2
    s_xor_b32 s49, s44, 2
    s_mul_i32 s49, s49, 12288
    s_add_u32 s49, s49, 118784
    v_add_u32 v11, s49, v2
    s_xor_b32 s49, s44, 3
    s_mul_i32 s49, s49, 12288
    s_add_u32 s49, s49, 122880
    v_add_u32_e64 v12, s49, v2
    s_mul_i32 s49, s44, 12288
    s_add_u32 s49, s49, 114688
    v_add_u32_e64 v13, s49, v2
    s_waitcnt vmcnt(11)
    s_waitcnt lgkmcnt(6)
    v_mfma_f32_32x32x16_bf16 v[16:31], v[80:83], v[120:123], v[16:31]
    ds_read_b64_tr_b16 v[96:97], v248 offset:8192
    ds_read_b64_tr_b16 v[98:99], v248 offset:9216
    v_mfma_f32_32x32x16_bf16 v[32:47], v[80:83], v[124:127], v[32:47]
    s_waitcnt lgkmcnt(6)
    s_nop 0
    v_mfma_f32_32x32x16_bf16 v[48:63], v[84:87], v[120:123], v[48:63]
    ds_read_b64_tr_b16 v[100:101], v253 offset:8192
    ds_read_b64_tr_b16 v[102:103], v253 offset:9216
    v_mfma_f32_32x32x16_bf16 v[64:79], v[84:87], v[124:127], v[64:79]
    buffer_load_dwordx4 v[180:183], v15, s[32:35], 0 offen offset:32
    s_waitcnt vmcnt(10)
    s_waitcnt lgkmcnt(6)
    v_mfma_f32_32x32x16_bf16 v[16:31], v[88:91], v[128:131], v[16:31]
    ds_read_b64_tr_b16 v[80:81], v248 offset:10240
    ds_read_b64_tr_b16 v[82:83], v248 offset:11264
    v_mfma_f32_32x32x16_bf16 v[32:47], v[88:91], v[132:135], v[32:47]
    s_waitcnt lgkmcnt(6)
    s_nop 0
    v_mfma_f32_32x32x16_bf16 v[48:63], v[92:95], v[128:131], v[48:63]
    ds_read_b64_tr_b16 v[84:85], v253 offset:10240
    ds_read_b64_tr_b16 v[86:87], v253 offset:11264
    v_mfma_f32_32x32x16_bf16 v[64:79], v[92:95], v[132:135], v[64:79]
    s_waitcnt vmcnt(8)
    s_waitcnt lgkmcnt(6)
    v_mfma_f32_32x32x16_bf16 v[16:31], v[96:99], v[136:139], v[16:31]
    ds_read_b64_tr_b16 v[88:89], v248 offset:12288
    ds_read_b64_tr_b16 v[90:91], v248 offset:13312
    v_mfma_f32_32x32x16_bf16 v[32:47], v[96:99], v[140:143], v[32:47]
    s_waitcnt lgkmcnt(6)
    s_nop 0
    v_mfma_f32_32x32x16_bf16 v[48:63], v[100:103], v[136:139], v[48:63]
    ds_read_b64_tr_b16 v[92:93], v253 offset:12288
    ds_read_b64_tr_b16 v[94:95], v253 offset:13312
    v_mfma_f32_32x32x16_bf16 v[64:79], v[100:103], v[140:143], v[64:79]
    s_waitcnt vmcnt(6)
    s_waitcnt lgkmcnt(6)
    v_mfma_f32_32x32x16_bf16 v[16:31], v[80:83], v[144:147], v[16:31]
    ds_read_b64_tr_b16 v[96:97], v248 offset:14336
    ds_read_b64_tr_b16 v[98:99], v248 offset:15360
    v_mfma_f32_32x32x16_bf16 v[32:47], v[80:83], v[148:151], v[32:47]
    s_waitcnt lgkmcnt(6)
    s_nop 0
    v_mfma_f32_32x32x16_bf16 v[48:63], v[84:87], v[144:147], v[48:63]
    ds_read_b64_tr_b16 v[100:101], v253 offset:14336
    ds_read_b64_tr_b16 v[102:103], v253 offset:15360
    v_mfma_f32_32x32x16_bf16 v[64:79], v[84:87], v[148:151], v[64:79]
    s_waitcnt vmcnt(0)
    s_waitcnt lgkmcnt(6)
    v_mfma_f32_32x32x16_bf16 v[16:31], v[88:91], v[152:155], v[16:31]
    v_lshlrev_b32 v184, 16, v240
    v_and_b32 v185, s55, v240
    v_lshlrev_b32 v200, 16, v176
    v_and_b32 v201, s55, v176
    v_add_f32 v184, v184, v200
    v_add_f32 v185, v185, v201
    v_mfma_f32_32x32x16_bf16 v[32:47], v[88:91], v[156:159], v[32:47]
    v_lshlrev_b32 v186, 16, v241
    v_and_b32 v187, s55, v241
    v_lshlrev_b32 v202, 16, v177
    v_and_b32 v203, s55, v177
    v_add_f32_e64 v186, v186, v202
    v_add_f32 v187, v187, v203
    s_waitcnt lgkmcnt(4)
    v_mfma_f32_32x32x16_bf16 v[48:63], v[92:95], v[152:155], v[48:63]
    v_lshlrev_b32 v188, 16, v242
    v_and_b32 v189, s55, v242
    v_lshlrev_b32 v200, 16, v178
    v_and_b32 v201, s55, v178
    v_add_f32 v188, v188, v200
    v_add_f32 v189, v189, v201
    v_mfma_f32_32x32x16_bf16 v[64:79], v[92:95], v[156:159], v[64:79]
    v_lshlrev_b32 v190, 16, v243
    v_and_b32 v191, s55, v243
    v_lshlrev_b32 v202, 16, v179
    v_and_b32 v203, s55, v179
    v_add_f32_e64 v190, v190, v202
    v_add_f32 v191, v191, v203
    s_waitcnt lgkmcnt(0)
    v_mfma_f32_32x32x16_bf16 v[64:79], v[100:103], v[164:167], v[64:79]
    v_lshlrev_b32 v192, 16, v244
    v_and_b32 v193, s55, v244
    v_lshlrev_b32 v200, 16, v180
    v_and_b32 v201, s55, v180
    v_add_f32 v192, v192, v200
    v_add_f32 v193, v193, v201
    v_mfma_f32_32x32x16_bf16 v[48:63], v[100:103], v[160:163], v[48:63]
    v_lshlrev_b32 v194, 16, v245
    v_and_b32 v195, s55, v245
    v_lshlrev_b32 v202, 16, v181
    v_and_b32 v203, s55, v181
    v_add_f32_e64 v194, v194, v202
    v_add_f32 v195, v195, v203
    s_waitcnt lgkmcnt(0)
    v_mfma_f32_32x32x16_bf16 v[32:47], v[96:99], v[164:167], v[32:47]
    v_lshlrev_b32 v196, 16, v246
    v_and_b32 v197, s55, v246
    v_lshlrev_b32 v200, 16, v182
    v_and_b32 v201, s55, v182
    v_add_f32 v196, v196, v200
    v_add_f32 v197, v197, v201
    v_mfma_f32_32x32x16_bf16 v[16:31], v[96:99], v[160:163], v[16:31]
    v_lshlrev_b32 v198, 16, v247
    v_and_b32 v199, s55, v247
    v_lshlrev_b32 v202, 16, v183
    v_and_b32 v203, s55, v183
    v_add_f32 v198, v198, v202
    v_add_f32 v199, v199, v203
    s_nop 7
    s_nop 0
    ds_write_b128 v12, v[64:67] offset:0
    ds_write_b128 v12, v[68:71] offset:1024
    ds_write_b128 v12, v[72:75] offset:2048
    ds_write_b128 v12, v[76:79] offset:3072
    ds_write_b128 v11, v[48:51] offset:0
    ds_write_b128 v11, v[52:55] offset:1024
    ds_write_b128 v11, v[56:59] offset:2048
    ds_write_b128 v11, v[60:63] offset:3072
    ds_write_b128 v10, v[32:35] offset:0
    ds_write_b128 v10, v[36:39] offset:1024
    ds_write_b128 v10, v[40:43] offset:2048
    ds_write_b128 v10, v[44:47] offset:3072
    s_waitcnt lgkmcnt(0)
    s_barrier
    ds_read_b128 v[104:107], v13 offset:0
    ds_read_b128 v[108:111], v13 offset:1024
    ds_read_b128 v[112:115], v13 offset:2048
    ds_read_b128 v[116:119], v13 offset:3072
    ds_read_b128 v[120:123], v13 offset:4096
    ds_read_b128 v[124:127], v13 offset:5120
    ds_read_b128 v[128:131], v13 offset:6144
    ds_read_b128 v[132:135], v13 offset:7168
    ds_read_b128 v[136:139], v13 offset:8192
    ds_read_b128 v[140:143], v13 offset:9216
    ds_read_b128 v[144:147], v13 offset:10240
    ds_read_b128 v[148:151], v13 offset:11264
    s_waitcnt lgkmcnt(8)
    s_nop 0
    v_pk_add_f32 v[16:17], v[16:17], v[104:105]
    v_pk_add_f32 v[18:19], v[18:19], v[106:107]
    v_pk_add_f32 v[20:21], v[20:21], v[108:109]
    v_pk_add_f32 v[22:23], v[22:23], v[110:111]
    v_pk_add_f32 v[24:25], v[24:25], v[112:113]
    v_pk_add_f32 v[26:27], v[26:27], v[114:115]
    v_pk_add_f32 v[28:29], v[28:29], v[116:117]
    v_pk_add_f32 v[30:31], v[30:31], v[118:119]
    s_waitcnt lgkmcnt(4)
    s_nop 0
    v_pk_add_f32 v[16:17], v[16:17], v[120:121]
    v_pk_add_f32 v[18:19], v[18:19], v[122:123]
    v_pk_add_f32 v[20:21], v[20:21], v[124:125]
    v_pk_add_f32 v[22:23], v[22:23], v[126:127]
    v_pk_add_f32 v[24:25], v[24:25], v[128:129]
    v_pk_add_f32 v[26:27], v[26:27], v[130:131]
    v_pk_add_f32 v[28:29], v[28:29], v[132:133]
    v_pk_add_f32 v[30:31], v[30:31], v[134:135]
    s_waitcnt lgkmcnt(0)
    s_nop 0
    v_pk_add_f32 v[16:17], v[16:17], v[136:137]
    v_pk_add_f32 v[18:19], v[18:19], v[138:139]
    v_pk_add_f32 v[20:21], v[20:21], v[140:141]
    v_pk_add_f32 v[22:23], v[22:23], v[142:143]
    v_pk_add_f32 v[24:25], v[24:25], v[144:145]
    v_pk_add_f32 v[26:27], v[26:27], v[146:147]
    v_pk_add_f32 v[28:29], v[28:29], v[148:149]
    v_pk_add_f32 v[30:31], v[30:31], v[150:151]
    s_nop 0
    v_permlane32_swap_b32 v16, v20
    v_permlane32_swap_b32 v17, v21
    v_permlane32_swap_b32 v18, v22
    v_permlane32_swap_b32 v19, v23
    v_permlane32_swap_b32 v24, v28
    v_permlane32_swap_b32 v25, v29
    v_permlane32_swap_b32 v26, v30
    v_permlane32_swap_b32 v27, v31
    s_nop 0
    v_pk_add_f32 v[16:17], v[16:17], v[184:185]
    v_pk_add_f32 v[18:19], v[18:19], v[186:187]
    v_pk_add_f32 v[20:21], v[20:21], v[188:189]
    v_pk_add_f32 v[22:23], v[22:23], v[190:191]
    v_pk_add_f32 v[24:25], v[24:25], v[192:193]
    v_pk_add_f32 v[26:27], v[26:27], v[194:195]
    v_pk_add_f32 v[28:29], v[28:29], v[196:197]
    v_pk_add_f32 v[30:31], v[30:31], v[198:199]
    v_cvt_pk_bf16_f32 v200, v16, v17
    v_cvt_pk_bf16_f32 v201, v18, v19
    v_cvt_pk_bf16_f32 v202, v20, v21
    v_cvt_pk_bf16_f32 v203, v22, v23
    v_cvt_pk_bf16_f32 v204, v24, v25
    v_cvt_pk_bf16_f32 v205, v26, v27
    v_cvt_pk_bf16_f32 v206, v28, v29
    v_cvt_pk_bf16_f32 v207, v30, v31
    buffer_store_dwordx4 v[200:203], v250, s[36:39], 0 offen offset:0
    buffer_store_dwordx4 v[204:207], v250, s[36:39], 0 offen offset:32
    s_branch L_done
L_tail_publish:
    s_waitcnt vmcnt(0)
    s_barrier
    s_cmp_lg_u32 s44, 0
    s_cbranch_scc1 L_done
    s_lshl_b32 s49, s58, 7
    s_add_u32 s49, s49, 16781312
    v_mov_b32 v14, 1
    s_mov_b64 exec, 1
    buffer_atomic_add v14, v252, s[4:7], s49 offen sc1
    s_waitcnt vmcnt(0)
L_done:
    s_endpgm
L_one_pair:
    s_waitcnt lgkmcnt(4)
    s_nop 0
    v_mfma_f32_32x32x16_bf16 v[128:143], v[192:195], v[112:115], v[128:143]
    ds_read_b64_tr_b16 v[208:209], v5 offset:53248
    ds_read_b64_tr_b16 v[210:211], v5 offset:53504
    v_mfma_f32_32x32x16_bf16 v[144:159], v[196:199], v[112:115], v[144:159]
    ds_read_b64_tr_b16 v[212:213], v5 offset:53760
    ds_read_b64_tr_b16 v[214:215], v5 offset:54016
    s_waitcnt lgkmcnt(4)
    s_nop 0
    v_mfma_f32_32x32x16_bf16 v[128:143], v[200:203], v[116:119], v[128:143]
    ds_read_b64_tr_b16 v[192:193], v5 offset:55296
    ds_read_b64_tr_b16 v[194:195], v5 offset:55552
    v_mfma_f32_32x32x16_bf16 v[144:159], v[204:207], v[116:119], v[144:159]
    ds_read_b64_tr_b16 v[196:197], v5 offset:55808
    ds_read_b64_tr_b16 v[198:199], v5 offset:56064
    s_waitcnt lgkmcnt(4)
    s_nop 0
    v_mfma_f32_32x32x16_bf16 v[128:143], v[208:211], v[120:123], v[128:143]
    v_mfma_f32_32x32x16_bf16 v[144:159], v[212:215], v[120:123], v[144:159]
    s_waitcnt lgkmcnt(0)
    s_nop 0
    v_mfma_f32_32x32x16_bf16 v[128:143], v[192:195], v[124:127], v[128:143]
    v_mfma_f32_32x32x16_bf16 v[144:159], v[196:199], v[124:127], v[144:159]
    s_mov_b32 s52, 16777216
    buffer_load_dword v7, v251, s[4:7], s52 offen sc1
    s_waitcnt vmcnt(0)
    v_cmp_gt_u32 vcc, 16, v7
    s_cmp_eq_u64 vcc, 0
    s_cbranch_scc1 L_kv_47_ok
    s_mov_b32 s72, 0
L_kv_47:
    s_nop 0
    buffer_load_dword v7, v251, s[4:7], s52 offen sc1
    s_waitcnt vmcnt(0)
    v_cmp_gt_u32 vcc, 16, v7
    s_cmp_eq_u64 vcc, 0
    s_cbranch_scc1 L_kv_47_ok
    s_add_u32 s72, s72, 1
    s_nop 0
    s_cmp_lt_u32 s72, 1000000
    s_cbranch_scc1 L_kv_47
    s_endpgm
L_kv_47_ok:
    s_barrier
    s_add_u32 s49, s44, 1
    s_and_b32 s49, s49, 3
    s_lshl_b32 s49, s49, 11
    s_add_u32 s49, s49, s63
    s_nop 0
    buffer_load_dwordx4 v[16:19], v2, s[4:7], s49 offen sc1
    buffer_load_dwordx4 v[20:23], v2, s[4:7], s49 offen offset:1024 sc1
    s_add_u32 s49, s44, 2
    s_and_b32 s49, s49, 3
    s_lshl_b32 s49, s49, 11
    s_add_u32 s49, s49, s63
    buffer_load_dwordx4 v[24:27], v2, s[4:7], s49 offen sc1
    buffer_load_dwordx4 v[28:31], v2, s[4:7], s49 offen offset:1024 sc1
    s_add_u32 s49, s44, 3
    s_and_b32 s49, s49, 3
    s_lshl_b32 s49, s49, 11
    s_add_u32 s49, s49, s63
    buffer_load_dwordx4 v[32:35], v2, s[4:7], s49 offen sc1
    buffer_load_dwordx4 v[36:39], v2, s[4:7], s49 offen offset:1024 sc1
    s_add_u32 s49, s44, 4
    s_and_b32 s49, s49, 3
    s_lshl_b32 s49, s49, 11
    s_add_u32 s49, s49, s63
    buffer_load_dwordx4 v[40:43], v2, s[4:7], s49 offen sc1
    buffer_load_dwordx4 v[44:47], v2, s[4:7], s49 offen offset:1024 sc1
    buffer_load_dwordx4 v[232:235], v2, s[4:7], s73 offen sc1
    buffer_load_dwordx4 v[236:239], v2, s[4:7], s73 offen offset:1024 sc1
    buffer_load_dwordx4 v[48:51], v2, s[4:7], s61 offen sc1
    buffer_load_dwordx4 v[52:55], v2, s[4:7], s61 offen offset:1024 sc1
    buffer_load_dwordx4 v[56:59], v2, s[4:7], s61 offen offset:2048 sc1
    buffer_load_dwordx4 v[60:63], v2, s[4:7], s61 offen offset:3072 sc1
    s_addk_i32 s61, 4096
    s_lshl_b32 s49, s47, 1
    s_lshl_b32 s50, s45, 2
    s_add_u32 s50, s50, s44
    s_mul_i32 s50, s50, 56
    s_add_u32 s49, s49, s50
    s_lshl_b32 s49, s49, 11
    s_nop 0
    s_add_u32 s53, s49, 8388608
    s_waitcnt vmcnt(4)
    s_nop 0
    v_mfma_f32_32x32x16_bf16 v[80:95], v[232:235], v[16:19], 0
    v_max_f32 v128, 0, v128
    v_max_f32 v129, 0, v129
    v_max_f32 v130, 0, v130
    v_max_f32 v131, 0, v131
    v_max_f32 v132, 0, v132
    v_max_f32 v133, 0, v133
    v_max_f32 v134, 0, v134
    v_max_f32 v135, 0, v135
    v_max_f32 v136, 0, v136
    v_max_f32 v137, 0, v137
    v_mfma_f32_32x32x16_bf16 v[80:95], v[236:239], v[20:23], v[80:95]
    buffer_load_dwordx4 v[64:67], v2, s[4:7], s61 offen sc1
    v_max_f32 v138, 0, v138
    v_max_f32 v139, 0, v139
    v_max_f32 v140, 0, v140
    v_max_f32 v141, 0, v141
    v_max_f32 v142, 0, v142
    v_max_f32 v143, 0, v143
    v_mul_f32 v128, v128, v128
    v_mul_f32 v129, v129, v129
    v_mul_f32 v130, v130, v130
    v_mul_f32 v131, v131, v131
    v_mfma_f32_32x32x16_bf16 v[96:111], v[232:235], v[24:27], 0
    v_mul_f32 v132, v132, v132
    v_mul_f32 v133, v133, v133
    v_mul_f32 v134, v134, v134
    v_mul_f32 v135, v135, v135
    v_mul_f32 v136, v136, v136
    v_mul_f32 v137, v137, v137
    v_mul_f32 v138, v138, v138
    v_mul_f32 v139, v139, v139
    v_mul_f32 v140, v140, v140
    v_mul_f32 v141, v141, v141
    v_mfma_f32_32x32x16_bf16 v[96:111], v[236:239], v[28:31], v[96:111]
    buffer_load_dwordx4 v[68:71], v2, s[4:7], s61 offen offset:1024 sc1
    v_mul_f32 v142, v142, v142
    v_mul_f32 v143, v143, v143
    v_cvt_pk_bf16_f32 v216, v128, v129
    v_cvt_pk_bf16_f32 v217, v130, v131
    v_cvt_pk_bf16_f32 v218, v132, v133
    v_cvt_pk_bf16_f32 v219, v134, v135
    v_cvt_pk_bf16_f32 v220, v136, v137
    v_cvt_pk_bf16_f32 v221, v138, v139
    v_cvt_pk_bf16_f32 v222, v140, v141
    v_cvt_pk_bf16_f32 v223, v142, v143
    v_mfma_f32_32x32x16_bf16 v[112:127], v[232:235], v[32:35], 0
    v_max_f32 v144, 0, v144
    v_max_f32 v145, 0, v145
    v_max_f32 v146, 0, v146
    v_max_f32 v147, 0, v147
    v_max_f32 v148, 0, v148
    v_max_f32 v149, 0, v149
    v_max_f32 v150, 0, v150
    v_max_f32 v151, 0, v151
    v_max_f32 v152, 0, v152
    v_max_f32 v153, 0, v153
    v_mfma_f32_32x32x16_bf16 v[112:127], v[236:239], v[36:39], v[112:127]
    buffer_load_dwordx4 v[72:75], v2, s[4:7], s61 offen offset:2048 sc1
    v_max_f32 v154, 0, v154
    v_max_f32 v155, 0, v155
    v_max_f32 v156, 0, v156
    v_max_f32 v157, 0, v157
    v_max_f32 v158, 0, v158
    v_max_f32 v159, 0, v159
    v_mul_f32 v144, v144, v144
    v_mul_f32 v145, v145, v145
    v_mul_f32 v146, v146, v146
    v_mul_f32 v147, v147, v147
    v_mfma_f32_32x32x16_bf16 v[192:207], v[232:235], v[40:43], 0
    v_mul_f32 v148, v148, v148
    v_mul_f32 v149, v149, v149
    v_mul_f32 v150, v150, v150
    v_mul_f32 v151, v151, v151
    v_mul_f32 v152, v152, v152
    v_mul_f32 v153, v153, v153
    v_mul_f32 v154, v154, v154
    v_mul_f32 v155, v155, v155
    v_mul_f32 v156, v156, v156
    v_mul_f32 v157, v157, v157
    v_mfma_f32_32x32x16_bf16 v[192:207], v[236:239], v[44:47], v[192:207]
    buffer_load_dwordx4 v[76:79], v2, s[4:7], s61 offen offset:3072 sc1
    s_addk_i32 s61, 4096
    v_mul_f32 v158, v158, v158
    v_mul_f32_e64 v159, v159, v159
    v_cvt_pk_bf16_f32 v224, v144, v145
    v_cvt_pk_bf16_f32 v225, v146, v147
    v_cvt_pk_bf16_f32 v226, v148, v149
    v_cvt_pk_bf16_f32 v227, v150, v151
    v_cvt_pk_bf16_f32 v228, v152, v153
    v_cvt_pk_bf16_f32 v229, v154, v155
    v_cvt_pk_bf16_f32 v230, v156, v157
    v_cvt_pk_bf16_f32 v231, v158, v159
    buffer_store_dwordx4 v[216:219], v2, s[4:7], s53 offen offset:0 sc1
    buffer_store_dwordx4 v[220:223], v2, s[4:7], s53 offen offset:1024 sc1
    buffer_store_dwordx4 v[224:227], v2, s[4:7], s53 offen offset:2048 sc1
    buffer_store_dwordx4 v[228:231], v2, s[4:7], s53 offen offset:3072 sc1
    s_branch L_attn_go
L_attn_slow:
    s_waitcnt vmcnt(0) lgkmcnt(0)
    s_mov_b32 exec_lo, 0
    v_mov_b32 v46, 0
    s_mov_b32 exec_lo, -1
    s_nop 0
    v_mov_b32 v232, 0xff800000
    s_mov_b32 s50, s73
    s_mov_b32 s49, 0
L_slow_max:
    buffer_load_dwordx4 v[48:51], v2, s[4:7], s50 offen sc1
    buffer_load_dwordx4 v[52:55], v2, s[4:7], s50 offen offset:1024 sc1
    s_waitcnt vmcnt(0)
    s_nop 0
    v_mfma_f32_32x32x16_bf16 v[192:207], v[48:51], v[40:43], 0
    v_mfma_f32_32x32x16_bf16 v[192:207], v[52:55], v[44:47], v[192:207]
    s_nop 7
    s_nop 7
    v_max3_f32 v232, v232, v192, v193
    v_max3_f32 v232, v232, v194, v195
    v_max3_f32 v232, v232, v196, v197
    v_max3_f32 v232, v232, v198, v199
    v_max3_f32 v232, v232, v200, v201
    v_max3_f32 v232, v232, v202, v203
    v_max3_f32 v232, v232, v204, v205
    v_max3_f32 v232, v232, v206, v207
    s_add_u32 s50, s50, 4096
    s_add_u32 s49, s49, 1
    s_cmp_lt_u32 s49, 64
    s_cbranch_scc1 L_slow_max
    v_mov_b32 v233, v232
    s_nop 1
    v_permlane32_swap_b32 v232, v233
    v_max_f32 v232, v232, v233
    v_mov_b32 v176, 0
    v_mov_b32 v177, 0
    v_mov_b32 v178, 0
    v_mov_b32 v179, 0
    v_mov_b32 v180, 0
    v_mov_b32 v181, 0
    v_mov_b32 v182, 0
    v_mov_b32 v183, 0
    v_mov_b32 v184, 0
    v_mov_b32 v185, 0
    v_mov_b32 v186, 0
    v_mov_b32 v187, 0
    v_mov_b32 v188, 0
    v_mov_b32 v189, 0
    v_mov_b32 v190, 0
    v_mov_b32 v191, 0
    s_mov_b32 s50, s73
    s_mov_b32 s49, 0
L_slow_pv:
    s_nop 0
    buffer_load_dwordx4 v[48:51], v2, s[4:7], s50 offen sc1
    buffer_load_dwordx4 v[52:55], v2, s[4:7], s50 offen offset:1024 sc1
    buffer_load_dwordx4 v[56:59], v2, s[4:7], s50 offen offset:2048 sc1
    buffer_load_dwordx4 v[60:63], v2, s[4:7], s50 offen offset:3072 sc1
    s_waitcnt vmcnt(0)
    s_nop 0
    v_mfma_f32_32x32x16_bf16 v[192:207], v[48:51], v[40:43], 0
    v_mfma_f32_32x32x16_bf16 v[192:207], v[52:55], v[44:47], v[192:207]
    s_nop 7
    s_nop 7
    v_sub_f32 v192, v192, v232
    v_sub_f32 v193, v193, v232
    v_sub_f32 v194, v194, v232
    v_sub_f32 v195, v195, v232
    v_sub_f32 v196, v196, v232
    v_sub_f32 v197, v197, v232
    v_sub_f32 v198, v198, v232
    v_sub_f32 v199, v199, v232
    v_sub_f32 v200, v200, v232
    v_sub_f32 v201, v201, v232
    v_sub_f32 v202, v202, v232
    v_sub_f32 v203, v203, v232
    v_sub_f32 v204, v204, v232
    v_sub_f32 v205, v205, v232
    v_sub_f32 v206, v206, v232
    v_sub_f32 v207, v207, v232
    v_exp_f32 v192, v192
    v_exp_f32 v193, v193
    v_exp_f32 v194, v194
    v_exp_f32 v195, v195
    v_exp_f32 v196, v196
    v_exp_f32 v197, v197
    v_exp_f32 v198, v198
    v_exp_f32 v199, v199
    v_exp_f32 v200, v200
    v_exp_f32 v201, v201
    v_exp_f32 v202, v202
    v_exp_f32 v203, v203
    v_exp_f32 v204, v204
    v_exp_f32 v205, v205
    v_exp_f32_e64 v206, v206
    v_exp_f32 v207, v207
    s_nop 1
    v_cvt_pk_bf16_f32 v112, v192, v193
    v_cvt_pk_bf16_f32 v113, v194, v195
    v_cvt_pk_bf16_f32 v114, v196, v197
    v_cvt_pk_bf16_f32 v115, v198, v199
    v_cvt_pk_bf16_f32 v116, v200, v201
    v_cvt_pk_bf16_f32 v117, v202, v203
    v_cvt_pk_bf16_f32 v118, v204, v205
    v_cvt_pk_bf16_f32 v119, v206, v207
    s_nop 1
    s_nop 0
    v_mfma_f32_32x32x16_bf16 v[176:191], v[56:59], v[112:115], v[176:191]
    v_mfma_f32_32x32x16_bf16 v[176:191], v[60:63], v[116:119], v[176:191]
    s_add_u32 s50, s50, 4096
    s_add_u32 s49, s49, 1
    s_cmp_lt_u32 s49, 64
    s_cbranch_scc1 L_slow_pv
    s_nop 7
    s_nop 7
    v_mov_b32 v224, v188
    v_mov_b32 v225, v188
    s_nop 1
    v_permlane32_swap_b32 v224, v225
    v_rcp_f32 v224, v225
    s_nop 1
    s_branch L_attn_fin
L_code_end:
.section .rodata,"a"
.p2align 6
.amdhsa_kernel parallel_sum__softmax_full_mha__dense_activation_squared_relu__prompt_kernel
  .amdhsa_next_free_vgpr 512
  .amdhsa_next_free_sgpr 102
  .amdhsa_accum_offset 256
  .amdhsa_group_segment_fixed_size 0
  .amdhsa_kernarg_size 88
  .amdhsa_user_sgpr_count 2
  .amdhsa_user_sgpr_kernarg_segment_ptr 1
  .amdhsa_system_sgpr_workgroup_id_x 1
.end_amdhsa_kernel
```
